```python
import torch

def _softmax(x, axis=-1):
    return torch.softmax(x, dim=axis)

def _gelu(x):
    return torch.nn.functional.gelu(x, approximate='tanh')

def _silu(x):
    return torch.nn.functional.silu(x)

def _sigmoid(x):
    return torch.sigmoid(x)

def _layernorm(x, axis=-1, eps=1e-05):
    m = x.mean(dim=axis, keepdim=True)
    v = x.var(dim=axis, keepdim=True, unbiased=False)
    return (x - m) / torch.sqrt(v + eps)

def _scatter_add(tgt, idx, src, axis=0):
    return tgt.clone().index_add_(axis, idx, src)

def _segment_sum(src, seg, n):
    out = torch.zeros((n,) + src.shape[1:], dtype=src.dtype)
    return out.index_add_(0, seg, src)

def _pad(x, pw):
    flat = tuple((v for pair in reversed(pw) for v in pair))
    return torch.nn.functional.pad(x, flat)
kernel_name = 'adaLN_cond__sliding_block__mixer_gmlp__prompt'

def setup_inputs():

    _w = lambda a: (lambda t: t.to(torch.bfloat16) if t.is_floating_point() else t)(torch.as_tensor(a))

    def _A_setup():
        B, S, D = (1, 2048, 448)
        return {'x': _w((lambda *s: torch.randn(*s, dtype=torch.bfloat16) * 0.05)(B, S, D)), 'wqkv': _w((lambda *s: torch.randn(*s, dtype=torch.bfloat16) * 0.05)(D, 3 * D)), 'wo': _w((lambda *s: torch.randn(*s, dtype=torch.bfloat16) * 0.05)(D, D))}
    _A_in = _A_setup()

    def _B_setup():
        B, S, D, F = (1, 2048, 448, 1792)
        Fh = F // 2
        return {'x': _w((lambda *s: torch.randn(*s, dtype=torch.bfloat16) * 0.05)(B, S, D)), 'w_in': _w((lambda *s: torch.randn(*s, dtype=torch.bfloat16) * 0.4)(D, 2 * Fh)), 'w_sp': _w(0.01 * (lambda *s: torch.randn(*s, dtype=torch.bfloat16) * 0.4)(S, S)), 'b_sp': _w(1.0 + 0.01 * (lambda *s: torch.randn(*s, dtype=torch.bfloat16) * 0.05)(S)), 'w_out': _w((lambda *s: torch.randn(*s, dtype=torch.bfloat16) * 0.05)(Fh, D))}
    _B_in = _B_setup()
    return {'A_x': _A_in['x'], 'A_wqkv': _A_in['wqkv'], 'A_wo': _A_in['wo'], 'B_x': _B_in['x'], 'B_w_in': _B_in['w_in'], 'B_w_sp': _B_in['w_sp'], 'B_b_sp': _B_in['b_sp'], 'B_w_out': _B_in['w_out'], 'c': _w((lambda *s: torch.randn(*s, dtype=torch.bfloat16) * 0.1)(1, 448) * 8.0), 'w_mod': _w((lambda *s: torch.randn(*s, dtype=torch.bfloat16) * 0.1)(448, 6 * 448) * 448 ** (-0.5) * 8.0)}

def reference(A_x, A_wqkv, A_wo, B_x, B_w_in, B_w_sp, B_b_sp, B_w_out, c, w_mod):

    def _A_ref(x, wqkv, wo):
        B, S, D = x.shape
        H = 16
        Dh = D // H
        W = 256
        qkv = (lambda x, *d: x.permute(*d))((x @ wqkv).reshape(B, S, 3, H, Dh), 2, 0, 3, 1, 4)
        q, k, v = (qkv[0], qkv[1], qkv[2])
        scores = torch.einsum('bhqd,bhkd->bhqk', q, k) * Dh ** (-0.5)
        idx = torch.arange(S)
        mask = (idx[:, None] - idx[None, :] >= 0) & (idx[:, None] - idx[None, :] < W)
        scores = torch.where(mask[None, None], scores, -1000000000.0)
        p = _softmax(scores, axis=-1)
        o = torch.einsum('bhqk,bhkd->bhqd', p, v)
        return (lambda x, *d: x.permute(*d))(o, 0, 2, 1, 3).reshape(B, S, D) @ wo

    def _B_ref(x, w_in, w_sp, b_sp, w_out):
        B, S, D = x.shape
        F = w_in.shape[-1]
        Fh = F // 2
        z = _gelu(torch.einsum('bsd,df->bsf', x, w_in))
        z1 = z[..., :Fh].clone()
        z2 = _layernorm(z[..., Fh:], axis=-1)
        g = torch.einsum('ts,bsf->btf', w_sp, z2) + b_sp[None, :, None]
        return torch.einsum('bsf,fd->bsd', z1 * g, w_out)
    x = A_x
    mod = (_silu(c) @ w_mod).reshape(c.shape[0], 6, 1, -1)
    sa, ca, ga, sb, cb, gb = (mod[:, 0].clone(), mod[:, 1].clone(), mod[:, 2].clone(), mod[:, 3].clone(), mod[:, 4].clone(), mod[:, 5].clone())
    h = _layernorm(x, axis=-1) * (1 + ca) + sa
    x = x + ga * _A_ref(h, A_wqkv, A_wo)
    h = _layernorm(x, axis=-1) * (1 + cb) + sb
    x = x + gb * _B_ref(h, B_w_in, B_w_sp, B_b_sp, B_w_out)
    return x
```

```asm
; @launch grid=(256,1,1) block=(256,1,1) lds=163840
.amdgcn_target "amdgcn-amd-amdhsa--gfx950"
.text
.globl adaLN_cond__sliding_block__mixer_gmlp__prompt_kernel
.p2align 8
.type adaLN_cond__sliding_block__mixer_gmlp__prompt_kernel,@function
adaLN_cond__sliding_block__mixer_gmlp__prompt_kernel:
  s_cmp_ge_u32 s2, 256
  s_cbranch_scc1 L_end
  s_load_dwordx16 s[56:71], s[0:1], 0
  s_load_dwordx8 s[72:79], s[0:1], 64
  s_load_dwordx2 s[80:81], s[0:1], 96
  s_sub_u32 s82, s2, 240
  s_cmp_lt_u32 s82, 16
  s_cbranch_scc0 L_nopf
  s_getpc_b64 s[84:85]
L_pf_pc:
  s_sub_u32 s84, s84, L_pf_pc-adaLN_cond__sliding_block__mixer_gmlp__prompt_kernel
  s_subb_u32 s85, s85, 0
  v_lshlrev_b32 v5, 7, v0
  s_mov_b32 s83, L_end-adaLN_cond__sliding_block__mixer_gmlp__prompt_kernel
  v_add_u32 v6, 0, v5
  v_min_u32 v6, s83, v6
  global_load_dword a255, v6, s[84:85]
  v_add_u32 v6, 32768, v5
  v_min_u32 v6, s83, v6
  global_load_dword a255, v6, s[84:85]
  s_nop 0
L_nopf:
  v_and_b32 v1, 63, v0
  v_lshrrev_b32 v5, 6, v0
  s_nop 0
  v_readfirstlane_b32 s52, v5
  v_lshlrev_b32 v2, 4, v1
  v_and_b32 v3, 15, v1
  v_lshrrev_b32 v4, 4, v1
  s_and_b32 s82, s2, 7
  s_lshr_b32 s83, s82, 1
  s_and_b32 s84, s82, 1
  s_lshr_b32 s85, s2, 3
  s_lshr_b32 s86, s85, 2
  s_lshl_b32 s83, s83, 3
  s_add_u32 s53, s83, s86
  s_and_b32 s85, s85, 3
  s_lshl_b32 s84, s84, 2
  s_add_u32 s54, s84, s85
  s_mov_b32 s100, 0xffff0000
  s_waitcnt lgkmcnt(0)
  s_mov_b32 s48, s80
  s_mov_b32 s49, s81
  s_mov_b32 s50, 33554432
  s_mov_b32 s51, 0x20000
  s_mov_b32 s36, s72
  s_mov_b32 s37, s73
  s_mov_b32 s38, 896
  s_mov_b32 s39, 0x20000
  s_mov_b32 s40, s74
  s_mov_b32 s41, s75
  s_mov_b32 s42, 2408448
  s_mov_b32 s43, 0x20000
  s_mov_b32 s8, s56
  s_mov_b32 s9, s57
  s_mov_b32 s10, 1835008
  s_mov_b32 s11, 0x20000
  s_mov_b32 s12, s58
  s_mov_b32 s13, s59
  s_mov_b32 s14, 1204224
  s_mov_b32 s15, 0x20000
  s_mov_b32 s16, s60
  s_mov_b32 s17, s61
  s_mov_b32 s18, 401408
  s_mov_b32 s19, 0x20000
  s_mov_b32 s20, s64
  s_mov_b32 s21, s65
  s_mov_b32 s22, 1605632
  s_mov_b32 s23, 0x20000
  s_mov_b32 s24, s66
  s_mov_b32 s25, s67
  s_mov_b32 s26, 8388608
  s_mov_b32 s27, 0x20000
  s_mov_b32 s28, s68
  s_mov_b32 s29, s69
  s_mov_b32 s30, 4096
  s_mov_b32 s31, 0x20000
  s_mov_b32 s32, s70
  s_mov_b32 s33, s71
  s_mov_b32 s34, 802816
  s_mov_b32 s35, 0x20000
  s_mov_b32 s44, s76
  s_mov_b32 s45, s77
  s_mov_b32 s46, 1835008
  s_mov_b32 s47, 0x20000
  s_mov_b32 s4, s78
  s_mov_b32 s5, s79
  s_mov_b32 s6, 256
  s_mov_b32 s7, 0x20000
  buffer_load_dword v6, off, s[48:51], 0 sc1
  s_sub_u32 s63, s2, 228
  s_sub_u32 s82, s2, 144
  s_cmp_ge_u32 s2, 228
  s_cselect_b32 s63, s63, s82
  s_cmp_ge_u32 s2, 172
  s_cbranch_scc0 L_nogemv_ld
  v_lshrrev_b32 v7, 2, v1
  v_mul_u32_u24 v8, 5376, v7
  v_and_b32 v9, 3, v1
  v_lshlrev_b32 v9, 4, v9
  v_add_u32 v8, v8, v9
  v_lshlrev_b32 v7, 1, v7
  s_mul_i32 s82, s52, 602112
  s_lshl_b32 s83, s63, 6
  s_add_u32 s82, s82, s83
  s_mul_i32 s83, s52, 224
  buffer_load_dwordx4 v[16:19], v8, s[40:43], s82 offen
  s_add_u32 s82, s82, 86016
  buffer_load_dwordx4 v[20:23], v8, s[40:43], s82 offen
  s_add_u32 s82, s82, 86016
  buffer_load_dwordx4 v[24:27], v8, s[40:43], s82 offen
  s_add_u32 s82, s82, 86016
  buffer_load_dwordx4 v[28:31], v8, s[40:43], s82 offen
  s_add_u32 s82, s82, 86016
  buffer_load_dwordx4 v[32:35], v8, s[40:43], s82 offen
  s_add_u32 s82, s82, 86016
  buffer_load_dwordx4 v[36:39], v8, s[40:43], s82 offen
  s_add_u32 s82, s82, 86016
  buffer_load_dwordx4 v[40:43], v8, s[40:43], s82 offen
  buffer_load_ushort v44, v7, s[36:39], s83 offen offset:0
  buffer_load_ushort v45, v7, s[36:39], s83 offen offset:32
  buffer_load_ushort v46, v7, s[36:39], s83 offen offset:64
  buffer_load_ushort v47, v7, s[36:39], s83 offen offset:96
  buffer_load_ushort v48, v7, s[36:39], s83 offen offset:128
  buffer_load_ushort v49, v7, s[36:39], s83 offen offset:160
  buffer_load_ushort v50, v7, s[36:39], s83 offen offset:192
L_nogemv_ld:
  v_lshrrev_b32 v7, 5, v1
  v_lshlrev_b32 v7, 3, v7
  v_bfe_u32 v8, v1, 3, 2
  v_add_u32 v7, v7, v8
  v_mul_u32_u24 v7, 896, v7
  v_and_b32 v8, 7, v1
  v_xor_b32 v8, v8, v4
  v_xor_b32 v9, 4, v8
  v_lshlrev_b32 v8, 4, v8
  v_lshlrev_b32 v9, 4, v9
  v_add_u32 v8, v7, v8
  v_add_u32 v9, v7, v9
  s_lshl_b32 s77, s53, 6
  s_lshr_b32 s83, s52, 1
  s_lshl_b32 s83, s83, 5
  s_add_u32 s77, s77, s83
  s_and_b32 s83, s52, 1
  s_lshl_b32 s83, s83, 2
  s_add_u32 s77, s77, s83
  s_mul_i32 s77, s77, 896
  s_lshl_b32 s78, s52, 11
  s_add_u32 s78, s78, 100352
  s_add_u32 m0, s78, 0
  s_add_u32 s83, s77, 0
  buffer_load_dwordx4 v8, s[8:11], s83 offen lds
  s_add_u32 m0, s78, 1024
  s_add_u32 s83, s77, 14336
  buffer_load_dwordx4 v9, s[8:11], s83 offen lds
  s_add_u32 m0, s78, 8192
  s_add_u32 s83, s77, 128
  buffer_load_dwordx4 v8, s[8:11], s83 offen lds
  s_add_u32 m0, s78, 9216
  s_add_u32 s83, s77, 14464
  buffer_load_dwordx4 v9, s[8:11], s83 offen lds
  s_add_u32 m0, s78, 16384
  s_add_u32 s83, s77, 256
  buffer_load_dwordx4 v8, s[8:11], s83 offen lds
  s_add_u32 m0, s78, 17408
  s_add_u32 s83, s77, 14592
  buffer_load_dwordx4 v9, s[8:11], s83 offen lds
  s_add_u32 m0, s78, 24576
  s_add_u32 s83, s77, 384
  buffer_load_dwordx4 v8, s[8:11], s83 offen lds
  s_add_u32 m0, s78, 25600
  s_add_u32 s83, s77, 14720
  buffer_load_dwordx4 v9, s[8:11], s83 offen lds
  s_add_u32 m0, s78, 32768
  s_add_u32 s83, s77, 512
  buffer_load_dwordx4 v8, s[8:11], s83 offen lds
  s_add_u32 m0, s78, 33792
  s_add_u32 s83, s77, 14848
  buffer_load_dwordx4 v9, s[8:11], s83 offen lds
  s_add_u32 m0, s78, 40960
  s_add_u32 s83, s77, 640
  buffer_load_dwordx4 v8, s[8:11], s83 offen lds
  s_add_u32 m0, s78, 41984
  s_add_u32 s83, s77, 14976
  buffer_load_dwordx4 v9, s[8:11], s83 offen lds
  s_add_u32 m0, s78, 49152
  s_add_u32 s83, s77, 768
  buffer_load_dwordx4 v8, s[8:11], s83 offen lds
  s_add_u32 m0, s78, 50176
  s_add_u32 s83, s77, 15104
  buffer_load_dwordx4 v9, s[8:11], s83 offen lds
  s_lshl_b32 s86, s2, 2
  s_add_u32 s86, s86, s52
  s_add_u32 s87, s2, 516
  s_cmp_eq_u32 s52, 1
  s_cselect_b32 s87, s87, 9999
  s_cmp_lt_u32 s2, 172
  s_cselect_b32 s86, s86, s87
  s_mul_i32 s87, s52, 4096
  s_add_u32 s87, s87, 83968
  s_mov_b32 m0, s87
  s_cmp_lt_u32 s86, 392
  s_cbranch_scc0 L_pp_not_win_i
  s_mul_hi_u32 s82, s86, 153391690
  s_mul_i32 s83, s82, 28
  s_sub_u32 s83, s86, s83
  v_lshrrev_b32 v10, 3, v1
  v_mul_u32_u24 v10, 3584, v10
  v_and_b32 v11, 7, v1
  v_lshlrev_b32 v11, 4, v11
  v_add_u32 v10, v10, v11
  s_mul_i32 s84, s82, 114688
  s_lshl_b32 s85, s83, 7
  s_add_u32 s84, s84, s85
  buffer_load_dwordx4 v10, s[20:23], s84 offen lds
  s_add_u32 s84, s84, 28672
  s_add_u32 m0, m0, 1024
  s_nop 0
  buffer_load_dwordx4 v10, s[20:23], s84 offen lds
  s_add_u32 s84, s84, 28672
  s_add_u32 m0, m0, 1024
  s_nop 0
  buffer_load_dwordx4 v10, s[20:23], s84 offen lds
  s_add_u32 s84, s84, 28672
  s_add_u32 m0, m0, 1024
  s_nop 0
  buffer_load_dwordx4 v10, s[20:23], s84 offen lds
  s_branch L_pp_issued
L_pp_not_win_i:
  s_cmp_lt_u32 s86, 744
  s_cbranch_scc0 L_pp_issued
  v_mul_u32_u24 v10, 37, v1
  v_lshrrev_b32 v10, 8, v10
  v_mul_u32_u24 v11, 7, v10
  v_sub_u32 v11, v1, v11
  v_lshlrev_b32 v11, 4, v11
  v_mul_u32_u24 v10, 896, v10
  v_add_u32 v13, v10, v11
  s_mov_b32 exec_hi, 0x00ffffff
  s_cmp_lt_u32 s86, 520
  s_cbranch_scc0 L_pp_wout_i
  s_sub_u32 s82, s86, 392
  s_lshr_b32 s83, s82, 4
  s_and_b32 s82, s82, 15
  s_mul_i32 s84, s82, 25088
  s_mul_i32 s85, s83, 112
  s_add_u32 s84, s84, s85
  buffer_load_dwordx4 v13, s[16:19], s84 offen lds
  s_add_u32 s84, s84, 7168
  s_add_u32 m0, m0, 896
  s_nop 0
  buffer_load_dwordx4 v13, s[16:19], s84 offen lds
  s_add_u32 s84, s84, 7168
  s_add_u32 m0, m0, 896
  s_nop 0
  buffer_load_dwordx4 v13, s[16:19], s84 offen lds
  s_add_u32 s84, s84, 7168
  s_add_u32 m0, m0, 896
  s_nop 0
  buffer_load_dwordx4 v13, s[16:19], s84 offen lds
  s_branch L_pp_issued7
L_pp_wout_i:
  s_sub_u32 s82, s86, 520
  s_mul_hi_u32 s83, s82, 153391690
  s_mul_i32 s84, s83, 28
  s_sub_u32 s82, s82, s84
  s_mul_i32 s84, s82, 28672
  s_mul_i32 s85, s83, 112
  s_add_u32 s84, s84, s85
  buffer_load_dwordx4 v13, s[32:35], s84 offen lds
  s_add_u32 s84, s84, 7168
  s_add_u32 m0, m0, 896
  s_nop 0
  buffer_load_dwordx4 v13, s[32:35], s84 offen lds
  s_add_u32 s84, s84, 7168
  s_add_u32 m0, m0, 896
  s_nop 0
  buffer_load_dwordx4 v13, s[32:35], s84 offen lds
  s_add_u32 s84, s84, 7168
  s_add_u32 m0, m0, 896
  s_nop 0
  buffer_load_dwordx4 v13, s[32:35], s84 offen lds
L_pp_issued7:
  s_mov_b32 exec_hi, -1
L_pp_issued:
  v_mul_u32_u24 v10, 37, v1
  v_lshrrev_b32 v10, 8, v10
  v_mul_u32_u24 v11, 7, v10
  v_sub_u32 v11, v1, v11
  v_lshlrev_b32 v11, 4, v11
  v_mul_u32_u24 v10, 2688, v10
  v_add_u32 v12, v10, v11
  s_mul_i32 s75, s52, 301056
  s_mul_i32 s82, s54, 112
  s_add_u32 s75, s75, s82
  s_mul_i32 s76, s52, 12544
  s_waitcnt vmcnt(14)
  v_readfirstlane_b32 s82, v6
  s_nop 3
  s_mul_i32 s82, s82, 0x9E3779B1
  s_add_u32 s55, s82, 0x7F4A7C15
  s_cmp_ge_u32 s2, 172
  s_cbranch_scc0 L_nogemv
  s_waitcnt vmcnt(14)
  v_lshlrev_b32 v44, 16, v44
  v_lshlrev_b32 v45, 16, v45
  v_lshlrev_b32 v46, 16, v46
  v_lshlrev_b32 v47, 16, v47
  v_lshlrev_b32 v48, 16, v48
  v_lshlrev_b32 v49, 16, v49
  v_lshlrev_b32 v50, 16, v50
  v_mul_f32 v60, 0xbfb8aa3b, v44
  v_mul_f32 v61, 0xbfb8aa3b, v45
  v_mul_f32 v62, 0xbfb8aa3b, v46
  v_mul_f32 v63, 0xbfb8aa3b, v47
  v_mul_f32 v64, 0xbfb8aa3b, v48
  v_mul_f32 v65, 0xbfb8aa3b, v49
  v_mul_f32 v66, 0xbfb8aa3b, v50
  v_exp_f32 v60, v60
  v_exp_f32 v61, v61
  v_exp_f32 v62, v62
  v_exp_f32 v63, v63
  v_exp_f32 v64, v64
  v_exp_f32 v65, v65
  v_exp_f32 v66, v66
  v_add_f32 v60, 1.0, v60
  v_add_f32 v61, 1.0, v61
  v_add_f32 v62, 1.0, v62
  v_add_f32 v63, 1.0, v63
  v_add_f32 v64, 1.0, v64
  v_add_f32 v65, 1.0, v65
  v_add_f32 v66, 1.0, v66
  v_rcp_f32 v60, v60
  v_rcp_f32 v61, v61
  v_rcp_f32 v62, v62
  v_rcp_f32 v63, v63
  v_rcp_f32 v64, v64
  v_rcp_f32 v65, v65
  v_rcp_f32 v66, v66
  v_mul_f32 v60, v60, v44
  v_mul_f32 v61, v61, v45
  v_mul_f32 v62, v62, v46
  v_mul_f32 v63, v63, v47
  v_mul_f32 v64, v64, v48
  v_mul_f32 v65, v65, v49
  v_mul_f32 v66, v66, v50
  v_cvt_pk_bf16_f32 v60, v60, v60
  v_cvt_pk_bf16_f32 v61, v61, v61
  v_cvt_pk_bf16_f32 v62, v62, v62
  v_cvt_pk_bf16_f32 v63, v63, v63
  v_cvt_pk_bf16_f32 v64, v64, v64
  v_cvt_pk_bf16_f32 v65, v65, v65
  v_cvt_pk_bf16_f32 v66, v66, v66
  s_mov_b32 s94, 0x05040100
  s_mov_b32 s95, 0x07060302
  v_perm_b32 v44, v61, v60, s94
  v_perm_b32 v46, v63, v62, s94
  v_perm_b32 v48, v65, v64, s94
  v_and_b32 v50, 0xffff, v66
  v_perm_b32 v68, v20, v16, s94
  v_perm_b32 v69, v20, v16, s95
  v_dot2_f32_bf16 v52, v68, v44, 0
  v_dot2_f32_bf16 v53, v69, v44, 0
  v_perm_b32 v68, v21, v17, s94
  v_perm_b32 v69, v21, v17, s95
  v_dot2_f32_bf16 v54, v68, v44, 0
  v_dot2_f32_bf16 v55, v69, v44, 0
  v_perm_b32 v68, v22, v18, s94
  v_perm_b32 v69, v22, v18, s95
  v_dot2_f32_bf16 v56, v68, v44, 0
  v_dot2_f32_bf16 v57, v69, v44, 0
  v_perm_b32 v68, v23, v19, s94
  v_perm_b32 v69, v23, v19, s95
  v_dot2_f32_bf16 v58, v68, v44, 0
  v_dot2_f32_bf16 v59, v69, v44, 0
  v_perm_b32 v68, v28, v24, s94
  v_perm_b32 v69, v28, v24, s95
  v_dot2_f32_bf16 v52, v68, v46, v52
  v_dot2_f32_bf16 v53, v69, v46, v53
  v_perm_b32 v68, v29, v25, s94
  v_perm_b32 v69, v29, v25, s95
  v_dot2_f32_bf16 v54, v68, v46, v54
  v_dot2_f32_bf16 v55, v69, v46, v55
  v_perm_b32 v68, v30, v26, s94
  v_perm_b32 v69, v30, v26, s95
  v_dot2_f32_bf16 v56, v68, v46, v56
  v_dot2_f32_bf16 v57, v69, v46, v57
  v_perm_b32 v68, v31, v27, s94
  v_perm_b32 v69, v31, v27, s95
  v_dot2_f32_bf16 v58, v68, v46, v58
  v_dot2_f32_bf16 v59, v69, v46, v59
  v_perm_b32 v68, v36, v32, s94
  v_perm_b32 v69, v36, v32, s95
  v_dot2_f32_bf16 v52, v68, v48, v52
  v_dot2_f32_bf16 v53, v69, v48, v53
  v_perm_b32 v68, v37, v33, s94
  v_perm_b32 v69, v37, v33, s95
  v_dot2_f32_bf16 v54, v68, v48, v54
  v_dot2_f32_bf16 v55, v69, v48, v55
  v_perm_b32 v68, v38, v34, s94
  v_perm_b32 v69, v38, v34, s95
  v_dot2_f32_bf16 v56, v68, v48, v56
  v_dot2_f32_bf16 v57, v69, v48, v57
  v_perm_b32 v68, v39, v35, s94
  v_perm_b32 v69, v39, v35, s95
  v_dot2_f32_bf16 v58, v68, v48, v58
  v_dot2_f32_bf16 v59, v69, v48, v59
  v_perm_b32 v68, v40, v40, s94
  v_perm_b32 v69, v40, v40, s95
  v_dot2_f32_bf16 v52, v68, v50, v52
  v_dot2_f32_bf16 v53, v69, v50, v53
  v_perm_b32 v68, v41, v41, s94
  v_perm_b32 v69, v41, v41, s95
  v_dot2_f32_bf16 v54, v68, v50, v54
  v_dot2_f32_bf16 v55, v69, v50, v55
  v_perm_b32 v68, v42, v42, s94
  v_perm_b32 v69, v42, v42, s95
  v_dot2_f32_bf16 v56, v68, v50, v56
  v_dot2_f32_bf16 v57, v69, v50, v57
  v_perm_b32 v68, v43, v43, s94
  v_perm_b32 v69, v43, v43, s95
  v_dot2_f32_bf16 v58, v68, v50, v58
  v_dot2_f32_bf16 v59, v69, v50, v59
  v_add_f32_dpp v52, v52, v52 row_ror:4 row_mask:0xf bank_mask:0xf
  v_add_f32_dpp v53, v53, v53 row_ror:4 row_mask:0xf bank_mask:0xf
  v_add_f32_dpp v54, v54, v54 row_ror:4 row_mask:0xf bank_mask:0xf
  v_add_f32_dpp v55, v55, v55 row_ror:4 row_mask:0xf bank_mask:0xf
  v_add_f32_dpp v56, v56, v56 row_ror:4 row_mask:0xf bank_mask:0xf
  v_add_f32_dpp v57, v57, v57 row_ror:4 row_mask:0xf bank_mask:0xf
  v_add_f32_dpp v58, v58, v58 row_ror:4 row_mask:0xf bank_mask:0xf
  v_add_f32_dpp v59, v59, v59 row_ror:4 row_mask:0xf bank_mask:0xf
  v_add_f32_dpp v52, v52, v52 row_ror:8 row_mask:0xf bank_mask:0xf
  v_add_f32_dpp v53, v53, v53 row_ror:8 row_mask:0xf bank_mask:0xf
  v_add_f32_dpp v54, v54, v54 row_ror:8 row_mask:0xf bank_mask:0xf
  v_add_f32_dpp v55, v55, v55 row_ror:8 row_mask:0xf bank_mask:0xf
  v_add_f32_dpp v56, v56, v56 row_ror:8 row_mask:0xf bank_mask:0xf
  v_add_f32_dpp v57, v57, v57 row_ror:8 row_mask:0xf bank_mask:0xf
  v_add_f32_dpp v58, v58, v58 row_ror:8 row_mask:0xf bank_mask:0xf
  v_add_f32_dpp v59, v59, v59 row_ror:8 row_mask:0xf bank_mask:0xf
  v_lshlrev_b32 v60, 7, v4
  v_and_b32 v61, 3, v1
  v_lshlrev_b32 v61, 5, v61
  v_add_u32 v60, v60, v61
  s_lshl_b32 s82, s52, 9
  s_add_u32 s82, s82, 161280
  v_add_u32 v60, s82, v60
  ds_write_b128 v60, v[52:55]
  ds_write_b128 v60, v[56:59] offset:16
  s_waitcnt lgkmcnt(0)
  s_barrier
  s_cmp_eq_u32 s52, 0
  s_cbranch_scc0 L_nogemv
  v_and_b32 v60, 31, v1
  v_lshlrev_b32 v60, 2, v60
  v_lshrrev_b32 v61, 5, v1
  v_lshlrev_b32 v61, 10, v61
  v_add_u32 v60, v60, v61
  v_add_u32 v60, 161280, v60
  ds_read_b32 v52, v60 offset:0
  ds_read_b32 v53, v60 offset:128
  ds_read_b32 v54, v60 offset:256
  ds_read_b32 v55, v60 offset:384
  ds_read_b32 v56, v60 offset:512
  ds_read_b32 v57, v60 offset:640
  ds_read_b32 v58, v60 offset:768
  ds_read_b32 v59, v60 offset:896
  s_waitcnt lgkmcnt(0)
  v_add_f32 v52, v52, v53
  v_add_f32 v52, v52, v54
  v_add_f32 v52, v52, v55
  v_add_f32 v52, v52, v56
  v_add_f32 v52, v52, v57
  v_add_f32 v52, v52, v58
  v_add_f32 v52, v52, v59
  v_mov_b32 v61, v52
  s_nop 1
  v_permlane32_swap_b32 v52, v61
  v_add_f32 v52, v52, v61
  v_cvt_pk_bf16_f32 v60, v52, v52
  v_lshlrev_b32 v60, 16, v60
  s_sub_u32 s82, s63, 14
  s_cmp_lt_u32 s82, 14
  s_cselect_b32 s83, 1, 0
  s_sub_u32 s82, s63, 56
  s_cmp_lt_u32 s82, 14
  s_cselect_b32 s83, 1, s83
  s_cmp_eq_u32 s83, 1
  s_cbranch_scc0 L_gemv_noplus
  v_add_f32 v60, 1.0, v60
  v_cvt_pk_bf16_f32 v60, v60, v60
  v_lshlrev_b32 v60, 16, v60
  s_nop 1
L_gemv_noplus:
  v_mov_b32_dpp v61, v60 quad_perm:[1,0,3,2] row_mask:0xf bank_mask:0xf
  v_cvt_pk_bf16_f32 v62, v60, v61
  v_mov_b32 v63, s55
  v_and_b32 v60, 31, v1
  v_lshlrev_b32 v60, 2, v60
  s_lshl_b32 s82, s63, 7
  s_add_u32 s82, s82, 32768
  s_mov_b32 exec_lo, 0x55555555
  s_mov_b32 exec_hi, 0
  buffer_store_dwordx2 v[62:63], v60, s[48:51], s82 offen sc1
  s_mov_b64 exec, -1
L_nogemv:
  s_waitcnt vmcnt(0)
  v_lshrrev_b32 v6, 1, v3
  v_xor_b32 v6, v6, v4
  v_xor_b32 v7, 4, v6
  v_lshlrev_b32 v6, 4, v6
  v_lshlrev_b32 v7, 4, v7
  v_lshlrev_b32 v9, 7, v3
  v_add_u32 v6, v6, v9
  v_add_u32 v7, v7, v9
  s_lshl_b32 s82, s52, 11
  s_add_u32 s82, s82, 100352
  v_add_u32 v6, s82, v6
  v_add_u32 v7, s82, v7
  ds_read_b128 v[20:23], v6 offset:0
  ds_read_b128 v[28:31], v7 offset:0
  ds_read_b128 v[36:39], v6 offset:8192
  ds_read_b128 v[44:47], v7 offset:8192
  ds_read_b128 v[52:55], v6 offset:16384
  s_waitcnt lgkmcnt(4)
  v_lshlrev_b32 v16, 16, v20
  v_lshlrev_b32 v17, 16, v21
  v_lshlrev_b32 v18, 16, v22
  v_lshlrev_b32 v19, 16, v23
  v_and_b32 v20, s100, v20
  v_and_b32 v21, s100, v21
  v_and_b32 v22, s100, v22
  v_and_b32 v23, s100, v23
  s_add_u32 s81, s75, 896
  s_add_u32 m0, s76, 0
  s_mov_b32 exec_hi, 0x00ffffff
  buffer_load_dwordx4 v12, s[12:15], s81 offen lds
  s_mov_b32 exec_hi, -1
  v_pk_add_f32 v[248:249], v[16:17], v[18:19]
  v_pk_mul_f32 v[250:251], v[16:17], v[16:17]
  v_pk_fma_f32 v[250:251], v[18:19], v[18:19], v[250:251]
  v_pk_add_f32 v[248:249], v[248:249], v[20:21]
  v_pk_fma_f32 v[250:251], v[20:21], v[20:21], v[250:251]
  v_pk_add_f32 v[248:249], v[248:249], v[22:23]
  v_pk_fma_f32 v[250:251], v[22:23], v[22:23], v[250:251]
  ds_read_b128 v[60:63], v7 offset:16384
  s_waitcnt lgkmcnt(4)
  v_lshlrev_b32 v24, 16, v28
  v_lshlrev_b32 v25, 16, v29
  v_lshlrev_b32 v26, 16, v30
  v_lshlrev_b32 v27, 16, v31
  v_and_b32 v28, s100, v28
  v_and_b32 v29, s100, v29
  v_and_b32 v30, s100, v30
  v_and_b32 v31, s100, v31
  s_add_u32 s81, s75, 22400
  s_add_u32 m0, s76, 896
  s_mov_b32 exec_hi, 0x00ffffff
  buffer_load_dwordx4 v12, s[12:15], s81 offen lds
  s_mov_b32 exec_hi, -1
  v_pk_add_f32 v[248:249], v[248:249], v[24:25]
  v_pk_fma_f32 v[250:251], v[24:25], v[24:25], v[250:251]
  v_pk_add_f32 v[248:249], v[248:249], v[26:27]
  v_pk_fma_f32 v[250:251], v[26:27], v[26:27], v[250:251]
  v_pk_add_f32 v[248:249], v[248:249], v[28:29]
  v_pk_fma_f32 v[250:251], v[28:29], v[28:29], v[250:251]
  v_pk_add_f32 v[248:249], v[248:249], v[30:31]
  v_pk_fma_f32 v[250:251], v[30:31], v[30:31], v[250:251]
  ds_read_b128 v[68:71], v6 offset:24576
  s_waitcnt lgkmcnt(4)
  v_lshlrev_b32 v32, 16, v36
  v_lshlrev_b32 v33, 16, v37
  v_lshlrev_b32 v34, 16, v38
  v_lshlrev_b32 v35, 16, v39
  v_and_b32 v36, s100, v36
  v_and_b32 v37, s100, v37
  v_and_b32 v38, s100, v38
  v_and_b32 v39, s100, v39
  s_add_u32 s81, s75, 43904
  s_add_u32 m0, s76, 1792
  s_mov_b32 exec_hi, 0x00ffffff
  buffer_load_dwordx4 v12, s[12:15], s81 offen lds
  s_mov_b32 exec_hi, -1
  v_pk_add_f32 v[248:249], v[248:249], v[32:33]
  v_pk_fma_f32 v[250:251], v[32:33], v[32:33], v[250:251]
  v_pk_add_f32 v[248:249], v[248:249], v[34:35]
  v_pk_fma_f32 v[250:251], v[34:35], v[34:35], v[250:251]
  v_pk_add_f32 v[248:249], v[248:249], v[36:37]
  v_pk_fma_f32 v[250:251], v[36:37], v[36:37], v[250:251]
  v_pk_add_f32 v[248:249], v[248:249], v[38:39]
  v_pk_fma_f32 v[250:251], v[38:39], v[38:39], v[250:251]
  ds_read_b128 v[76:79], v7 offset:24576
  s_waitcnt lgkmcnt(4)
  v_lshlrev_b32 v40, 16, v44
  v_lshlrev_b32 v41, 16, v45
  v_lshlrev_b32 v42, 16, v46
  v_lshlrev_b32 v43, 16, v47
  v_and_b32 v44, s100, v44
  v_and_b32 v45, s100, v45
  v_and_b32 v46, s100, v46
  v_and_b32 v47, s100, v47
  s_add_u32 s81, s75, 65408
  s_add_u32 m0, s76, 2688
  s_mov_b32 exec_hi, 0x00ffffff
  buffer_load_dwordx4 v12, s[12:15], s81 offen lds
  s_mov_b32 exec_hi, -1
  v_pk_add_f32 v[248:249], v[248:249], v[40:41]
  v_pk_fma_f32 v[250:251], v[40:41], v[40:41], v[250:251]
  v_pk_add_f32 v[248:249], v[248:249], v[42:43]
  v_pk_fma_f32 v[250:251], v[42:43], v[42:43], v[250:251]
  v_pk_add_f32 v[248:249], v[248:249], v[44:45]
  v_pk_fma_f32 v[250:251], v[44:45], v[44:45], v[250:251]
  v_pk_add_f32 v[248:249], v[248:249], v[46:47]
  v_pk_fma_f32 v[250:251], v[46:47], v[46:47], v[250:251]
  ds_read_b128 v[84:87], v6 offset:32768
  s_waitcnt lgkmcnt(4)
  v_lshlrev_b32 v48, 16, v52
  v_lshlrev_b32 v49, 16, v53
  v_lshlrev_b32 v50, 16, v54
  v_lshlrev_b32 v51, 16, v55
  v_and_b32 v52, s100, v52
  v_and_b32 v53, s100, v53
  v_and_b32 v54, s100, v54
  v_and_b32 v55, s100, v55
  s_add_u32 s81, s75, 86912
  s_add_u32 m0, s76, 3584
  s_mov_b32 exec_hi, 0x00ffffff
  buffer_load_dwordx4 v12, s[12:15], s81 offen lds
  s_mov_b32 exec_hi, -1
  v_pk_add_f32 v[248:249], v[248:249], v[48:49]
  v_pk_fma_f32 v[250:251], v[48:49], v[48:49], v[250:251]
  v_pk_add_f32 v[248:249], v[248:249], v[50:51]
  v_pk_fma_f32 v[250:251], v[50:51], v[50:51], v[250:251]
  v_pk_add_f32 v[248:249], v[248:249], v[52:53]
  v_pk_fma_f32 v[250:251], v[52:53], v[52:53], v[250:251]
  v_pk_add_f32 v[248:249], v[248:249], v[54:55]
  v_pk_fma_f32 v[250:251], v[54:55], v[54:55], v[250:251]
  ds_read_b128 v[92:95], v7 offset:32768
  s_waitcnt lgkmcnt(4)
  v_lshlrev_b32 v56, 16, v60
  v_lshlrev_b32 v57, 16, v61
  v_lshlrev_b32 v58, 16, v62
  v_lshlrev_b32 v59, 16, v63
  v_and_b32 v60, s100, v60
  v_and_b32 v61, s100, v61
  v_and_b32 v62, s100, v62
  v_and_b32 v63, s100, v63
  s_add_u32 s81, s75, 108416
  s_add_u32 m0, s76, 4480
  s_mov_b32 exec_hi, 0x00ffffff
  buffer_load_dwordx4 v12, s[12:15], s81 offen lds
  s_mov_b32 exec_hi, -1
  v_pk_add_f32 v[248:249], v[248:249], v[56:57]
  v_pk_fma_f32 v[250:251], v[56:57], v[56:57], v[250:251]
  v_pk_add_f32 v[248:249], v[248:249], v[58:59]
  v_pk_fma_f32 v[250:251], v[58:59], v[58:59], v[250:251]
  v_pk_add_f32 v[248:249], v[248:249], v[60:61]
  v_pk_fma_f32 v[250:251], v[60:61], v[60:61], v[250:251]
  v_pk_add_f32 v[248:249], v[248:249], v[62:63]
  v_pk_fma_f32 v[250:251], v[62:63], v[62:63], v[250:251]
  ds_read_b128 v[100:103], v6 offset:40960
  s_waitcnt lgkmcnt(4)
  v_lshlrev_b32 v64, 16, v68
  v_lshlrev_b32 v65, 16, v69
  v_lshlrev_b32 v66, 16, v70
  v_lshlrev_b32 v67, 16, v71
  v_and_b32 v68, s100, v68
  v_and_b32 v69, s100, v69
  v_and_b32 v70, s100, v70
  v_and_b32 v71, s100, v71
  s_add_u32 s81, s75, 129920
  s_add_u32 m0, s76, 5376
  s_mov_b32 exec_hi, 0x00ffffff
  buffer_load_dwordx4 v12, s[12:15], s81 offen lds
  s_mov_b32 exec_hi, -1
  v_pk_add_f32 v[248:249], v[248:249], v[64:65]
  v_pk_fma_f32 v[250:251], v[64:65], v[64:65], v[250:251]
  v_pk_add_f32 v[248:249], v[248:249], v[66:67]
  v_pk_fma_f32 v[250:251], v[66:67], v[66:67], v[250:251]
  v_pk_add_f32 v[248:249], v[248:249], v[68:69]
  v_pk_fma_f32 v[250:251], v[68:69], v[68:69], v[250:251]
  v_pk_add_f32 v[248:249], v[248:249], v[70:71]
  v_pk_fma_f32 v[250:251], v[70:71], v[70:71], v[250:251]
  ds_read_b128 v[108:111], v7 offset:40960
  s_waitcnt lgkmcnt(4)
  v_lshlrev_b32 v72, 16, v76
  v_lshlrev_b32 v73, 16, v77
  v_lshlrev_b32 v74, 16, v78
  v_lshlrev_b32 v75, 16, v79
  v_and_b32 v76, s100, v76
  v_and_b32 v77, s100, v77
  v_and_b32 v78, s100, v78
  v_and_b32 v79, s100, v79
  s_add_u32 s81, s75, 151424
  s_add_u32 m0, s76, 6272
  s_mov_b32 exec_hi, 0x00ffffff
  buffer_load_dwordx4 v12, s[12:15], s81 offen lds
  s_mov_b32 exec_hi, -1
  v_pk_add_f32 v[248:249], v[248:249], v[72:73]
  v_pk_fma_f32 v[250:251], v[72:73], v[72:73], v[250:251]
  v_pk_add_f32 v[248:249], v[248:249], v[74:75]
  v_pk_fma_f32 v[250:251], v[74:75], v[74:75], v[250:251]
  v_pk_add_f32 v[248:249], v[248:249], v[76:77]
  v_pk_fma_f32 v[250:251], v[76:77], v[76:77], v[250:251]
  v_pk_add_f32 v[248:249], v[248:249], v[78:79]
  v_pk_fma_f32 v[250:251], v[78:79], v[78:79], v[250:251]
  ds_read_b128 v[116:119], v6 offset:49152
  s_waitcnt lgkmcnt(4)
  v_lshlrev_b32 v80, 16, v84
  v_lshlrev_b32 v81, 16, v85
  v_lshlrev_b32 v82, 16, v86
  v_lshlrev_b32 v83, 16, v87
  v_and_b32 v84, s100, v84
  v_and_b32 v85, s100, v85
  v_and_b32 v86, s100, v86
  v_and_b32 v87, s100, v87
  s_add_u32 s81, s75, 172928
  s_add_u32 m0, s76, 7168
  s_mov_b32 exec_hi, 0x00ffffff
  buffer_load_dwordx4 v12, s[12:15], s81 offen lds
  s_mov_b32 exec_hi, -1
  v_pk_add_f32 v[248:249], v[248:249], v[80:81]
  v_pk_fma_f32 v[250:251], v[80:81], v[80:81], v[250:251]
  v_pk_add_f32 v[248:249], v[248:249], v[82:83]
  v_pk_fma_f32 v[250:251], v[82:83], v[82:83], v[250:251]
  v_pk_add_f32 v[248:249], v[248:249], v[84:85]
  v_pk_fma_f32 v[250:251], v[84:85], v[84:85], v[250:251]
  v_pk_add_f32 v[248:249], v[248:249], v[86:87]
  v_pk_fma_f32 v[250:251], v[86:87], v[86:87], v[250:251]
  ds_read_b128 v[124:127], v7 offset:49152
  s_waitcnt lgkmcnt(4)
  v_lshlrev_b32 v88, 16, v92
  v_lshlrev_b32 v89, 16, v93
  v_lshlrev_b32 v90, 16, v94
  v_lshlrev_b32 v91, 16, v95
  v_and_b32 v92, s100, v92
  v_and_b32 v93, s100, v93
  v_and_b32 v94, s100, v94
  v_and_b32 v95, s100, v95
  s_add_u32 s81, s75, 194432
  s_add_u32 m0, s76, 8064
  s_mov_b32 exec_hi, 0x00ffffff
  buffer_load_dwordx4 v12, s[12:15], s81 offen lds
  s_mov_b32 exec_hi, -1
  v_pk_add_f32 v[248:249], v[248:249], v[88:89]
  v_pk_fma_f32 v[250:251], v[88:89], v[88:89], v[250:251]
  v_pk_add_f32 v[248:249], v[248:249], v[90:91]
  v_pk_fma_f32 v[250:251], v[90:91], v[90:91], v[250:251]
  v_pk_add_f32 v[248:249], v[248:249], v[92:93]
  v_pk_fma_f32 v[250:251], v[92:93], v[92:93], v[250:251]
  v_pk_add_f32 v[248:249], v[248:249], v[94:95]
  v_pk_fma_f32 v[250:251], v[94:95], v[94:95], v[250:251]
  s_waitcnt lgkmcnt(3)
  v_lshlrev_b32 v96, 16, v100
  v_lshlrev_b32 v97, 16, v101
  v_lshlrev_b32 v98, 16, v102
  v_lshlrev_b32 v99, 16, v103
  v_and_b32 v100, s100, v100
  v_and_b32 v101, s100, v101
  v_and_b32 v102, s100, v102
  v_and_b32 v103, s100, v103
  s_add_u32 s81, s75, 215936
  s_add_u32 m0, s76, 8960
  s_mov_b32 exec_hi, 0x00ffffff
  buffer_load_dwordx4 v12, s[12:15], s81 offen lds
  s_mov_b32 exec_hi, -1
  v_pk_add_f32 v[248:249], v[248:249], v[96:97]
  v_pk_fma_f32 v[250:251], v[96:97], v[96:97], v[250:251]
  v_pk_add_f32 v[248:249], v[248:249], v[98:99]
  v_pk_fma_f32 v[250:251], v[98:99], v[98:99], v[250:251]
  v_pk_add_f32 v[248:249], v[248:249], v[100:101]
  v_pk_fma_f32 v[250:251], v[100:101], v[100:101], v[250:251]
  v_pk_add_f32 v[248:249], v[248:249], v[102:103]
  v_pk_fma_f32 v[250:251], v[102:103], v[102:103], v[250:251]
  s_waitcnt lgkmcnt(2)
  v_lshlrev_b32 v104, 16, v108
  v_lshlrev_b32 v105, 16, v109
  v_lshlrev_b32 v106, 16, v110
  v_lshlrev_b32 v107, 16, v111
  v_and_b32 v108, s100, v108
  v_and_b32 v109, s100, v109
  v_and_b32 v110, s100, v110
  v_and_b32 v111, s100, v111
  s_add_u32 s81, s75, 237440
  s_add_u32 m0, s76, 9856
  s_mov_b32 exec_hi, 0x00ffffff
  buffer_load_dwordx4 v12, s[12:15], s81 offen lds
  s_mov_b32 exec_hi, -1
  v_pk_add_f32 v[248:249], v[248:249], v[104:105]
  v_pk_fma_f32 v[250:251], v[104:105], v[104:105], v[250:251]
  v_pk_add_f32 v[248:249], v[248:249], v[106:107]
  v_pk_fma_f32 v[250:251], v[106:107], v[106:107], v[250:251]
  v_pk_add_f32 v[248:249], v[248:249], v[108:109]
  v_pk_fma_f32 v[250:251], v[108:109], v[108:109], v[250:251]
  v_pk_add_f32 v[248:249], v[248:249], v[110:111]
  v_pk_fma_f32 v[250:251], v[110:111], v[110:111], v[250:251]
  s_waitcnt lgkmcnt(1)
  v_lshlrev_b32 v112, 16, v116
  v_lshlrev_b32 v113, 16, v117
  v_lshlrev_b32 v114, 16, v118
  v_lshlrev_b32 v115, 16, v119
  v_and_b32 v116, s100, v116
  v_and_b32 v117, s100, v117
  v_and_b32 v118, s100, v118
  v_and_b32 v119, s100, v119
  s_add_u32 s81, s75, 258944
  s_add_u32 m0, s76, 10752
  s_mov_b32 exec_hi, 0x00ffffff
  buffer_load_dwordx4 v12, s[12:15], s81 offen lds
  s_mov_b32 exec_hi, -1
  v_pk_add_f32 v[248:249], v[248:249], v[112:113]
  v_pk_fma_f32 v[250:251], v[112:113], v[112:113], v[250:251]
  v_pk_add_f32 v[248:249], v[248:249], v[114:115]
  v_pk_fma_f32 v[250:251], v[114:115], v[114:115], v[250:251]
  v_pk_add_f32 v[248:249], v[248:249], v[116:117]
  v_pk_fma_f32 v[250:251], v[116:117], v[116:117], v[250:251]
  v_pk_add_f32 v[248:249], v[248:249], v[118:119]
  v_pk_fma_f32 v[250:251], v[118:119], v[118:119], v[250:251]
  s_waitcnt lgkmcnt(0)
  v_lshlrev_b32 v120, 16, v124
  v_lshlrev_b32 v121, 16, v125
  v_lshlrev_b32 v122, 16, v126
  v_lshlrev_b32 v123, 16, v127
  v_and_b32 v124, s100, v124
  v_and_b32 v125, s100, v125
  v_and_b32 v126, s100, v126
  v_and_b32 v127, s100, v127
  s_add_u32 s81, s75, 280448
  s_add_u32 m0, s76, 11648
  s_mov_b32 exec_hi, 0x00ffffff
  buffer_load_dwordx4 v12, s[12:15], s81 offen lds
  s_mov_b32 exec_hi, -1
  v_pk_add_f32 v[248:249], v[248:249], v[120:121]
  v_pk_fma_f32 v[250:251], v[120:121], v[120:121], v[250:251]
  v_pk_add_f32 v[248:249], v[248:249], v[122:123]
  v_pk_fma_f32 v[250:251], v[122:123], v[122:123], v[250:251]
  v_pk_add_f32 v[248:249], v[248:249], v[124:125]
  v_pk_fma_f32 v[250:251], v[124:125], v[124:125], v[250:251]
  v_pk_add_f32 v[248:249], v[248:249], v[126:127]
  v_pk_fma_f32 v[250:251], v[126:127], v[126:127], v[250:251]
  v_add_f32 v248, v248, v249
  v_add_f32 v250, v250, v251
  v_mov_b32 v6, v248
  v_mov_b32 v7, v250
  s_nop 0
  v_permlane32_swap_b32 v248, v6
  v_permlane32_swap_b32 v250, v7
  v_add_f32 v248, v248, v6
  v_add_f32 v250, v250, v7
  v_mov_b32 v6, v248
  v_mov_b32 v7, v250
  s_nop 0
  v_permlane16_swap_b32 v248, v6
  v_permlane16_swap_b32 v250, v7
  v_add_f32 v248, v248, v6
  v_add_f32 v250, v250, v7
  v_mul_f32 v248, 0x3b124925, v248
  v_mul_f32 v250, 0x3b124925, v250
  v_fma_f32 v250, -v248, v248, v250
  v_max_f32 v250, 0, v250
  v_add_f32 v250, 0x3727c5ac, v250
  v_rsq_f32 v252, v250
  s_nop 0
  v_mul_f32_e64 v253, -v248, v252
  v_pk_fma_f32 v[16:17], v[16:17], v[252:253], v[252:253] op_sel:[0,0,1] op_sel_hi:[1,0,1]
  v_pk_fma_f32 v[18:19], v[18:19], v[252:253], v[252:253] op_sel:[0,0,1] op_sel_hi:[1,0,1]
  v_pk_fma_f32 v[20:21], v[20:21], v[252:253], v[252:253] op_sel:[0,0,1] op_sel_hi:[1,0,1]
  v_pk_fma_f32 v[22:23], v[22:23], v[252:253], v[252:253] op_sel:[0,0,1] op_sel_hi:[1,0,1]
  v_pk_fma_f32 v[24:25], v[24:25], v[252:253], v[252:253] op_sel:[0,0,1] op_sel_hi:[1,0,1]
  v_pk_fma_f32 v[26:27], v[26:27], v[252:253], v[252:253] op_sel:[0,0,1] op_sel_hi:[1,0,1]
  v_pk_fma_f32 v[28:29], v[28:29], v[252:253], v[252:253] op_sel:[0,0,1] op_sel_hi:[1,0,1]
  v_pk_fma_f32 v[30:31], v[30:31], v[252:253], v[252:253] op_sel:[0,0,1] op_sel_hi:[1,0,1]
  v_pk_fma_f32 v[32:33], v[32:33], v[252:253], v[252:253] op_sel:[0,0,1] op_sel_hi:[1,0,1]
  v_pk_fma_f32 v[34:35], v[34:35], v[252:253], v[252:253] op_sel:[0,0,1] op_sel_hi:[1,0,1]
  v_pk_fma_f32 v[36:37], v[36:37], v[252:253], v[252:253] op_sel:[0,0,1] op_sel_hi:[1,0,1]
  v_pk_fma_f32 v[38:39], v[38:39], v[252:253], v[252:253] op_sel:[0,0,1] op_sel_hi:[1,0,1]
  v_pk_fma_f32 v[40:41], v[40:41], v[252:253], v[252:253] op_sel:[0,0,1] op_sel_hi:[1,0,1]
  v_pk_fma_f32 v[42:43], v[42:43], v[252:253], v[252:253] op_sel:[0,0,1] op_sel_hi:[1,0,1]
  v_pk_fma_f32 v[44:45], v[44:45], v[252:253], v[252:253] op_sel:[0,0,1] op_sel_hi:[1,0,1]
  v_pk_fma_f32 v[46:47], v[46:47], v[252:253], v[252:253] op_sel:[0,0,1] op_sel_hi:[1,0,1]
  v_pk_fma_f32 v[48:49], v[48:49], v[252:253], v[252:253] op_sel:[0,0,1] op_sel_hi:[1,0,1]
  v_pk_fma_f32 v[50:51], v[50:51], v[252:253], v[252:253] op_sel:[0,0,1] op_sel_hi:[1,0,1]
  v_pk_fma_f32 v[52:53], v[52:53], v[252:253], v[252:253] op_sel:[0,0,1] op_sel_hi:[1,0,1]
  v_pk_fma_f32 v[54:55], v[54:55], v[252:253], v[252:253] op_sel:[0,0,1] op_sel_hi:[1,0,1]
  v_pk_fma_f32 v[56:57], v[56:57], v[252:253], v[252:253] op_sel:[0,0,1] op_sel_hi:[1,0,1]
  v_pk_fma_f32 v[58:59], v[58:59], v[252:253], v[252:253] op_sel:[0,0,1] op_sel_hi:[1,0,1]
  v_pk_fma_f32 v[60:61], v[60:61], v[252:253], v[252:253] op_sel:[0,0,1] op_sel_hi:[1,0,1]
  v_pk_fma_f32 v[62:63], v[62:63], v[252:253], v[252:253] op_sel:[0,0,1] op_sel_hi:[1,0,1]
  v_pk_fma_f32 v[64:65], v[64:65], v[252:253], v[252:253] op_sel:[0,0,1] op_sel_hi:[1,0,1]
  v_pk_fma_f32 v[66:67], v[66:67], v[252:253], v[252:253] op_sel:[0,0,1] op_sel_hi:[1,0,1]
  v_pk_fma_f32 v[68:69], v[68:69], v[252:253], v[252:253] op_sel:[0,0,1] op_sel_hi:[1,0,1]
  v_pk_fma_f32 v[70:71], v[70:71], v[252:253], v[252:253] op_sel:[0,0,1] op_sel_hi:[1,0,1]
  v_pk_fma_f32 v[72:73], v[72:73], v[252:253], v[252:253] op_sel:[0,0,1] op_sel_hi:[1,0,1]
  v_pk_fma_f32 v[74:75], v[74:75], v[252:253], v[252:253] op_sel:[0,0,1] op_sel_hi:[1,0,1]
  v_pk_fma_f32 v[76:77], v[76:77], v[252:253], v[252:253] op_sel:[0,0,1] op_sel_hi:[1,0,1]
  v_pk_fma_f32 v[78:79], v[78:79], v[252:253], v[252:253] op_sel:[0,0,1] op_sel_hi:[1,0,1]
  v_pk_fma_f32 v[80:81], v[80:81], v[252:253], v[252:253] op_sel:[0,0,1] op_sel_hi:[1,0,1]
  v_pk_fma_f32 v[82:83], v[82:83], v[252:253], v[252:253] op_sel:[0,0,1] op_sel_hi:[1,0,1]
  v_pk_fma_f32 v[84:85], v[84:85], v[252:253], v[252:253] op_sel:[0,0,1] op_sel_hi:[1,0,1]
  v_pk_fma_f32 v[86:87], v[86:87], v[252:253], v[252:253] op_sel:[0,0,1] op_sel_hi:[1,0,1]
  v_pk_fma_f32 v[88:89], v[88:89], v[252:253], v[252:253] op_sel:[0,0,1] op_sel_hi:[1,0,1]
  v_pk_fma_f32 v[90:91], v[90:91], v[252:253], v[252:253] op_sel:[0,0,1] op_sel_hi:[1,0,1]
  v_pk_fma_f32 v[92:93], v[92:93], v[252:253], v[252:253] op_sel:[0,0,1] op_sel_hi:[1,0,1]
  v_pk_fma_f32 v[94:95], v[94:95], v[252:253], v[252:253] op_sel:[0,0,1] op_sel_hi:[1,0,1]
  v_pk_fma_f32 v[96:97], v[96:97], v[252:253], v[252:253] op_sel:[0,0,1] op_sel_hi:[1,0,1]
  v_pk_fma_f32 v[98:99], v[98:99], v[252:253], v[252:253] op_sel:[0,0,1] op_sel_hi:[1,0,1]
  v_pk_fma_f32 v[100:101], v[100:101], v[252:253], v[252:253] op_sel:[0,0,1] op_sel_hi:[1,0,1]
  v_pk_fma_f32 v[102:103], v[102:103], v[252:253], v[252:253] op_sel:[0,0,1] op_sel_hi:[1,0,1]
  v_pk_fma_f32 v[104:105], v[104:105], v[252:253], v[252:253] op_sel:[0,0,1] op_sel_hi:[1,0,1]
  v_pk_fma_f32 v[106:107], v[106:107], v[252:253], v[252:253] op_sel:[0,0,1] op_sel_hi:[1,0,1]
  v_pk_fma_f32 v[108:109], v[108:109], v[252:253], v[252:253] op_sel:[0,0,1] op_sel_hi:[1,0,1]
  v_pk_fma_f32 v[110:111], v[110:111], v[252:253], v[252:253] op_sel:[0,0,1] op_sel_hi:[1,0,1]
  v_pk_fma_f32 v[112:113], v[112:113], v[252:253], v[252:253] op_sel:[0,0,1] op_sel_hi:[1,0,1]
  v_pk_fma_f32 v[114:115], v[114:115], v[252:253], v[252:253] op_sel:[0,0,1] op_sel_hi:[1,0,1]
  v_pk_fma_f32 v[116:117], v[116:117], v[252:253], v[252:253] op_sel:[0,0,1] op_sel_hi:[1,0,1]
  v_pk_fma_f32 v[118:119], v[118:119], v[252:253], v[252:253] op_sel:[0,0,1] op_sel_hi:[1,0,1]
  v_pk_fma_f32 v[120:121], v[120:121], v[252:253], v[252:253] op_sel:[0,0,1] op_sel_hi:[1,0,1]
  v_pk_fma_f32 v[122:123], v[122:123], v[252:253], v[252:253] op_sel:[0,0,1] op_sel_hi:[1,0,1]
  v_pk_fma_f32 v[124:125], v[124:125], v[252:253], v[252:253] op_sel:[0,0,1] op_sel_hi:[1,0,1]
  v_pk_fma_f32 v[126:127], v[126:127], v[252:253], v[252:253] op_sel:[0,0,1] op_sel_hi:[1,0,1]
  s_waitcnt vmcnt(14)
  s_lshl_b32 s86, s2, 2
  s_add_u32 s86, s86, s52
  s_add_u32 s87, s2, 516
  s_cmp_eq_u32 s52, 1
  s_cselect_b32 s87, s87, 9999
  s_cmp_lt_u32 s2, 172
  s_cselect_b32 s86, s86, s87
  s_cmp_lt_u32 s86, 744
  s_cbranch_scc0 L_pp_done
  s_mul_i32 s87, s52, 4096
  s_add_u32 s87, s87, 83968
  v_lshrrev_b32 v10, 2, v3
  v_and_b32 v11, 3, v3
  s_cmp_lt_u32 s86, 392
  s_nop 0
  s_cbranch_scc0 L_pp_not_win_f
  s_mul_hi_u32 s82, s86, 153391690
  s_mul_i32 s83, s82, 28
  s_sub_u32 s83, s86, s83
  v_lshlrev_b32 v14, 3, v4
  v_add_u32 v14, v14, v10
  v_lshlrev_b32 v14, 7, v14
  v_lshlrev_b32 v11, 3, v11
  v_add_u32 v14, v14, v11
  v_add_u32 v14, s87, v14
  ds_read_b64_tr_b16 v[128:129], v14 offset:0
  ds_read_b64_tr_b16 v[130:131], v14 offset:512
  ds_read_b64_tr_b16 v[132:133], v14 offset:32
  ds_read_b64_tr_b16 v[134:135], v14 offset:544
  ds_read_b64_tr_b16 v[136:137], v14 offset:64
  ds_read_b64_tr_b16 v[138:139], v14 offset:576
  ds_read_b64_tr_b16 v[140:141], v14 offset:96
  ds_read_b64_tr_b16 v[142:143], v14 offset:608
  s_lshl_b32 s84, s83, 2
  s_add_u32 s84, s84, 0
  s_cmp_ge_u32 s84, 56
  s_cselect_b32 s85, 1, 0
  s_mul_i32 s88, s85, 56
  s_sub_u32 s84, s84, s88
  s_mul_i32 s88, s84, 37
  s_lshr_b32 s88, s88, 8
  s_mul_i32 s89, s88, 7
  s_sub_u32 s84, s84, s89
  s_lshl_b32 s88, s88, 1
  s_add_u32 s88, s88, s85
  s_lshl_b32 s88, s88, 3
  s_add_u32 s88, s88, s84
  s_mul_i32 s88, s88, 14
  s_add_u32 s88, s88, s82
  s_lshl_b32 s88, s88, 10
  s_add_u32 s88, s88, 2097152
  s_waitcnt lgkmcnt(0)
  buffer_store_dwordx4 v[128:131], v2, s[48:51], s88 offen sc1
  s_lshl_b32 s84, s83, 2
  s_add_u32 s84, s84, 1
  s_cmp_ge_u32 s84, 56
  s_cselect_b32 s85, 1, 0
  s_mul_i32 s88, s85, 56
  s_sub_u32 s84, s84, s88
  s_mul_i32 s88, s84, 37
  s_lshr_b32 s88, s88, 8
  s_mul_i32 s89, s88, 7
  s_sub_u32 s84, s84, s89
  s_lshl_b32 s88, s88, 1
  s_add_u32 s88, s88, s85
  s_lshl_b32 s88, s88, 3
  s_add_u32 s88, s88, s84
  s_mul_i32 s88, s88, 14
  s_add_u32 s88, s88, s82
  s_lshl_b32 s88, s88, 10
  s_add_u32 s88, s88, 2097152
  buffer_store_dwordx4 v[132:135], v2, s[48:51], s88 offen sc1
  s_lshl_b32 s84, s83, 2
  s_add_u32 s84, s84, 2
  s_cmp_ge_u32 s84, 56
  s_cselect_b32 s85, 1, 0
  s_mul_i32 s88, s85, 56
  s_sub_u32 s84, s84, s88
  s_mul_i32 s88, s84, 37
  s_lshr_b32 s88, s88, 8
  s_mul_i32 s89, s88, 7
  s_sub_u32 s84, s84, s89
  s_lshl_b32 s88, s88, 1
  s_add_u32 s88, s88, s85
  s_lshl_b32 s88, s88, 3
  s_add_u32 s88, s88, s84
  s_mul_i32 s88, s88, 14
  s_add_u32 s88, s88, s82
  s_lshl_b32 s88, s88, 10
  s_add_u32 s88, s88, 2097152
  buffer_store_dwordx4 v[136:139], v2, s[48:51], s88 offen sc1
  s_lshl_b32 s84, s83, 2
  s_add_u32 s84, s84, 3
  s_cmp_ge_u32 s84, 56
  s_cselect_b32 s85, 1, 0
  s_mul_i32 s88, s85, 56
  s_sub_u32 s84, s84, s88
  s_mul_i32 s88, s84, 37
  s_lshr_b32 s88, s88, 8
  s_mul_i32 s89, s88, 7
  s_sub_u32 s84, s84, s89
  s_lshl_b32 s88, s88, 1
  s_add_u32 s88, s88, s85
  s_lshl_b32 s88, s88, 3
  s_add_u32 s88, s88, s84
  s_mul_i32 s88, s88, 14
  s_add_u32 s88, s88, s82
  s_lshl_b32 s88, s88, 10
  s_add_u32 s88, s88, 2097152
  buffer_store_dwordx4 v[140:143], v2, s[48:51], s88 offen sc1
  s_nop 1
  s_branch L_pp_done
L_pp_not_win_f:
  s_cmp_lt_u32 s86, 744
  s_cbranch_scc0 L_pp_done
  v_cmp_gt_u32 vcc, 12, v3
  s_nop 1
  v_cndmask_b32 v15, 0, -1, vcc
  s_cmp_lt_u32 s86, 520
  s_nop 0
  s_cbranch_scc0 L_pp_wout_f
  s_sub_u32 s88, s86, 392
  v_lshlrev_b32 v14, 2, v4
  v_add_u32 v14, v14, v10
  v_mul_u32_u24 v14, 112, v14
  v_lshlrev_b32 v11, 4, v11
  v_add_u32 v14, v14, v11
  v_add_u32 v14, s87, v14
  ds_read_b64_tr_b16 v[128:129], v14 offset:0
  ds_read_b64_tr_b16 v[130:131], v14 offset:1792
  ds_read_b64_tr_b16 v[132:133], v14 offset:8
  ds_read_b64_tr_b16 v[134:135], v14 offset:1800
  ds_read_b64_tr_b16 v[136:137], v14 offset:64
  ds_read_b64_tr_b16 v[138:139], v14 offset:1856
  ds_read_b64_tr_b16 v[140:141], v14 offset:72
  ds_read_b64_tr_b16 v[142:143], v14 offset:1864
  v_cmp_gt_u32 vcc, 3, v4
  s_nop 1
  v_cndmask_b32 v13, 0, -1, vcc
  s_waitcnt lgkmcnt(0)
  v_and_b32 v130, v13, v130
  v_and_b32 v131, v13, v131
  v_and_b32 v134, v13, v134
  v_and_b32 v135, v13, v135
  v_and_b32 v138, v13, v138
  v_and_b32 v139, v13, v139
  v_and_b32 v142, v13, v142
  v_and_b32 v143, v13, v143
  s_lshl_b32 s88, s88, 12
  s_add_u32 s88, s88, 1048576
  s_branch L_pp_st7
L_pp_wout_f:
  s_sub_u32 s88, s86, 520
  v_lshlrev_b32 v14, 3, v4
  v_add_u32 v14, v14, v10
  v_mul_u32_u24 v14, 112, v14
  v_lshlrev_b32 v11, 4, v11
  v_add_u32 v14, v14, v11
  v_add_u32 v14, s87, v14
  ds_read_b64_tr_b16 v[128:129], v14 offset:0
  ds_read_b64_tr_b16 v[130:131], v14 offset:448
  ds_read_b64_tr_b16 v[132:133], v14 offset:8
  ds_read_b64_tr_b16 v[134:135], v14 offset:456
  ds_read_b64_tr_b16 v[136:137], v14 offset:64
  ds_read_b64_tr_b16 v[138:139], v14 offset:512
  ds_read_b64_tr_b16 v[140:141], v14 offset:72
  ds_read_b64_tr_b16 v[142:143], v14 offset:520
  s_waitcnt lgkmcnt(0)
  s_lshl_b32 s88, s88, 12
  s_add_u32 s88, s88, 4194304
L_pp_st7:
  v_and_b32 v136, v15, v136
  v_and_b32 v137, v15, v137
  v_and_b32 v138, v15, v138
  v_and_b32 v139, v15, v139
  v_and_b32 v140, v15, v140
  v_and_b32 v141, v15, v141
  v_and_b32 v142, v15, v142
  v_and_b32 v143, v15, v143
  buffer_store_dwordx4 v[128:131], v2, s[48:51], s88 offen offset:0 sc1
  buffer_store_dwordx4 v[132:135], v2, s[48:51], s88 offen offset:1024 sc1
  buffer_store_dwordx4 v[136:139], v2, s[48:51], s88 offen offset:2048 sc1
  buffer_store_dwordx4 v[140:143], v2, s[48:51], s88 offen offset:3072 sc1
  s_nop 1
L_pp_done:
  s_cmp_eq_u32 s52, 3
  s_cbranch_scc0 L_mod1_skip
  v_add_u32 v7, 192, v1
  v_min_u32 v7, 223, v7
  v_lshlrev_b32 v8, 4, v7
  v_add_u32 v132, 0, v1
  v_cmp_gt_u32 vcc, 112, v132
  v_subrev_u32 v133, 112, v132
  s_nop 0
  v_cndmask_b32 v133, v133, v132, vcc
  v_cndmask_b32 v135, 0, 8, vcc
  v_and_b32 v134, 1, v133
  v_lshlrev_b32 v134, 2, v134
  v_add_u32 v135, v135, v134
  v_lshlrev_b32 v135, 4, v135
  v_bfe_u32 v134, v133, 1, 2
  v_lshlrev_b32 v134, 8, v134
  v_add_u32 v135, v135, v134
  v_bfe_u32 v134, v133, 3, 2
  v_lshlrev_b32 v134, 2, v134
  v_add_u32 v135, v135, v134
  v_lshrrev_b32 v134, 5, v133
  v_lshlrev_b32 v134, 10, v134
  v_add_u32 v135, v135, v134
  v_add_u32 v128, 157696, v135
  v_add_u32 v132, 64, v1
  v_cmp_gt_u32 vcc, 112, v132
  v_subrev_u32 v133, 112, v132
  s_nop 0
  v_cndmask_b32 v133, v133, v132, vcc
  v_cndmask_b32 v135, 0, 8, vcc
  v_and_b32 v134, 1, v133
  v_lshlrev_b32 v134, 2, v134
  v_add_u32 v135, v135, v134
  v_lshlrev_b32 v135, 4, v135
  v_bfe_u32 v134, v133, 1, 2
  v_lshlrev_b32 v134, 8, v134
  v_add_u32 v135, v135, v134
  v_bfe_u32 v134, v133, 3, 2
  v_lshlrev_b32 v134, 2, v134
  v_add_u32 v135, v135, v134
  v_lshrrev_b32 v134, 5, v133
  v_lshlrev_b32 v134, 10, v134
  v_add_u32 v135, v135, v134
  v_add_u32 v129, 157696, v135
  v_add_u32 v132, 128, v1
  v_cmp_gt_u32 vcc, 112, v132
  v_subrev_u32 v133, 112, v132
  s_nop 0
  v_cndmask_b32 v133, v133, v132, vcc
  v_cndmask_b32 v135, 0, 8, vcc
  v_and_b32 v134, 1, v133
  v_lshlrev_b32 v134, 2, v134
  v_add_u32 v135, v135, v134
  v_lshlrev_b32 v135, 4, v135
  v_bfe_u32 v134, v133, 1, 2
  v_lshlrev_b32 v134, 8, v134
  v_add_u32 v135, v135, v134
  v_bfe_u32 v134, v133, 3, 2
  v_lshlrev_b32 v134, 2, v134
  v_add_u32 v135, v135, v134
  v_lshrrev_b32 v134, 5, v133
  v_lshlrev_b32 v134, 10, v134
  v_add_u32 v135, v135, v134
  v_add_u32 v130, 157696, v135
  v_mov_b32 v132, v7
  v_cmp_gt_u32 vcc, 112, v132
  v_subrev_u32 v133, 112, v132
  s_nop 0
  v_cndmask_b32 v133, v133, v132, vcc
  v_cndmask_b32 v135, 0, 8, vcc
  v_and_b32 v134, 1, v133
  v_lshlrev_b32 v134, 2, v134
  v_add_u32 v135, v135, v134
  v_lshlrev_b32 v135, 4, v135
  v_bfe_u32 v134, v133, 1, 2
  v_lshlrev_b32 v134, 8, v134
  v_add_u32 v135, v135, v134
  v_bfe_u32 v134, v133, 3, 2
  v_lshlrev_b32 v134, 2, v134
  v_add_u32 v135, v135, v134
  v_lshrrev_b32 v134, 5, v133
  v_lshlrev_b32 v134, 10, v134
  v_add_u32 v135, v135, v134
  v_add_u32 v131, 157696, v135
  s_mov_b32 s92, 32768
  s_mov_b32 s93, 32768
  s_mov_b32 s94, 32768
  s_mov_b32 s95, 32768
  s_mov_b32 s101, 0
L_mod1_1:
  buffer_load_dwordx4 v[240:243], v2, s[48:51], s92 offen offset:0 sc1
  buffer_load_dwordx4 v[244:247], v2, s[48:51], s93 offen offset:1024 sc1
  buffer_load_dwordx4 v[248:251], v2, s[48:51], s94 offen offset:2048 sc1
  buffer_load_dwordx4 v[252:255], v8, s[48:51], s95 offen offset:0 sc1
  s_waitcnt vmcnt(0)
  v_xor_b32 v241, s55, v241
  v_xor_b32 v243, s55, v243
  v_xor_b32 v245, s55, v245
  v_xor_b32 v247, s55, v247
  v_xor_b32 v249, s55, v249
  v_xor_b32 v251, s55, v251
  v_xor_b32 v253, s55, v253
  v_xor_b32 v255, s55, v255
  v_or3_b32 v241, v241, v243, v245
  v_or3_b32 v241, v241, v247, v249
  v_or3_b32 v241, v241, v251, v253
  v_or_b32 v241, v241, v255
  v_cmp_ne_u32 vcc, 0, v241
  s_nop 3
  s_cmp_eq_u64 vcc, 0
  s_cbranch_scc1 L_mod1ok_2
  s_add_u32 s101, s101, 1
  s_cmp_lt_u32 s101, 131072
  s_cbranch_scc1 L_mod1_1
  v_mov_b32 v5, 2
  v_mov_b32 v6, 0
  buffer_store_dword v5, v6, s[4:7], 0 offen
  s_nop 0
L_mod1ok_2:
  v_and_b32 v241, s100, v240
  v_and_b32 v243, s100, v242
  v_lshlrev_b32 v240, 16, v240
  v_lshlrev_b32 v242, 16, v242
  ds_write_b32 v128, v240 offset:0
  ds_write_b32 v128, v241 offset:16
  ds_write_b32 v128, v242 offset:32
  ds_write_b32 v128, v243 offset:48
  v_and_b32 v245, s100, v244
  v_and_b32 v247, s100, v246
  v_lshlrev_b32 v244, 16, v244
  v_lshlrev_b32 v246, 16, v246
  ds_write_b32 v129, v244 offset:0
  ds_write_b32 v129, v245 offset:16
  ds_write_b32 v129, v246 offset:32
  ds_write_b32 v129, v247 offset:48
  v_and_b32 v249, s100, v248
  v_and_b32 v251, s100, v250
  v_lshlrev_b32 v248, 16, v248
  v_lshlrev_b32 v250, 16, v250
  ds_write_b32 v130, v248 offset:0
  ds_write_b32 v130, v249 offset:16
  ds_write_b32 v130, v250 offset:32
  ds_write_b32 v130, v251 offset:48
  v_and_b32 v253, s100, v252
  v_and_b32 v255, s100, v254
  v_lshlrev_b32 v252, 16, v252
  v_lshlrev_b32 v254, 16, v254
  ds_write_b32 v131, v252 offset:0
  ds_write_b32 v131, v253 offset:16
  ds_write_b32 v131, v254 offset:32
  ds_write_b32 v131, v255 offset:48
  s_waitcnt lgkmcnt(0)
L_mod1_skip:
  s_waitcnt vmcnt(0)
  s_barrier
  v_add_u32 v7, 157696, v2
  ds_read_b128 v[128:131], v7 offset:0
  ds_read_b128 v[132:135], v7 offset:1024
  ds_read_b128 v[136:139], v7 offset:2048
  ds_read_b128 v[140:143], v7 offset:3072
  s_lshl_b32 s82, s52, 11
  s_add_u32 s82, s82, 100352
  v_add_u32 v6, s82, v2
  s_waitcnt lgkmcnt(3)
  v_mov_b32_dpp v144, v128 row_newbcast:8 row_mask:0xf bank_mask:0xf
  v_mov_b32_dpp v145, v128 row_newbcast:10 row_mask:0xf bank_mask:0xf
  v_mov_b32_dpp v146, v128 row_newbcast:12 row_mask:0xf bank_mask:0xf
  v_mov_b32_dpp v147, v128 row_newbcast:14 row_mask:0xf bank_mask:0xf
  v_mov_b32_dpp v148, v128 row_newbcast:9 row_mask:0xf bank_mask:0xf
  v_mov_b32_dpp v149, v128 row_newbcast:11 row_mask:0xf bank_mask:0xf
  v_mov_b32_dpp v150, v128 row_newbcast:13 row_mask:0xf bank_mask:0xf
  v_mov_b32_dpp v151, v128 row_newbcast:15 row_mask:0xf bank_mask:0xf
  v_fmac_f32_dpp v144, v128, v16 row_newbcast:0 row_mask:0xf bank_mask:0xf
  v_fmac_f32_dpp v145, v128, v17 row_newbcast:2 row_mask:0xf bank_mask:0xf
  v_fmac_f32_dpp v146, v128, v18 row_newbcast:4 row_mask:0xf bank_mask:0xf
  v_fmac_f32_dpp v147, v128, v19 row_newbcast:6 row_mask:0xf bank_mask:0xf
  v_fmac_f32_dpp v148, v128, v20 row_newbcast:1 row_mask:0xf bank_mask:0xf
  v_fmac_f32_dpp v149, v128, v21 row_newbcast:3 row_mask:0xf bank_mask:0xf
  v_fmac_f32_dpp v150, v128, v22 row_newbcast:5 row_mask:0xf bank_mask:0xf
  v_fmac_f32_dpp v151, v128, v23 row_newbcast:7 row_mask:0xf bank_mask:0xf
  s_add_u32 s81, s75, 1792
  s_add_u32 m0, s76, 50176
  s_mov_b32 exec_hi, 0x00ffffff
  buffer_load_dwordx4 v12, s[12:15], s81 offen lds
  s_mov_b32 exec_hi, -1
  v_cvt_pk_bf16_f32 v16, v144, v145
  v_cvt_pk_bf16_f32 v17, v146, v147
  v_cvt_pk_bf16_f32 v18, v148, v149
  v_cvt_pk_bf16_f32 v19, v150, v151
  ds_write_b128 v6, v[16:19] offset:0
  v_mov_b32_dpp v152, v129 row_newbcast:8 row_mask:0xf bank_mask:0xf
  v_mov_b32_dpp v153, v129 row_newbcast:10 row_mask:0xf bank_mask:0xf
  v_mov_b32_dpp v154, v129 row_newbcast:12 row_mask:0xf bank_mask:0xf
  v_mov_b32_dpp v155, v129 row_newbcast:14 row_mask:0xf bank_mask:0xf
  v_mov_b32_dpp v156, v129 row_newbcast:9 row_mask:0xf bank_mask:0xf
  v_mov_b32_dpp v157, v129 row_newbcast:11 row_mask:0xf bank_mask:0xf
  v_mov_b32_dpp v158, v129 row_newbcast:13 row_mask:0xf bank_mask:0xf
  v_mov_b32_dpp v159, v129 row_newbcast:15 row_mask:0xf bank_mask:0xf
  v_fmac_f32_dpp v152, v129, v24 row_newbcast:0 row_mask:0xf bank_mask:0xf
  v_fmac_f32_dpp v153, v129, v25 row_newbcast:2 row_mask:0xf bank_mask:0xf
  v_fmac_f32_dpp v154, v129, v26 row_newbcast:4 row_mask:0xf bank_mask:0xf
  v_fmac_f32_dpp v155, v129, v27 row_newbcast:6 row_mask:0xf bank_mask:0xf
  v_fmac_f32_dpp v156, v129, v28 row_newbcast:1 row_mask:0xf bank_mask:0xf
  v_fmac_f32_dpp v157, v129, v29 row_newbcast:3 row_mask:0xf bank_mask:0xf
  v_fmac_f32_dpp v158, v129, v30 row_newbcast:5 row_mask:0xf bank_mask:0xf
  v_fmac_f32_dpp v159, v129, v31 row_newbcast:7 row_mask:0xf bank_mask:0xf
  s_add_u32 s81, s75, 23296
  s_add_u32 m0, s76, 51072
  s_mov_b32 exec_hi, 0x00ffffff
  buffer_load_dwordx4 v12, s[12:15], s81 offen lds
  s_mov_b32 exec_hi, -1
  v_cvt_pk_bf16_f32 v24, v152, v153
  v_cvt_pk_bf16_f32 v25, v154, v155
  v_cvt_pk_bf16_f32 v26, v156, v157
  v_cvt_pk_bf16_f32 v27, v158, v159
  ds_write_b128 v6, v[24:27] offset:1024
  v_mov_b32_dpp v144, v130 row_newbcast:8 row_mask:0xf bank_mask:0xf
  v_mov_b32_dpp v145, v130 row_newbcast:10 row_mask:0xf bank_mask:0xf
  v_mov_b32_dpp v146, v130 row_newbcast:12 row_mask:0xf bank_mask:0xf
  v_mov_b32_dpp v147, v130 row_newbcast:14 row_mask:0xf bank_mask:0xf
  v_mov_b32_dpp v148, v130 row_newbcast:9 row_mask:0xf bank_mask:0xf
  v_mov_b32_dpp v149, v130 row_newbcast:11 row_mask:0xf bank_mask:0xf
  v_mov_b32_dpp v150, v130 row_newbcast:13 row_mask:0xf bank_mask:0xf
  v_mov_b32_dpp v151, v130 row_newbcast:15 row_mask:0xf bank_mask:0xf
  v_fmac_f32_dpp v144, v130, v32 row_newbcast:0 row_mask:0xf bank_mask:0xf
  v_fmac_f32_dpp v145, v130, v33 row_newbcast:2 row_mask:0xf bank_mask:0xf
  v_fmac_f32_dpp v146, v130, v34 row_newbcast:4 row_mask:0xf bank_mask:0xf
  v_fmac_f32_dpp v147, v130, v35 row_newbcast:6 row_mask:0xf bank_mask:0xf
  v_fmac_f32_dpp v148, v130, v36 row_newbcast:1 row_mask:0xf bank_mask:0xf
  v_fmac_f32_dpp v149, v130, v37 row_newbcast:3 row_mask:0xf bank_mask:0xf
  v_fmac_f32_dpp v150, v130, v38 row_newbcast:5 row_mask:0xf bank_mask:0xf
  v_fmac_f32_dpp v151, v130, v39 row_newbcast:7 row_mask:0xf bank_mask:0xf
  s_add_u32 s81, s75, 44800
  s_add_u32 m0, s76, 51968
  s_mov_b32 exec_hi, 0x00ffffff
  buffer_load_dwordx4 v12, s[12:15], s81 offen lds
  s_mov_b32 exec_hi, -1
  v_cvt_pk_bf16_f32 v32, v144, v145
  v_cvt_pk_bf16_f32 v33, v146, v147
  v_cvt_pk_bf16_f32 v34, v148, v149
  v_cvt_pk_bf16_f32 v35, v150, v151
  ds_write_b128 v6, v[32:35] offset:8192
  v_mov_b32_dpp v152, v131 row_newbcast:8 row_mask:0xf bank_mask:0xf
  v_mov_b32_dpp v153, v131 row_newbcast:10 row_mask:0xf bank_mask:0xf
  v_mov_b32_dpp v154, v131 row_newbcast:12 row_mask:0xf bank_mask:0xf
  v_mov_b32_dpp v155, v131 row_newbcast:14 row_mask:0xf bank_mask:0xf
  v_mov_b32_dpp v156, v131 row_newbcast:9 row_mask:0xf bank_mask:0xf
  v_mov_b32_dpp v157, v131 row_newbcast:11 row_mask:0xf bank_mask:0xf
  v_mov_b32_dpp v158, v131 row_newbcast:13 row_mask:0xf bank_mask:0xf
  v_mov_b32_dpp v159, v131 row_newbcast:15 row_mask:0xf bank_mask:0xf
  v_fmac_f32_dpp v152, v131, v40 row_newbcast:0 row_mask:0xf bank_mask:0xf
  v_fmac_f32_dpp v153, v131, v41 row_newbcast:2 row_mask:0xf bank_mask:0xf
  v_fmac_f32_dpp v154, v131, v42 row_newbcast:4 row_mask:0xf bank_mask:0xf
  v_fmac_f32_dpp v155, v131, v43 row_newbcast:6 row_mask:0xf bank_mask:0xf
  v_fmac_f32_dpp v156, v131, v44 row_newbcast:1 row_mask:0xf bank_mask:0xf
  v_fmac_f32_dpp v157, v131, v45 row_newbcast:3 row_mask:0xf bank_mask:0xf
  v_fmac_f32_dpp v158, v131, v46 row_newbcast:5 row_mask:0xf bank_mask:0xf
  v_fmac_f32_dpp v159, v131, v47 row_newbcast:7 row_mask:0xf bank_mask:0xf
  s_add_u32 s81, s75, 66304
  s_add_u32 m0, s76, 52864
  s_mov_b32 exec_hi, 0x00ffffff
  buffer_load_dwordx4 v12, s[12:15], s81 offen lds
  s_mov_b32 exec_hi, -1
  v_cvt_pk_bf16_f32 v40, v152, v153
  v_cvt_pk_bf16_f32 v41, v154, v155
  v_cvt_pk_bf16_f32 v42, v156, v157
  v_cvt_pk_bf16_f32 v43, v158, v159
  ds_write_b128 v6, v[40:43] offset:9216
  s_waitcnt lgkmcnt(6)
  v_mov_b32_dpp v144, v132 row_newbcast:8 row_mask:0xf bank_mask:0xf
  v_mov_b32_dpp v145, v132 row_newbcast:10 row_mask:0xf bank_mask:0xf
  v_mov_b32_dpp v146, v132 row_newbcast:12 row_mask:0xf bank_mask:0xf
  v_mov_b32_dpp v147, v132 row_newbcast:14 row_mask:0xf bank_mask:0xf
  v_mov_b32_dpp v148, v132 row_newbcast:9 row_mask:0xf bank_mask:0xf
  v_mov_b32_dpp v149, v132 row_newbcast:11 row_mask:0xf bank_mask:0xf
  v_mov_b32_dpp v150, v132 row_newbcast:13 row_mask:0xf bank_mask:0xf
  v_mov_b32_dpp v151, v132 row_newbcast:15 row_mask:0xf bank_mask:0xf
  v_fmac_f32_dpp v144, v132, v48 row_newbcast:0 row_mask:0xf bank_mask:0xf
  v_fmac_f32_dpp v145, v132, v49 row_newbcast:2 row_mask:0xf bank_mask:0xf
  v_fmac_f32_dpp v146, v132, v50 row_newbcast:4 row_mask:0xf bank_mask:0xf
  v_fmac_f32_dpp v147, v132, v51 row_newbcast:6 row_mask:0xf bank_mask:0xf
  v_fmac_f32_dpp v148, v132, v52 row_newbcast:1 row_mask:0xf bank_mask:0xf
  v_fmac_f32_dpp v149, v132, v53 row_newbcast:3 row_mask:0xf bank_mask:0xf
  v_fmac_f32_dpp v150, v132, v54 row_newbcast:5 row_mask:0xf bank_mask:0xf
  v_fmac_f32_dpp v151, v132, v55 row_newbcast:7 row_mask:0xf bank_mask:0xf
  s_add_u32 s81, s75, 87808
  s_add_u32 m0, s76, 53760
  s_mov_b32 exec_hi, 0x00ffffff
  buffer_load_dwordx4 v12, s[12:15], s81 offen lds
  s_mov_b32 exec_hi, -1
  v_cvt_pk_bf16_f32 v48, v144, v145
  v_cvt_pk_bf16_f32 v49, v146, v147
  v_cvt_pk_bf16_f32 v50, v148, v149
  v_cvt_pk_bf16_f32 v51, v150, v151
  ds_write_b128 v6, v[48:51] offset:16384
  v_mov_b32_dpp v152, v133 row_newbcast:8 row_mask:0xf bank_mask:0xf
  v_mov_b32_dpp v153, v133 row_newbcast:10 row_mask:0xf bank_mask:0xf
  v_mov_b32_dpp v154, v133 row_newbcast:12 row_mask:0xf bank_mask:0xf
  v_mov_b32_dpp v155, v133 row_newbcast:14 row_mask:0xf bank_mask:0xf
  v_mov_b32_dpp v156, v133 row_newbcast:9 row_mask:0xf bank_mask:0xf
  v_mov_b32_dpp v157, v133 row_newbcast:11 row_mask:0xf bank_mask:0xf
  v_mov_b32_dpp v158, v133 row_newbcast:13 row_mask:0xf bank_mask:0xf
  v_mov_b32_dpp v159, v133 row_newbcast:15 row_mask:0xf bank_mask:0xf
  v_fmac_f32_dpp v152, v133, v56 row_newbcast:0 row_mask:0xf bank_mask:0xf
  v_fmac_f32_dpp v153, v133, v57 row_newbcast:2 row_mask:0xf bank_mask:0xf
  v_fmac_f32_dpp v154, v133, v58 row_newbcast:4 row_mask:0xf bank_mask:0xf
  v_fmac_f32_dpp v155, v133, v59 row_newbcast:6 row_mask:0xf bank_mask:0xf
  v_fmac_f32_dpp v156, v133, v60 row_newbcast:1 row_mask:0xf bank_mask:0xf
  v_fmac_f32_dpp v157, v133, v61 row_newbcast:3 row_mask:0xf bank_mask:0xf
  v_fmac_f32_dpp v158, v133, v62 row_newbcast:5 row_mask:0xf bank_mask:0xf
  v_fmac_f32_dpp v159, v133, v63 row_newbcast:7 row_mask:0xf bank_mask:0xf
  s_add_u32 s81, s75, 109312
  s_add_u32 m0, s76, 54656
  s_mov_b32 exec_hi, 0x00ffffff
  buffer_load_dwordx4 v12, s[12:15], s81 offen lds
  s_mov_b32 exec_hi, -1
  v_cvt_pk_bf16_f32 v56, v152, v153
  v_cvt_pk_bf16_f32 v57, v154, v155
  v_cvt_pk_bf16_f32 v58, v156, v157
  v_cvt_pk_bf16_f32 v59, v158, v159
  ds_write_b128 v6, v[56:59] offset:17408
  v_mov_b32_dpp v144, v134 row_newbcast:8 row_mask:0xf bank_mask:0xf
  v_mov_b32_dpp v145, v134 row_newbcast:10 row_mask:0xf bank_mask:0xf
  v_mov_b32_dpp v146, v134 row_newbcast:12 row_mask:0xf bank_mask:0xf
  v_mov_b32_dpp v147, v134 row_newbcast:14 row_mask:0xf bank_mask:0xf
  v_mov_b32_dpp v148, v134 row_newbcast:9 row_mask:0xf bank_mask:0xf
  v_mov_b32_dpp v149, v134 row_newbcast:11 row_mask:0xf bank_mask:0xf
  v_mov_b32_dpp v150, v134 row_newbcast:13 row_mask:0xf bank_mask:0xf
  v_mov_b32_dpp v151, v134 row_newbcast:15 row_mask:0xf bank_mask:0xf
  v_fmac_f32_dpp v144, v134, v64 row_newbcast:0 row_mask:0xf bank_mask:0xf
  v_fmac_f32_dpp v145, v134, v65 row_newbcast:2 row_mask:0xf bank_mask:0xf
  v_fmac_f32_dpp v146, v134, v66 row_newbcast:4 row_mask:0xf bank_mask:0xf
  v_fmac_f32_dpp v147, v134, v67 row_newbcast:6 row_mask:0xf bank_mask:0xf
  v_fmac_f32_dpp v148, v134, v68 row_newbcast:1 row_mask:0xf bank_mask:0xf
  v_fmac_f32_dpp v149, v134, v69 row_newbcast:3 row_mask:0xf bank_mask:0xf
  v_fmac_f32_dpp v150, v134, v70 row_newbcast:5 row_mask:0xf bank_mask:0xf
  v_fmac_f32_dpp v151, v134, v71 row_newbcast:7 row_mask:0xf bank_mask:0xf
  s_add_u32 s81, s75, 130816
  s_add_u32 m0, s76, 55552
  s_mov_b32 exec_hi, 0x00ffffff
  buffer_load_dwordx4 v12, s[12:15], s81 offen lds
  s_mov_b32 exec_hi, -1
  v_cvt_pk_bf16_f32 v64, v144, v145
  v_cvt_pk_bf16_f32 v65, v146, v147
  v_cvt_pk_bf16_f32 v66, v148, v149
  v_cvt_pk_bf16_f32 v67, v150, v151
  ds_write_b128 v6, v[64:67] offset:24576
  v_mov_b32_dpp v152, v135 row_newbcast:8 row_mask:0xf bank_mask:0xf
  v_mov_b32_dpp v153, v135 row_newbcast:10 row_mask:0xf bank_mask:0xf
  v_mov_b32_dpp v154, v135 row_newbcast:12 row_mask:0xf bank_mask:0xf
  v_mov_b32_dpp v155, v135 row_newbcast:14 row_mask:0xf bank_mask:0xf
  v_mov_b32_dpp v156, v135 row_newbcast:9 row_mask:0xf bank_mask:0xf
  v_mov_b32_dpp v157, v135 row_newbcast:11 row_mask:0xf bank_mask:0xf
  v_mov_b32_dpp v158, v135 row_newbcast:13 row_mask:0xf bank_mask:0xf
  v_mov_b32_dpp v159, v135 row_newbcast:15 row_mask:0xf bank_mask:0xf
  v_fmac_f32_dpp v152, v135, v72 row_newbcast:0 row_mask:0xf bank_mask:0xf
  v_fmac_f32_dpp v153, v135, v73 row_newbcast:2 row_mask:0xf bank_mask:0xf
  v_fmac_f32_dpp v154, v135, v74 row_newbcast:4 row_mask:0xf bank_mask:0xf
  v_fmac_f32_dpp v155, v135, v75 row_newbcast:6 row_mask:0xf bank_mask:0xf
  v_fmac_f32_dpp v156, v135, v76 row_newbcast:1 row_mask:0xf bank_mask:0xf
  v_fmac_f32_dpp v157, v135, v77 row_newbcast:3 row_mask:0xf bank_mask:0xf
  v_fmac_f32_dpp v158, v135, v78 row_newbcast:5 row_mask:0xf bank_mask:0xf
  v_fmac_f32_dpp v159, v135, v79 row_newbcast:7 row_mask:0xf bank_mask:0xf
  s_add_u32 s81, s75, 152320
  s_add_u32 m0, s76, 56448
  s_mov_b32 exec_hi, 0x00ffffff
  buffer_load_dwordx4 v12, s[12:15], s81 offen lds
  s_mov_b32 exec_hi, -1
  v_cvt_pk_bf16_f32 v72, v152, v153
  v_cvt_pk_bf16_f32 v73, v154, v155
  v_cvt_pk_bf16_f32 v74, v156, v157
  v_cvt_pk_bf16_f32 v75, v158, v159
  ds_write_b128 v6, v[72:75] offset:25600
  s_waitcnt lgkmcnt(9)
  v_mov_b32_dpp v144, v136 row_newbcast:8 row_mask:0xf bank_mask:0xf
  v_mov_b32_dpp v145, v136 row_newbcast:10 row_mask:0xf bank_mask:0xf
  v_mov_b32_dpp v146, v136 row_newbcast:12 row_mask:0xf bank_mask:0xf
  v_mov_b32_dpp v147, v136 row_newbcast:14 row_mask:0xf bank_mask:0xf
  v_mov_b32_dpp v148, v136 row_newbcast:9 row_mask:0xf bank_mask:0xf
  v_mov_b32_dpp v149, v136 row_newbcast:11 row_mask:0xf bank_mask:0xf
  v_mov_b32_dpp v150, v136 row_newbcast:13 row_mask:0xf bank_mask:0xf
  v_mov_b32_dpp v151, v136 row_newbcast:15 row_mask:0xf bank_mask:0xf
  v_fmac_f32_dpp v144, v136, v80 row_newbcast:0 row_mask:0xf bank_mask:0xf
  v_fmac_f32_dpp v145, v136, v81 row_newbcast:2 row_mask:0xf bank_mask:0xf
  v_fmac_f32_dpp v146, v136, v82 row_newbcast:4 row_mask:0xf bank_mask:0xf
  v_fmac_f32_dpp v147, v136, v83 row_newbcast:6 row_mask:0xf bank_mask:0xf
  v_fmac_f32_dpp v148, v136, v84 row_newbcast:1 row_mask:0xf bank_mask:0xf
  v_fmac_f32_dpp v149, v136, v85 row_newbcast:3 row_mask:0xf bank_mask:0xf
  v_fmac_f32_dpp v150, v136, v86 row_newbcast:5 row_mask:0xf bank_mask:0xf
  v_fmac_f32_dpp v151, v136, v87 row_newbcast:7 row_mask:0xf bank_mask:0xf
  s_add_u32 s81, s75, 173824
  s_add_u32 m0, s76, 57344
  s_mov_b32 exec_hi, 0x00ffffff
  buffer_load_dwordx4 v12, s[12:15], s81 offen lds
  s_mov_b32 exec_hi, -1
  v_cvt_pk_bf16_f32 v80, v144, v145
  v_cvt_pk_bf16_f32 v81, v146, v147
  v_cvt_pk_bf16_f32 v82, v148, v149
  v_cvt_pk_bf16_f32 v83, v150, v151
  ds_write_b128 v6, v[80:83] offset:32768
  v_mov_b32_dpp v152, v137 row_newbcast:8 row_mask:0xf bank_mask:0xf
  v_mov_b32_dpp v153, v137 row_newbcast:10 row_mask:0xf bank_mask:0xf
  v_mov_b32_dpp v154, v137 row_newbcast:12 row_mask:0xf bank_mask:0xf
  v_mov_b32_dpp v155, v137 row_newbcast:14 row_mask:0xf bank_mask:0xf
  v_mov_b32_dpp v156, v137 row_newbcast:9 row_mask:0xf bank_mask:0xf
  v_mov_b32_dpp v157, v137 row_newbcast:11 row_mask:0xf bank_mask:0xf
  v_mov_b32_dpp v158, v137 row_newbcast:13 row_mask:0xf bank_mask:0xf
  v_mov_b32_dpp v159, v137 row_newbcast:15 row_mask:0xf bank_mask:0xf
  v_fmac_f32_dpp v152, v137, v88 row_newbcast:0 row_mask:0xf bank_mask:0xf
  v_fmac_f32_dpp v153, v137, v89 row_newbcast:2 row_mask:0xf bank_mask:0xf
  v_fmac_f32_dpp v154, v137, v90 row_newbcast:4 row_mask:0xf bank_mask:0xf
  v_fmac_f32_dpp v155, v137, v91 row_newbcast:6 row_mask:0xf bank_mask:0xf
  v_fmac_f32_dpp v156, v137, v92 row_newbcast:1 row_mask:0xf bank_mask:0xf
  v_fmac_f32_dpp v157, v137, v93 row_newbcast:3 row_mask:0xf bank_mask:0xf
  v_fmac_f32_dpp v158, v137, v94 row_newbcast:5 row_mask:0xf bank_mask:0xf
  v_fmac_f32_dpp v159, v137, v95 row_newbcast:7 row_mask:0xf bank_mask:0xf
  s_add_u32 s81, s75, 195328
  s_add_u32 m0, s76, 58240
  s_mov_b32 exec_hi, 0x00ffffff
  buffer_load_dwordx4 v12, s[12:15], s81 offen lds
  s_mov_b32 exec_hi, -1
  v_cvt_pk_bf16_f32 v88, v152, v153
  v_cvt_pk_bf16_f32 v89, v154, v155
  v_cvt_pk_bf16_f32 v90, v156, v157
  v_cvt_pk_bf16_f32 v91, v158, v159
  ds_write_b128 v6, v[88:91] offset:33792
  v_mov_b32_dpp v144, v138 row_newbcast:8 row_mask:0xf bank_mask:0xf
  v_mov_b32_dpp v145, v138 row_newbcast:10 row_mask:0xf bank_mask:0xf
  v_mov_b32_dpp v146, v138 row_newbcast:12 row_mask:0xf bank_mask:0xf
  v_mov_b32_dpp v147, v138 row_newbcast:14 row_mask:0xf bank_mask:0xf
  v_mov_b32_dpp v148, v138 row_newbcast:9 row_mask:0xf bank_mask:0xf
  v_mov_b32_dpp v149, v138 row_newbcast:11 row_mask:0xf bank_mask:0xf
  v_mov_b32_dpp v150, v138 row_newbcast:13 row_mask:0xf bank_mask:0xf
  v_mov_b32_dpp v151, v138 row_newbcast:15 row_mask:0xf bank_mask:0xf
  v_fmac_f32_dpp v144, v138, v96 row_newbcast:0 row_mask:0xf bank_mask:0xf
  v_fmac_f32_dpp v145, v138, v97 row_newbcast:2 row_mask:0xf bank_mask:0xf
  v_fmac_f32_dpp v146, v138, v98 row_newbcast:4 row_mask:0xf bank_mask:0xf
  v_fmac_f32_dpp v147, v138, v99 row_newbcast:6 row_mask:0xf bank_mask:0xf
  v_fmac_f32_dpp v148, v138, v100 row_newbcast:1 row_mask:0xf bank_mask:0xf
  v_fmac_f32_dpp v149, v138, v101 row_newbcast:3 row_mask:0xf bank_mask:0xf
  v_fmac_f32_dpp v150, v138, v102 row_newbcast:5 row_mask:0xf bank_mask:0xf
  v_fmac_f32_dpp v151, v138, v103 row_newbcast:7 row_mask:0xf bank_mask:0xf
  s_add_u32 s81, s75, 216832
  s_add_u32 m0, s76, 59136
  s_mov_b32 exec_hi, 0x00ffffff
  buffer_load_dwordx4 v12, s[12:15], s81 offen lds
  s_mov_b32 exec_hi, -1
  v_cvt_pk_bf16_f32 v96, v144, v145
  v_cvt_pk_bf16_f32 v97, v146, v147
  v_cvt_pk_bf16_f32 v98, v148, v149
  v_cvt_pk_bf16_f32 v99, v150, v151
  ds_write_b128 v6, v[96:99] offset:40960
  v_mov_b32_dpp v152, v139 row_newbcast:8 row_mask:0xf bank_mask:0xf
  v_mov_b32_dpp v153, v139 row_newbcast:10 row_mask:0xf bank_mask:0xf
  v_mov_b32_dpp v154, v139 row_newbcast:12 row_mask:0xf bank_mask:0xf
  v_mov_b32_dpp v155, v139 row_newbcast:14 row_mask:0xf bank_mask:0xf
  v_mov_b32_dpp v156, v139 row_newbcast:9 row_mask:0xf bank_mask:0xf
  v_mov_b32_dpp v157, v139 row_newbcast:11 row_mask:0xf bank_mask:0xf
  v_mov_b32_dpp v158, v139 row_newbcast:13 row_mask:0xf bank_mask:0xf
  v_mov_b32_dpp v159, v139 row_newbcast:15 row_mask:0xf bank_mask:0xf
  v_fmac_f32_dpp v152, v139, v104 row_newbcast:0 row_mask:0xf bank_mask:0xf
  v_fmac_f32_dpp v153, v139, v105 row_newbcast:2 row_mask:0xf bank_mask:0xf
  v_fmac_f32_dpp v154, v139, v106 row_newbcast:4 row_mask:0xf bank_mask:0xf
  v_fmac_f32_dpp v155, v139, v107 row_newbcast:6 row_mask:0xf bank_mask:0xf
  v_fmac_f32_dpp v156, v139, v108 row_newbcast:1 row_mask:0xf bank_mask:0xf
  v_fmac_f32_dpp v157, v139, v109 row_newbcast:3 row_mask:0xf bank_mask:0xf
  v_fmac_f32_dpp v158, v139, v110 row_newbcast:5 row_mask:0xf bank_mask:0xf
  v_fmac_f32_dpp v159, v139, v111 row_newbcast:7 row_mask:0xf bank_mask:0xf
  s_add_u32 s81, s75, 238336
  s_add_u32 m0, s76, 60032
  s_mov_b32 exec_hi, 0x00ffffff
  buffer_load_dwordx4 v12, s[12:15], s81 offen lds
  s_mov_b32 exec_hi, -1
  v_cvt_pk_bf16_f32 v104, v152, v153
  v_cvt_pk_bf16_f32 v105, v154, v155
  v_cvt_pk_bf16_f32 v106, v156, v157
  v_cvt_pk_bf16_f32 v107, v158, v159
  ds_write_b128 v6, v[104:107] offset:41984
  s_waitcnt lgkmcnt(12)
  v_mov_b32_dpp v144, v140 row_newbcast:8 row_mask:0xf bank_mask:0xf
  v_mov_b32_dpp v145, v140 row_newbcast:10 row_mask:0xf bank_mask:0xf
  v_mov_b32_dpp v146, v140 row_newbcast:12 row_mask:0xf bank_mask:0xf
  v_mov_b32_dpp v147, v140 row_newbcast:14 row_mask:0xf bank_mask:0xf
  v_mov_b32_dpp v148, v140 row_newbcast:9 row_mask:0xf bank_mask:0xf
  v_mov_b32_dpp v149, v140 row_newbcast:11 row_mask:0xf bank_mask:0xf
  v_mov_b32_dpp v150, v140 row_newbcast:13 row_mask:0xf bank_mask:0xf
  v_mov_b32_dpp v151, v140 row_newbcast:15 row_mask:0xf bank_mask:0xf
  v_fmac_f32_dpp v144, v140, v112 row_newbcast:0 row_mask:0xf bank_mask:0xf
  v_fmac_f32_dpp v145, v140, v113 row_newbcast:2 row_mask:0xf bank_mask:0xf
  v_fmac_f32_dpp v146, v140, v114 row_newbcast:4 row_mask:0xf bank_mask:0xf
  v_fmac_f32_dpp v147, v140, v115 row_newbcast:6 row_mask:0xf bank_mask:0xf
  v_fmac_f32_dpp v148, v140, v116 row_newbcast:1 row_mask:0xf bank_mask:0xf
  v_fmac_f32_dpp v149, v140, v117 row_newbcast:3 row_mask:0xf bank_mask:0xf
  v_fmac_f32_dpp v150, v140, v118 row_newbcast:5 row_mask:0xf bank_mask:0xf
  v_fmac_f32_dpp v151, v140, v119 row_newbcast:7 row_mask:0xf bank_mask:0xf
  s_add_u32 s81, s75, 259840
  s_add_u32 m0, s76, 60928
  s_mov_b32 exec_hi, 0x00ffffff
  buffer_load_dwordx4 v12, s[12:15], s81 offen lds
  s_mov_b32 exec_hi, -1
  v_cvt_pk_bf16_f32 v112, v144, v145
  v_cvt_pk_bf16_f32 v113, v146, v147
  v_cvt_pk_bf16_f32 v114, v148, v149
  v_cvt_pk_bf16_f32 v115, v150, v151
  ds_write_b128 v6, v[112:115] offset:49152
  v_mov_b32_dpp v152, v141 row_newbcast:8 row_mask:0xf bank_mask:0xf
  v_mov_b32_dpp v153, v141 row_newbcast:10 row_mask:0xf bank_mask:0xf
  v_mov_b32_dpp v154, v141 row_newbcast:12 row_mask:0xf bank_mask:0xf
  v_mov_b32_dpp v155, v141 row_newbcast:14 row_mask:0xf bank_mask:0xf
  v_mov_b32_dpp v156, v141 row_newbcast:9 row_mask:0xf bank_mask:0xf
  v_mov_b32_dpp v157, v141 row_newbcast:11 row_mask:0xf bank_mask:0xf
  v_mov_b32_dpp v158, v141 row_newbcast:13 row_mask:0xf bank_mask:0xf
  v_mov_b32_dpp v159, v141 row_newbcast:15 row_mask:0xf bank_mask:0xf
  v_fmac_f32_dpp v152, v141, v120 row_newbcast:0 row_mask:0xf bank_mask:0xf
  v_fmac_f32_dpp v153, v141, v121 row_newbcast:2 row_mask:0xf bank_mask:0xf
  v_fmac_f32_dpp v154, v141, v122 row_newbcast:4 row_mask:0xf bank_mask:0xf
  v_fmac_f32_dpp v155, v141, v123 row_newbcast:6 row_mask:0xf bank_mask:0xf
  v_fmac_f32_dpp v156, v141, v124 row_newbcast:1 row_mask:0xf bank_mask:0xf
  v_fmac_f32_dpp v157, v141, v125 row_newbcast:3 row_mask:0xf bank_mask:0xf
  v_fmac_f32_dpp v158, v141, v126 row_newbcast:5 row_mask:0xf bank_mask:0xf
  v_fmac_f32_dpp v159, v141, v127 row_newbcast:7 row_mask:0xf bank_mask:0xf
  s_add_u32 s81, s75, 281344
  s_add_u32 m0, s76, 61824
  s_mov_b32 exec_hi, 0x00ffffff
  buffer_load_dwordx4 v12, s[12:15], s81 offen lds
  s_mov_b32 exec_hi, -1
  v_cvt_pk_bf16_f32 v120, v152, v153
  v_cvt_pk_bf16_f32 v121, v154, v155
  v_cvt_pk_bf16_f32 v122, v156, v157
  v_cvt_pk_bf16_f32 v123, v158, v159
  ds_write_b128 v6, v[120:123] offset:50176
  s_waitcnt vmcnt(14)
  s_lshl_b32 s86, s2, 2
  s_add_u32 s86, s86, s52
  s_add_u32 s87, s2, 516
  s_cmp_eq_u32 s52, 1
  s_cselect_b32 s87, s87, 9999
  s_cmp_lt_u32 s2, 172
  s_cselect_b32 s86, s86, s87
  s_cmp_lt_u32 s86, 768
  s_cbranch_scc0 L_pp_flagged
  s_lshl_b32 s88, s86, 2
  s_add_u32 s88, s88, 4096
  v_mov_b32 v5, s55
  s_mov_b64 exec, 1
  buffer_store_dword v5, off, s[48:51], s88 sc1
  s_mov_b64 exec, -1
L_pp_flagged:
  s_waitcnt lgkmcnt(0)
  s_barrier
  s_lshr_b32 s82, s52, 1
  s_lshl_b32 s82, s82, 12
  s_add_u32 s82, s82, 100352
  v_add_u32 v7, s82, v2
  ds_read_b128 v[16:19], v7 offset:0
  ds_read_b128 v[20:23], v7 offset:2048
  ds_read_b128 v[24:27], v7 offset:1024
  ds_read_b128 v[28:31], v7 offset:3072
  ds_read_b128 v[32:35], v7 offset:8192
  ds_read_b128 v[36:39], v7 offset:10240
  ds_read_b128 v[40:43], v7 offset:9216
  ds_read_b128 v[44:47], v7 offset:11264
  ds_read_b128 v[48:51], v7 offset:16384
  ds_read_b128 v[52:55], v7 offset:18432
  ds_read_b128 v[56:59], v7 offset:17408
  ds_read_b128 v[60:63], v7 offset:19456
  ds_read_b128 v[64:67], v7 offset:24576
  ds_read_b128 v[68:71], v7 offset:26624
  ds_read_b128 v[72:75], v7 offset:25600
  ds_read_b128 v[76:79], v7 offset:27648
  ds_read_b128 v[80:83], v7 offset:32768
  ds_read_b128 v[84:87], v7 offset:34816
  ds_read_b128 v[88:91], v7 offset:33792
  ds_read_b128 v[92:95], v7 offset:35840
  ds_read_b128 v[96:99], v7 offset:40960
  ds_read_b128 v[100:103], v7 offset:43008
  ds_read_b128 v[104:107], v7 offset:41984
  ds_read_b128 v[108:111], v7 offset:44032
  ds_read_b128 v[112:115], v7 offset:49152
  ds_read_b128 v[116:119], v7 offset:51200
  ds_read_b128 v[120:123], v7 offset:50176
  ds_read_b128 v[124:127], v7 offset:52224
  s_and_b32 s82, s52, 1
  s_lshl_b32 s83, s54, 1
  s_add_u32 s58, s83, s82
  s_lshr_b32 s82, s52, 1
  s_lshl_b32 s83, s53, 1
  s_add_u32 s59, s83, s82
  s_lshl_b32 s82, s58, 6
  s_add_u32 s82, s82, s59
  s_lshl_b32 s60, s82, 12
  s_add_u32 s60, s60, 5242880
  s_lshl_b32 s61, s82, 2
  s_add_u32 s61, s61, 8192
  v_cmp_gt_u32 vcc, 3, v4
  s_nop 1
  v_cndmask_b32 v13, 0, -1, vcc
  v_cmp_gt_u32 vcc, 12, v3
  s_nop 1
  v_cndmask_b32 v14, 0, -1, vcc
  v_cmp_eq_u32 vcc, 12, v3
  v_mov_b32 v15, 0x3f803f80
  s_nop 0
  v_cndmask_b32 v15, 0, v15, vcc
  s_waitcnt lgkmcnt(0)
  s_barrier
  v_lshrrev_b32 v8, 2, v3
  v_lshlrev_b32 v8, 1, v8
  v_lshlrev_b32 v6, 3, v4
  v_add_u32 v6, v6, v8
  v_mul_u32_u24 v6, 112, v6
  v_and_b32 v8, 3, v3
  v_lshlrev_b32 v8, 3, v8
  v_add_u32 v6, v6, v8
  s_and_b32 s82, s52, 1
  s_mul_i32 s82, s82, 56
  v_add_u32 v6, s82, v6
  v_add_u32 v7, 0, v6
  ds_read_b64_tr_b16 v[176:177], v7 offset:0
  ds_read_b64_tr_b16 v[178:179], v7 offset:112
  ds_read_b64_tr_b16 v[180:181], v7 offset:32
  ds_read_b64_tr_b16 v[182:183], v7 offset:144
  ds_read_b64_tr_b16 v[184:185], v7 offset:3584
  ds_read_b64_tr_b16 v[186:187], v7 offset:3696
  ds_read_b64_tr_b16 v[188:189], v7 offset:3616
  ds_read_b64_tr_b16 v[190:191], v7 offset:3728
  ds_read_b64_tr_b16 v[192:193], v7 offset:7168
  ds_read_b64_tr_b16 v[194:195], v7 offset:7280
  ds_read_b64_tr_b16 v[196:197], v7 offset:7200
  ds_read_b64_tr_b16 v[198:199], v7 offset:7312
  s_add_u32 s81, s75, 0
  s_add_u32 m0, s76, 100352
  s_mov_b32 exec_hi, 0x00ffffff
  buffer_load_dwordx4 v12, s[12:15], s81 offen lds
  s_mov_b32 exec_hi, -1
  s_waitcnt lgkmcnt(8)
  v_mfma_f32_16x16x32_bf16 v[128:131], v[176:179], v[16:19], 0
  ds_read_b64_tr_b16 v[200:201], v7 offset:10752
  v_mfma_f32_16x16x32_bf16 v[132:135], v[180:183], v[16:19], 0
  ds_read_b64_tr_b16 v[202:203], v7 offset:10864
  v_mfma_f32_16x16x32_bf16 v[136:139], v[176:179], v[20:23], 0
  ds_read_b64_tr_b16 v[204:205], v7 offset:10784
  v_mfma_f32_16x16x32_bf16 v[140:143], v[180:183], v[20:23], 0
  ds_read_b64_tr_b16 v[206:207], v7 offset:10896
  s_add_u32 s81, s75, 21504
  s_add_u32 m0, s76, 101248
  s_mov_b32 exec_hi, 0x00ffffff
  buffer_load_dwordx4 v12, s[12:15], s81 offen lds
  s_mov_b32 exec_hi, -1
  s_waitcnt lgkmcnt(8)
  v_mfma_f32_16x16x32_bf16 v[128:131], v[184:187], v[24:27], v[128:131]
  ds_read_b64_tr_b16 v[176:177], v7 offset:14336
  v_mfma_f32_16x16x32_bf16 v[132:135], v[188:191], v[24:27], v[132:135]
  ds_read_b64_tr_b16 v[178:179], v7 offset:14448
  v_mfma_f32_16x16x32_bf16 v[136:139], v[184:187], v[28:31], v[136:139]
  ds_read_b64_tr_b16 v[180:181], v7 offset:14368
  v_mfma_f32_16x16x32_bf16 v[140:143], v[188:191], v[28:31], v[140:143]
  ds_read_b64_tr_b16 v[182:183], v7 offset:14480
  s_add_u32 s81, s75, 43008
  s_add_u32 m0, s76, 102144
  s_mov_b32 exec_hi, 0x00ffffff
  buffer_load_dwordx4 v12, s[12:15], s81 offen lds
  s_mov_b32 exec_hi, -1
  s_waitcnt lgkmcnt(8)
  v_mfma_f32_16x16x32_bf16 v[128:131], v[192:195], v[32:35], v[128:131]
  ds_read_b64_tr_b16 v[184:185], v7 offset:17920
  v_mfma_f32_16x16x32_bf16 v[132:135], v[196:199], v[32:35], v[132:135]
  ds_read_b64_tr_b16 v[186:187], v7 offset:18032
  v_mfma_f32_16x16x32_bf16 v[136:139], v[192:195], v[36:39], v[136:139]
  ds_read_b64_tr_b16 v[188:189], v7 offset:17952
  v_mfma_f32_16x16x32_bf16 v[140:143], v[196:199], v[36:39], v[140:143]
  ds_read_b64_tr_b16 v[190:191], v7 offset:18064
  s_add_u32 s81, s75, 64512
  s_add_u32 m0, s76, 103040
  s_mov_b32 exec_hi, 0x00ffffff
  buffer_load_dwordx4 v12, s[12:15], s81 offen lds
  s_mov_b32 exec_hi, -1
  s_waitcnt lgkmcnt(8)
  v_mfma_f32_16x16x32_bf16 v[128:131], v[200:203], v[40:43], v[128:131]
  ds_read_b64_tr_b16 v[192:193], v7 offset:21504
  v_mfma_f32_16x16x32_bf16 v[132:135], v[204:207], v[40:43], v[132:135]
  ds_read_b64_tr_b16 v[194:195], v7 offset:21616
  v_mfma_f32_16x16x32_bf16 v[136:139], v[200:203], v[44:47], v[136:139]
  ds_read_b64_tr_b16 v[196:197], v7 offset:21536
  v_mfma_f32_16x16x32_bf16 v[140:143], v[204:207], v[44:47], v[140:143]
  ds_read_b64_tr_b16 v[198:199], v7 offset:21648
  s_add_u32 s81, s75, 86016
  s_add_u32 m0, s76, 103936
  s_mov_b32 exec_hi, 0x00ffffff
  buffer_load_dwordx4 v12, s[12:15], s81 offen lds
  s_mov_b32 exec_hi, -1
  s_waitcnt lgkmcnt(8)
  v_mfma_f32_16x16x32_bf16 v[128:131], v[176:179], v[48:51], v[128:131]
  ds_read_b64_tr_b16 v[200:201], v7 offset:25088
  v_mfma_f32_16x16x32_bf16 v[132:135], v[180:183], v[48:51], v[132:135]
  ds_read_b64_tr_b16 v[202:203], v7 offset:25200
  v_mfma_f32_16x16x32_bf16 v[136:139], v[176:179], v[52:55], v[136:139]
  ds_read_b64_tr_b16 v[204:205], v7 offset:25120
  v_mfma_f32_16x16x32_bf16 v[140:143], v[180:183], v[52:55], v[140:143]
  ds_read_b64_tr_b16 v[206:207], v7 offset:25232
  s_add_u32 s81, s75, 107520
  s_add_u32 m0, s76, 104832
  s_mov_b32 exec_hi, 0x00ffffff
  buffer_load_dwordx4 v12, s[12:15], s81 offen lds
  s_mov_b32 exec_hi, -1
  s_waitcnt lgkmcnt(8)
  v_mfma_f32_16x16x32_bf16 v[128:131], v[184:187], v[56:59], v[128:131]
  ds_read_b64_tr_b16 v[176:177], v7 offset:28672
  v_mfma_f32_16x16x32_bf16 v[132:135], v[188:191], v[56:59], v[132:135]
  ds_read_b64_tr_b16 v[178:179], v7 offset:28784
  v_mfma_f32_16x16x32_bf16 v[136:139], v[184:187], v[60:63], v[136:139]
  ds_read_b64_tr_b16 v[180:181], v7 offset:28704
  v_mfma_f32_16x16x32_bf16 v[140:143], v[188:191], v[60:63], v[140:143]
  ds_read_b64_tr_b16 v[182:183], v7 offset:28816
  s_add_u32 s81, s75, 129024
  s_add_u32 m0, s76, 105728
  s_mov_b32 exec_hi, 0x00ffffff
  buffer_load_dwordx4 v12, s[12:15], s81 offen lds
  s_mov_b32 exec_hi, -1
  s_waitcnt lgkmcnt(8)
  v_mfma_f32_16x16x32_bf16 v[128:131], v[192:195], v[64:67], v[128:131]
  ds_read_b64_tr_b16 v[184:185], v7 offset:32256
  v_mfma_f32_16x16x32_bf16 v[132:135], v[196:199], v[64:67], v[132:135]
  ds_read_b64_tr_b16 v[186:187], v7 offset:32368
  v_mfma_f32_16x16x32_bf16 v[136:139], v[192:195], v[68:71], v[136:139]
  ds_read_b64_tr_b16 v[188:189], v7 offset:32288
  v_mfma_f32_16x16x32_bf16 v[140:143], v[196:199], v[68:71], v[140:143]
  ds_read_b64_tr_b16 v[190:191], v7 offset:32400
  s_add_u32 s81, s75, 150528
  s_add_u32 m0, s76, 106624
  s_mov_b32 exec_hi, 0x00ffffff
  buffer_load_dwordx4 v12, s[12:15], s81 offen lds
  s_mov_b32 exec_hi, -1
  s_waitcnt lgkmcnt(8)
  v_mfma_f32_16x16x32_bf16 v[128:131], v[200:203], v[72:75], v[128:131]
  ds_read_b64_tr_b16 v[192:193], v7 offset:35840
  v_mfma_f32_16x16x32_bf16 v[132:135], v[204:207], v[72:75], v[132:135]
  ds_read_b64_tr_b16 v[194:195], v7 offset:35952
  v_mfma_f32_16x16x32_bf16 v[136:139], v[200:203], v[76:79], v[136:139]
  ds_read_b64_tr_b16 v[196:197], v7 offset:35872
  v_mfma_f32_16x16x32_bf16 v[140:143], v[204:207], v[76:79], v[140:143]
  ds_read_b64_tr_b16 v[198:199], v7 offset:35984
  s_add_u32 s81, s75, 172032
  s_add_u32 m0, s76, 107520
  s_mov_b32 exec_hi, 0x00ffffff
  buffer_load_dwordx4 v12, s[12:15], s81 offen lds
  s_mov_b32 exec_hi, -1
  s_waitcnt lgkmcnt(8)
  v_mfma_f32_16x16x32_bf16 v[128:131], v[176:179], v[80:83], v[128:131]
  ds_read_b64_tr_b16 v[200:201], v7 offset:39424
  v_mfma_f32_16x16x32_bf16 v[132:135], v[180:183], v[80:83], v[132:135]
  ds_read_b64_tr_b16 v[202:203], v7 offset:39536
  v_mfma_f32_16x16x32_bf16 v[136:139], v[176:179], v[84:87], v[136:139]
  ds_read_b64_tr_b16 v[204:205], v7 offset:39456
  v_mfma_f32_16x16x32_bf16 v[140:143], v[180:183], v[84:87], v[140:143]
  ds_read_b64_tr_b16 v[206:207], v7 offset:39568
  s_add_u32 s81, s75, 193536
  s_add_u32 m0, s76, 108416
  s_mov_b32 exec_hi, 0x00ffffff
  buffer_load_dwordx4 v12, s[12:15], s81 offen lds
  s_mov_b32 exec_hi, -1
  s_waitcnt lgkmcnt(8)
  v_mfma_f32_16x16x32_bf16 v[128:131], v[184:187], v[88:91], v[128:131]
  ds_read_b64_tr_b16 v[176:177], v7 offset:43008
  v_mfma_f32_16x16x32_bf16 v[132:135], v[188:191], v[88:91], v[132:135]
  ds_read_b64_tr_b16 v[178:179], v7 offset:43120
  v_mfma_f32_16x16x32_bf16 v[136:139], v[184:187], v[92:95], v[136:139]
  ds_read_b64_tr_b16 v[180:181], v7 offset:43040
  v_mfma_f32_16x16x32_bf16 v[140:143], v[188:191], v[92:95], v[140:143]
  ds_read_b64_tr_b16 v[182:183], v7 offset:43152
  s_add_u32 s81, s75, 215040
  s_add_u32 m0, s76, 109312
  s_mov_b32 exec_hi, 0x00ffffff
  buffer_load_dwordx4 v12, s[12:15], s81 offen lds
  s_mov_b32 exec_hi, -1
  s_waitcnt lgkmcnt(8)
  v_mfma_f32_16x16x32_bf16 v[128:131], v[192:195], v[96:99], v[128:131]
  ds_read_b64_tr_b16 v[184:185], v7 offset:46592
  v_mfma_f32_16x16x32_bf16 v[132:135], v[196:199], v[96:99], v[132:135]
  ds_read_b64_tr_b16 v[186:187], v7 offset:46704
  v_mfma_f32_16x16x32_bf16 v[136:139], v[192:195], v[100:103], v[136:139]
  ds_read_b64_tr_b16 v[188:189], v7 offset:46624
  v_mfma_f32_16x16x32_bf16 v[140:143], v[196:199], v[100:103], v[140:143]
  ds_read_b64_tr_b16 v[190:191], v7 offset:46736
  s_add_u32 s81, s75, 236544
  s_add_u32 m0, s76, 110208
  s_mov_b32 exec_hi, 0x00ffffff
  buffer_load_dwordx4 v12, s[12:15], s81 offen lds
  s_mov_b32 exec_hi, -1
  s_waitcnt lgkmcnt(8)
  v_mfma_f32_16x16x32_bf16 v[128:131], v[200:203], v[104:107], v[128:131]
  v_mfma_f32_16x16x32_bf16 v[132:135], v[204:207], v[104:107], v[132:135]
  v_mfma_f32_16x16x32_bf16 v[136:139], v[200:203], v[108:111], v[136:139]
  v_mfma_f32_16x16x32_bf16 v[140:143], v[204:207], v[108:111], v[140:143]
  s_add_u32 s81, s75, 258048
  s_add_u32 m0, s76, 111104
  s_mov_b32 exec_hi, 0x00ffffff
  buffer_load_dwordx4 v12, s[12:15], s81 offen lds
  s_mov_b32 exec_hi, -1
  s_waitcnt lgkmcnt(4)
  v_mfma_f32_16x16x32_bf16 v[128:131], v[176:179], v[112:115], v[128:131]
  v_mfma_f32_16x16x32_bf16 v[132:135], v[180:183], v[112:115], v[132:135]
  v_mfma_f32_16x16x32_bf16 v[136:139], v[176:179], v[116:119], v[136:139]
  v_mfma_f32_16x16x32_bf16 v[140:143], v[180:183], v[116:119], v[140:143]
  s_add_u32 s81, s75, 279552
  s_add_u32 m0, s76, 112000
  s_mov_b32 exec_hi, 0x00ffffff
  buffer_load_dwordx4 v12, s[12:15], s81 offen lds
  s_mov_b32 exec_hi, -1
  s_waitcnt lgkmcnt(0)
  v_mfma_f32_16x16x32_bf16 v[128:131], v[184:187], v[120:123], v[128:131]
  v_mfma_f32_16x16x32_bf16 v[132:135], v[188:191], v[120:123], v[132:135]
  v_mfma_f32_16x16x32_bf16 v[136:139], v[184:187], v[124:127], v[136:139]
  v_mfma_f32_16x16x32_bf16 v[140:143], v[188:191], v[124:127], v[140:143]
  s_waitcnt vmcnt(14)
  s_barrier
  s_nop 2
  v_cvt_pk_bf16_f32 v208, v128, v129
  v_cvt_pk_bf16_f32 v209, v130, v131
  v_cvt_pk_bf16_f32 v210, v132, v133
  v_cvt_pk_bf16_f32 v211, v134, v135
  v_and_b32 v210, v13, v210
  v_and_b32 v211, v13, v211
  buffer_store_dwordx4 v[208:211], v2, s[48:51], s60 offen offset:0 sc1
  v_cvt_pk_bf16_f32 v212, v136, v137
  v_cvt_pk_bf16_f32 v213, v138, v139
  v_cvt_pk_bf16_f32 v214, v140, v141
  v_cvt_pk_bf16_f32 v215, v142, v143
  v_and_b32 v214, v13, v214
  v_and_b32 v215, v13, v215
  buffer_store_dwordx4 v[212:215], v2, s[48:51], s60 offen offset:1024 sc1
  s_lshl_b32 s82, s52, 6
  v_add_u32 v10, s82, v1
  v_min_u32 v10, 223, v10
  v_lshlrev_b32 v9, 4, v10
  s_mov_b32 s92, 4096
  s_mov_b32 s93, 36352
  buffer_load_dwordx4 v[232:235], v2, s[48:51], s92 offen offset:0 sc1
  buffer_load_dwordx4 v[236:239], v2, s[48:51], s92 offen offset:1024 sc1
  buffer_load_dwordx4 v[240:243], v2, s[48:51], s92 offen offset:2048 sc1
  buffer_load_dwordx4 v[244:247], v9, s[48:51], s93 offen sc1
  buffer_load_dwordx4 v[248:251], v9, s[48:51], s93 offen offset:3584 sc1
  v_add_u32 v7, 50176, v6
  ds_read_b64_tr_b16 v[176:177], v7 offset:0
  ds_read_b64_tr_b16 v[178:179], v7 offset:112
  ds_read_b64_tr_b16 v[180:181], v7 offset:32
  ds_read_b64_tr_b16 v[182:183], v7 offset:144
  ds_read_b64_tr_b16 v[184:185], v7 offset:3584
  ds_read_b64_tr_b16 v[186:187], v7 offset:3696
  ds_read_b64_tr_b16 v[188:189], v7 offset:3616
  ds_read_b64_tr_b16 v[190:191], v7 offset:3728
  ds_read_b64_tr_b16 v[192:193], v7 offset:7168
  ds_read_b64_tr_b16 v[194:195], v7 offset:7280
  ds_read_b64_tr_b16 v[196:197], v7 offset:7200
  ds_read_b64_tr_b16 v[198:199], v7 offset:7312
  s_waitcnt lgkmcnt(8)
  v_mfma_f32_16x16x32_bf16 v[144:147], v[16:19], v[176:179], 0
  ds_read_b64_tr_b16 v[200:201], v7 offset:10752
  v_mfma_f32_16x16x32_bf16 v[148:151], v[16:19], v[180:183], 0
  ds_read_b64_tr_b16 v[202:203], v7 offset:10864
  v_mfma_f32_16x16x32_bf16 v[152:155], v[20:23], v[176:179], 0
  ds_read_b64_tr_b16 v[204:205], v7 offset:10784
  v_mfma_f32_16x16x32_bf16 v[156:159], v[20:23], v[180:183], 0
  ds_read_b64_tr_b16 v[206:207], v7 offset:10896
  s_waitcnt lgkmcnt(8)
  v_mfma_f32_16x16x32_bf16 v[144:147], v[24:27], v[184:187], v[144:147]
  ds_read_b64_tr_b16 v[176:177], v7 offset:14336
  v_mfma_f32_16x16x32_bf16 v[148:151], v[24:27], v[188:191], v[148:151]
  ds_read_b64_tr_b16 v[178:179], v7 offset:14448
  v_mfma_f32_16x16x32_bf16 v[152:155], v[28:31], v[184:187], v[152:155]
  ds_read_b64_tr_b16 v[180:181], v7 offset:14368
  v_mfma_f32_16x16x32_bf16 v[156:159], v[28:31], v[188:191], v[156:159]
  ds_read_b64_tr_b16 v[182:183], v7 offset:14480
  s_waitcnt lgkmcnt(8)
  v_mfma_f32_16x16x32_bf16 v[144:147], v[32:35], v[192:195], v[144:147]
  ds_read_b64_tr_b16 v[184:185], v7 offset:17920
  v_mfma_f32_16x16x32_bf16 v[148:151], v[32:35], v[196:199], v[148:151]
  ds_read_b64_tr_b16 v[186:187], v7 offset:18032
  v_mfma_f32_16x16x32_bf16 v[152:155], v[36:39], v[192:195], v[152:155]
  ds_read_b64_tr_b16 v[188:189], v7 offset:17952
  v_mfma_f32_16x16x32_bf16 v[156:159], v[36:39], v[196:199], v[156:159]
  ds_read_b64_tr_b16 v[190:191], v7 offset:18064
  s_waitcnt lgkmcnt(8)
  v_mfma_f32_16x16x32_bf16 v[144:147], v[40:43], v[200:203], v[144:147]
  ds_read_b64_tr_b16 v[192:193], v7 offset:21504
  v_mfma_f32_16x16x32_bf16 v[148:151], v[40:43], v[204:207], v[148:151]
  ds_read_b64_tr_b16 v[194:195], v7 offset:21616
  v_mfma_f32_16x16x32_bf16 v[152:155], v[44:47], v[200:203], v[152:155]
  ds_read_b64_tr_b16 v[196:197], v7 offset:21536
  v_mfma_f32_16x16x32_bf16 v[156:159], v[44:47], v[204:207], v[156:159]
  ds_read_b64_tr_b16 v[198:199], v7 offset:21648
  s_waitcnt lgkmcnt(8)
  v_mfma_f32_16x16x32_bf16 v[144:147], v[48:51], v[176:179], v[144:147]
  ds_read_b64_tr_b16 v[200:201], v7 offset:25088
  v_mfma_f32_16x16x32_bf16 v[148:151], v[48:51], v[180:183], v[148:151]
  ds_read_b64_tr_b16 v[202:203], v7 offset:25200
  v_mfma_f32_16x16x32_bf16 v[152:155], v[52:55], v[176:179], v[152:155]
  ds_read_b64_tr_b16 v[204:205], v7 offset:25120
  v_mfma_f32_16x16x32_bf16 v[156:159], v[52:55], v[180:183], v[156:159]
  ds_read_b64_tr_b16 v[206:207], v7 offset:25232
  s_waitcnt lgkmcnt(8)
  v_mfma_f32_16x16x32_bf16 v[144:147], v[56:59], v[184:187], v[144:147]
  ds_read_b64_tr_b16 v[176:177], v7 offset:28672
  v_mfma_f32_16x16x32_bf16 v[148:151], v[56:59], v[188:191], v[148:151]
  ds_read_b64_tr_b16 v[178:179], v7 offset:28784
  v_mfma_f32_16x16x32_bf16 v[152:155], v[60:63], v[184:187], v[152:155]
  ds_read_b64_tr_b16 v[180:181], v7 offset:28704
  v_mfma_f32_16x16x32_bf16 v[156:159], v[60:63], v[188:191], v[156:159]
  ds_read_b64_tr_b16 v[182:183], v7 offset:28816
  s_waitcnt lgkmcnt(8)
  v_mfma_f32_16x16x32_bf16 v[144:147], v[64:67], v[192:195], v[144:147]
  ds_read_b64_tr_b16 v[184:185], v7 offset:32256
  v_mfma_f32_16x16x32_bf16 v[148:151], v[64:67], v[196:199], v[148:151]
  ds_read_b64_tr_b16 v[186:187], v7 offset:32368
  v_mfma_f32_16x16x32_bf16 v[152:155], v[68:71], v[192:195], v[152:155]
  ds_read_b64_tr_b16 v[188:189], v7 offset:32288
  v_mfma_f32_16x16x32_bf16 v[156:159], v[68:71], v[196:199], v[156:159]
  ds_read_b64_tr_b16 v[190:191], v7 offset:32400
  s_waitcnt lgkmcnt(8)
  v_mfma_f32_16x16x32_bf16 v[144:147], v[72:75], v[200:203], v[144:147]
  ds_read_b64_tr_b16 v[192:193], v7 offset:35840
  v_mfma_f32_16x16x32_bf16 v[148:151], v[72:75], v[204:207], v[148:151]
  ds_read_b64_tr_b16 v[194:195], v7 offset:35952
  v_mfma_f32_16x16x32_bf16 v[152:155], v[76:79], v[200:203], v[152:155]
  ds_read_b64_tr_b16 v[196:197], v7 offset:35872
  v_mfma_f32_16x16x32_bf16 v[156:159], v[76:79], v[204:207], v[156:159]
  ds_read_b64_tr_b16 v[198:199], v7 offset:35984
  s_waitcnt lgkmcnt(8)
  v_mfma_f32_16x16x32_bf16 v[144:147], v[80:83], v[176:179], v[144:147]
  ds_read_b64_tr_b16 v[200:201], v7 offset:39424
  v_mfma_f32_16x16x32_bf16 v[148:151], v[80:83], v[180:183], v[148:151]
  ds_read_b64_tr_b16 v[202:203], v7 offset:39536
  v_mfma_f32_16x16x32_bf16 v[152:155], v[84:87], v[176:179], v[152:155]
  ds_read_b64_tr_b16 v[204:205], v7 offset:39456
  v_mfma_f32_16x16x32_bf16 v[156:159], v[84:87], v[180:183], v[156:159]
  ds_read_b64_tr_b16 v[206:207], v7 offset:39568
  s_waitcnt lgkmcnt(8)
  v_mfma_f32_16x16x32_bf16 v[144:147], v[88:91], v[184:187], v[144:147]
  ds_read_b64_tr_b16 v[176:177], v7 offset:43008
  v_mfma_f32_16x16x32_bf16 v[148:151], v[88:91], v[188:191], v[148:151]
  ds_read_b64_tr_b16 v[178:179], v7 offset:43120
  v_mfma_f32_16x16x32_bf16 v[152:155], v[92:95], v[184:187], v[152:155]
  ds_read_b64_tr_b16 v[180:181], v7 offset:43040
  v_mfma_f32_16x16x32_bf16 v[156:159], v[92:95], v[188:191], v[156:159]
  ds_read_b64_tr_b16 v[182:183], v7 offset:43152
  s_waitcnt lgkmcnt(8)
  v_mfma_f32_16x16x32_bf16 v[144:147], v[96:99], v[192:195], v[144:147]
  ds_read_b64_tr_b16 v[184:185], v7 offset:46592
  v_mfma_f32_16x16x32_bf16 v[148:151], v[96:99], v[196:199], v[148:151]
  ds_read_b64_tr_b16 v[186:187], v7 offset:46704
  v_mfma_f32_16x16x32_bf16 v[152:155], v[100:103], v[192:195], v[152:155]
  ds_read_b64_tr_b16 v[188:189], v7 offset:46624
  v_mfma_f32_16x16x32_bf16 v[156:159], v[100:103], v[196:199], v[156:159]
  ds_read_b64_tr_b16 v[190:191], v7 offset:46736
  s_waitcnt lgkmcnt(8)
  v_mfma_f32_16x16x32_bf16 v[144:147], v[104:107], v[200:203], v[144:147]
  v_mfma_f32_16x16x32_bf16 v[148:151], v[104:107], v[204:207], v[148:151]
  v_mfma_f32_16x16x32_bf16 v[152:155], v[108:111], v[200:203], v[152:155]
  v_mfma_f32_16x16x32_bf16 v[156:159], v[108:111], v[204:207], v[156:159]
  s_waitcnt lgkmcnt(4)
  v_mfma_f32_16x16x32_bf16 v[144:147], v[112:115], v[176:179], v[144:147]
  v_mfma_f32_16x16x32_bf16 v[148:151], v[112:115], v[180:183], v[148:151]
  v_mfma_f32_16x16x32_bf16 v[152:155], v[116:119], v[176:179], v[152:155]
  v_mfma_f32_16x16x32_bf16 v[156:159], v[116:119], v[180:183], v[156:159]
  s_waitcnt lgkmcnt(0)
  v_mfma_f32_16x16x32_bf16 v[144:147], v[120:123], v[184:187], v[144:147]
  v_mfma_f32_16x16x32_bf16 v[148:151], v[120:123], v[188:191], v[148:151]
  v_mfma_f32_16x16x32_bf16 v[152:155], v[124:127], v[184:187], v[152:155]
  v_mfma_f32_16x16x32_bf16 v[156:159], v[124:127], v[188:191], v[156:159]
  s_waitcnt vmcnt(7)
  s_barrier
  s_nop 2
  v_cvt_pk_bf16_f32 v216, v144, v145
  v_cvt_pk_bf16_f32 v217, v146, v147
  v_cvt_pk_bf16_f32 v218, v152, v153
  v_cvt_pk_bf16_f32 v219, v154, v155
  buffer_store_dwordx4 v[216:219], v2, s[48:51], s60 offen offset:2048 sc1
  v_cvt_pk_bf16_f32 v220, v148, v149
  v_cvt_pk_bf16_f32 v221, v150, v151
  v_cvt_pk_bf16_f32 v222, v156, v157
  v_cvt_pk_bf16_f32 v223, v158, v159
  v_and_or_b32 v220, v220, v14, v15
  v_and_or_b32 v221, v221, v14, v15
  v_and_or_b32 v222, v222, v14, v15
  v_and_or_b32 v223, v223, v14, v15
  buffer_store_dwordx4 v[220:223], v2, s[48:51], s60 offen offset:3072 sc1
  v_add_u32 v7, 100352, v6
  ds_read_b64_tr_b16 v[176:177], v7 offset:0
  ds_read_b64_tr_b16 v[178:179], v7 offset:112
  ds_read_b64_tr_b16 v[180:181], v7 offset:32
  ds_read_b64_tr_b16 v[182:183], v7 offset:144
  ds_read_b64_tr_b16 v[184:185], v7 offset:3584
  ds_read_b64_tr_b16 v[186:187], v7 offset:3696
  ds_read_b64_tr_b16 v[188:189], v7 offset:3616
  ds_read_b64_tr_b16 v[190:191], v7 offset:3728
  ds_read_b64_tr_b16 v[192:193], v7 offset:7168
  ds_read_b64_tr_b16 v[194:195], v7 offset:7280
  ds_read_b64_tr_b16 v[196:197], v7 offset:7200
  ds_read_b64_tr_b16 v[198:199], v7 offset:7312
  s_waitcnt lgkmcnt(8)
  v_mfma_f32_16x16x32_bf16 v[160:163], v[176:179], v[16:19], 0
  ds_read_b64_tr_b16 v[200:201], v7 offset:10752
  v_mfma_f32_16x16x32_bf16 v[164:167], v[180:183], v[16:19], 0
  ds_read_b64_tr_b16 v[202:203], v7 offset:10864
  v_mfma_f32_16x16x32_bf16 v[168:171], v[176:179], v[20:23], 0
  ds_read_b64_tr_b16 v[204:205], v7 offset:10784
  v_mfma_f32_16x16x32_bf16 v[172:175], v[180:183], v[20:23], 0
  ds_read_b64_tr_b16 v[206:207], v7 offset:10896
  s_waitcnt lgkmcnt(8)
  v_mfma_f32_16x16x32_bf16 v[160:163], v[184:187], v[24:27], v[160:163]
  ds_read_b64_tr_b16 v[176:177], v7 offset:14336
  v_mfma_f32_16x16x32_bf16 v[164:167], v[188:191], v[24:27], v[164:167]
  ds_read_b64_tr_b16 v[178:179], v7 offset:14448
  v_mfma_f32_16x16x32_bf16 v[168:171], v[184:187], v[28:31], v[168:171]
  ds_read_b64_tr_b16 v[180:181], v7 offset:14368
  v_mfma_f32_16x16x32_bf16 v[172:175], v[188:191], v[28:31], v[172:175]
  ds_read_b64_tr_b16 v[182:183], v7 offset:14480
  s_waitcnt lgkmcnt(8)
  v_mfma_f32_16x16x32_bf16 v[160:163], v[192:195], v[32:35], v[160:163]
  ds_read_b64_tr_b16 v[184:185], v7 offset:17920
  v_mfma_f32_16x16x32_bf16 v[164:167], v[196:199], v[32:35], v[164:167]
  ds_read_b64_tr_b16 v[186:187], v7 offset:18032
  v_mfma_f32_16x16x32_bf16 v[168:171], v[192:195], v[36:39], v[168:171]
  ds_read_b64_tr_b16 v[188:189], v7 offset:17952
  v_mfma_f32_16x16x32_bf16 v[172:175], v[196:199], v[36:39], v[172:175]
  ds_read_b64_tr_b16 v[190:191], v7 offset:18064
  s_waitcnt lgkmcnt(8)
  v_mfma_f32_16x16x32_bf16 v[160:163], v[200:203], v[40:43], v[160:163]
  ds_read_b64_tr_b16 v[192:193], v7 offset:21504
  v_mfma_f32_16x16x32_bf16 v[164:167], v[204:207], v[40:43], v[164:167]
  ds_read_b64_tr_b16 v[194:195], v7 offset:21616
  v_mfma_f32_16x16x32_bf16 v[168:171], v[200:203], v[44:47], v[168:171]
  ds_read_b64_tr_b16 v[196:197], v7 offset:21536
  v_mfma_f32_16x16x32_bf16 v[172:175], v[204:207], v[44:47], v[172:175]
  ds_read_b64_tr_b16 v[198:199], v7 offset:21648
  s_waitcnt lgkmcnt(8)
  v_mfma_f32_16x16x32_bf16 v[160:163], v[176:179], v[48:51], v[160:163]
  ds_read_b64_tr_b16 v[200:201], v7 offset:25088
  v_mfma_f32_16x16x32_bf16 v[164:167], v[180:183], v[48:51], v[164:167]
  ds_read_b64_tr_b16 v[202:203], v7 offset:25200
  v_mfma_f32_16x16x32_bf16 v[168:171], v[176:179], v[52:55], v[168:171]
  ds_read_b64_tr_b16 v[204:205], v7 offset:25120
  v_mfma_f32_16x16x32_bf16 v[172:175], v[180:183], v[52:55], v[172:175]
  ds_read_b64_tr_b16 v[206:207], v7 offset:25232
  s_waitcnt lgkmcnt(8)
  v_mfma_f32_16x16x32_bf16 v[160:163], v[184:187], v[56:59], v[160:163]
  ds_read_b64_tr_b16 v[176:177], v7 offset:28672
  v_mfma_f32_16x16x32_bf16 v[164:167], v[188:191], v[56:59], v[164:167]
  ds_read_b64_tr_b16 v[178:179], v7 offset:28784
  v_mfma_f32_16x16x32_bf16 v[168:171], v[184:187], v[60:63], v[168:171]
  ds_read_b64_tr_b16 v[180:181], v7 offset:28704
  v_mfma_f32_16x16x32_bf16 v[172:175], v[188:191], v[60:63], v[172:175]
  ds_read_b64_tr_b16 v[182:183], v7 offset:28816
  s_waitcnt lgkmcnt(8)
  v_mfma_f32_16x16x32_bf16 v[160:163], v[192:195], v[64:67], v[160:163]
  ds_read_b64_tr_b16 v[184:185], v7 offset:32256
  v_mfma_f32_16x16x32_bf16 v[164:167], v[196:199], v[64:67], v[164:167]
  ds_read_b64_tr_b16 v[186:187], v7 offset:32368
  v_mfma_f32_16x16x32_bf16 v[168:171], v[192:195], v[68:71], v[168:171]
  ds_read_b64_tr_b16 v[188:189], v7 offset:32288
  v_mfma_f32_16x16x32_bf16 v[172:175], v[196:199], v[68:71], v[172:175]
  ds_read_b64_tr_b16 v[190:191], v7 offset:32400
  s_waitcnt lgkmcnt(8)
  v_mfma_f32_16x16x32_bf16 v[160:163], v[200:203], v[72:75], v[160:163]
  ds_read_b64_tr_b16 v[192:193], v7 offset:35840
  v_mfma_f32_16x16x32_bf16 v[164:167], v[204:207], v[72:75], v[164:167]
  ds_read_b64_tr_b16 v[194:195], v7 offset:35952
  v_mfma_f32_16x16x32_bf16 v[168:171], v[200:203], v[76:79], v[168:171]
  ds_read_b64_tr_b16 v[196:197], v7 offset:35872
  v_mfma_f32_16x16x32_bf16 v[172:175], v[204:207], v[76:79], v[172:175]
  ds_read_b64_tr_b16 v[198:199], v7 offset:35984
  s_waitcnt lgkmcnt(8)
  v_mfma_f32_16x16x32_bf16 v[160:163], v[176:179], v[80:83], v[160:163]
  ds_read_b64_tr_b16 v[200:201], v7 offset:39424
  v_mfma_f32_16x16x32_bf16 v[164:167], v[180:183], v[80:83], v[164:167]
  ds_read_b64_tr_b16 v[202:203], v7 offset:39536
  v_mfma_f32_16x16x32_bf16 v[168:171], v[176:179], v[84:87], v[168:171]
  ds_read_b64_tr_b16 v[204:205], v7 offset:39456
  v_mfma_f32_16x16x32_bf16 v[172:175], v[180:183], v[84:87], v[172:175]
  ds_read_b64_tr_b16 v[206:207], v7 offset:39568
  s_waitcnt lgkmcnt(8)
  v_mfma_f32_16x16x32_bf16 v[160:163], v[184:187], v[88:91], v[160:163]
  ds_read_b64_tr_b16 v[176:177], v7 offset:43008
  v_mfma_f32_16x16x32_bf16 v[164:167], v[188:191], v[88:91], v[164:167]
  ds_read_b64_tr_b16 v[178:179], v7 offset:43120
  v_mfma_f32_16x16x32_bf16 v[168:171], v[184:187], v[92:95], v[168:171]
  ds_read_b64_tr_b16 v[180:181], v7 offset:43040
  v_mfma_f32_16x16x32_bf16 v[172:175], v[188:191], v[92:95], v[172:175]
  ds_read_b64_tr_b16 v[182:183], v7 offset:43152
  s_waitcnt lgkmcnt(8)
  v_mfma_f32_16x16x32_bf16 v[160:163], v[192:195], v[96:99], v[160:163]
  ds_read_b64_tr_b16 v[184:185], v7 offset:46592
  v_mfma_f32_16x16x32_bf16 v[164:167], v[196:199], v[96:99], v[164:167]
  ds_read_b64_tr_b16 v[186:187], v7 offset:46704
  v_mfma_f32_16x16x32_bf16 v[168:171], v[192:195], v[100:103], v[168:171]
  ds_read_b64_tr_b16 v[188:189], v7 offset:46624
  v_mfma_f32_16x16x32_bf16 v[172:175], v[196:199], v[100:103], v[172:175]
  ds_read_b64_tr_b16 v[190:191], v7 offset:46736
  s_waitcnt lgkmcnt(8)
  v_mfma_f32_16x16x32_bf16 v[160:163], v[200:203], v[104:107], v[160:163]
  v_mfma_f32_16x16x32_bf16 v[164:167], v[204:207], v[104:107], v[164:167]
  v_mfma_f32_16x16x32_bf16 v[168:171], v[200:203], v[108:111], v[168:171]
  v_mfma_f32_16x16x32_bf16 v[172:175], v[204:207], v[108:111], v[172:175]
  s_waitcnt lgkmcnt(4)
  v_mfma_f32_16x16x32_bf16 v[160:163], v[176:179], v[112:115], v[160:163]
  v_mfma_f32_16x16x32_bf16 v[164:167], v[180:183], v[112:115], v[164:167]
  v_mfma_f32_16x16x32_bf16 v[168:171], v[176:179], v[116:119], v[168:171]
  v_mfma_f32_16x16x32_bf16 v[172:175], v[180:183], v[116:119], v[172:175]
  s_waitcnt lgkmcnt(0)
  v_mfma_f32_16x16x32_bf16 v[160:163], v[184:187], v[120:123], v[160:163]
  v_mfma_f32_16x16x32_bf16 v[164:167], v[188:191], v[120:123], v[164:167]
  v_mfma_f32_16x16x32_bf16 v[168:171], v[184:187], v[124:127], v[168:171]
  v_mfma_f32_16x16x32_bf16 v[172:175], v[188:191], v[124:127], v[172:175]
  s_waitcnt vmcnt(0)
  v_mov_b32 v5, s55
  s_mov_b64 exec, 1
  buffer_store_dword v5, off, s[48:51], s61 sc1
  s_mov_b64 exec, -1
  v_xor_b32 v232, s55, v232
  v_xor_b32 v233, s55, v233
  v_xor_b32 v234, s55, v234
  v_xor_b32 v235, s55, v235
  v_xor_b32 v236, s55, v236
  v_xor_b32 v237, s55, v237
  v_xor_b32 v238, s55, v238
  v_xor_b32 v239, s55, v239
  v_xor_b32 v240, s55, v240
  v_xor_b32 v241, s55, v241
  v_xor_b32 v242, s55, v242
  v_xor_b32 v243, s55, v243
  v_xor_b32 v245, s55, v245
  v_xor_b32 v247, s55, v247
  v_xor_b32 v249, s55, v249
  v_xor_b32 v251, s55, v251
  v_or3_b32 v232, v232, v233, v234
  v_or3_b32 v232, v232, v235, v236
  v_or3_b32 v232, v232, v237, v238
  v_or3_b32 v232, v232, v239, v240
  v_or3_b32 v232, v232, v241, v242
  v_or3_b32 v232, v232, v243, v245
  v_or3_b32 v232, v232, v247, v249
  v_or_b32 v232, v232, v251
  v_cmp_ne_u32 vcc, 0, v232
  s_nop 3
  s_cmp_eq_u64 vcc, 0
  s_cbranch_scc1 L_lateok_3
  s_mov_b32 s92, 4096
  s_mov_b32 s93, 36352
  s_mov_b32 s101, 0
L_late_4:
  buffer_load_dwordx4 v[232:235], v2, s[48:51], s92 offen offset:0 sc1
  buffer_load_dwordx4 v[236:239], v2, s[48:51], s92 offen offset:1024 sc1
  buffer_load_dwordx4 v[240:243], v2, s[48:51], s92 offen offset:2048 sc1
  buffer_load_dwordx4 v[244:247], v9, s[48:51], s93 offen offset:0 sc1
  buffer_load_dwordx4 v[248:251], v9, s[48:51], s93 offen offset:3584 sc1
  s_waitcnt vmcnt(0)
  v_xor_b32 v232, s55, v232
  v_xor_b32 v233, s55, v233
  v_xor_b32 v234, s55, v234
  v_xor_b32 v235, s55, v235
  v_xor_b32 v236, s55, v236
  v_xor_b32 v237, s55, v237
  v_xor_b32 v238, s55, v238
  v_xor_b32 v239, s55, v239
  v_xor_b32 v240, s55, v240
  v_xor_b32 v241, s55, v241
  v_xor_b32 v242, s55, v242
  v_xor_b32 v243, s55, v243
  v_xor_b32 v245, s55, v245
  v_xor_b32 v247, s55, v247
  v_xor_b32 v249, s55, v249
  v_xor_b32 v251, s55, v251
  v_or3_b32 v232, v232, v233, v234
  v_or3_b32 v232, v232, v235, v236
  v_or3_b32 v232, v232, v237, v238
  v_or3_b32 v232, v232, v239, v240
  v_or3_b32 v232, v232, v241, v242
  v_or3_b32 v232, v232, v243, v245
  v_or3_b32 v232, v232, v247, v249
  v_or_b32 v232, v232, v251
  v_cmp_ne_u32 vcc, 0, v232
  s_nop 3
  s_cmp_eq_u64 vcc, 0
  s_cbranch_scc1 L_lateok_5
  s_add_u32 s101, s101, 1
  s_cmp_lt_u32 s101, 131072
  s_cbranch_scc1 L_late_4
  v_mov_b32 v5, 5
  v_mov_b32 v6, 0
  buffer_store_dword v5, v6, s[4:7], 0 offen
  s_nop 0
L_lateok_5:
L_lateok_3:
  v_lshlrev_b32 v10, 3, v10
  v_add_u32 v10, 157696, v10
  v_mov_b32 v245, v246
  v_mov_b32 v249, v250
  ds_write_b64 v10, v[244:245]
  ds_write_b64 v10, v[248:249] offset:1792
  s_mov_b32 s82, 0x3e8b97f6
  v_mul_f32 v160, s82, v160
  v_mul_f32 v161, s82, v161
  v_mul_f32 v162, s82, v162
  v_mul_f32 v163, s82, v163
  v_cvt_pk_bf16_f32 v224, v160, v161
  v_cvt_pk_bf16_f32 v225, v162, v163
  v_mul_f32 v164, s82, v164
  v_mul_f32 v165, s82, v165
  v_mul_f32 v166, s82, v166
  v_mul_f32 v167, s82, v167
  v_cvt_pk_bf16_f32 v226, v164, v165
  v_cvt_pk_bf16_f32 v227, v166, v167
  v_and_b32 v226, v13, v226
  v_and_b32 v227, v13, v227
  v_mul_f32 v168, s82, v168
  v_mul_f32 v169, s82, v169
  v_mul_f32 v170, s82, v170
  v_mul_f32 v171, s82, v171
  v_cvt_pk_bf16_f32 v228, v168, v169
  v_cvt_pk_bf16_f32 v229, v170, v171
  v_mul_f32 v172, s82, v172
  v_mul_f32 v173, s82, v173
  v_mul_f32 v174, s82, v174
  v_mul_f32 v175, s82, v175
  v_cvt_pk_bf16_f32 v230, v172, v173
  v_cvt_pk_bf16_f32 v231, v174, v175
  v_and_b32 v230, v13, v230
  v_and_b32 v231, v13, v231
  s_waitcnt lgkmcnt(0)
  s_barrier
  v_lshrrev_b32 v5, 2, v3
  v_sub_u32 v5, v5, v4
  v_lshlrev_b32 v5, 3, v5
  v_and_b32 v6, 3, v3
  v_add_u32 v5, v5, v6
  v_mov_b32 v6, 0xf149f2ca
  v_mov_b32 v7, 0
  v_cmp_le_i32 s[82:83], 0, v5
  v_cmp_le_i32 s[84:85], 1, v5
  v_cmp_le_i32 s[86:87], 2, v5
  v_cmp_le_i32 s[88:89], 3, v5
  v_cndmask_b32 v144, v6, v7, s[82:83]
  v_cndmask_b32 v16, v7, v6, s[82:83]
  v_cndmask_b32 v145, v6, v7, s[84:85]
  v_cndmask_b32 v17, v7, v6, s[84:85]
  v_cndmask_b32 v146, v6, v7, s[86:87]
  v_cndmask_b32 v18, v7, v6, s[86:87]
  v_cndmask_b32 v147, v6, v7, s[88:89]
  v_cndmask_b32 v19, v7, v6, s[88:89]
  v_cmp_le_i32 s[82:83], 4, v5
  v_cmp_le_i32 s[84:85], 5, v5
  v_cmp_le_i32 s[86:87], 6, v5
  v_cmp_le_i32 s[88:89], 7, v5
  v_cndmask_b32 v148, v6, v7, s[82:83]
  v_cndmask_b32 v20, v7, v6, s[82:83]
  v_cndmask_b32 v149, v6, v7, s[84:85]
  v_cndmask_b32 v21, v7, v6, s[84:85]
  v_cndmask_b32 v150, v6, v7, s[86:87]
  v_cndmask_b32 v22, v7, v6, s[86:87]
  v_cndmask_b32 v151, v6, v7, s[88:89]
  v_cndmask_b32 v23, v7, v6, s[88:89]
  v_cmp_le_i32 s[82:83], -4, v5
  v_cmp_le_i32 s[84:85], -3, v5
  v_cmp_le_i32 s[86:87], -2, v5
  v_cmp_le_i32 s[88:89], -1, v5
  v_cndmask_b32 v152, v6, v7, s[82:83]
  v_cndmask_b32 v24, v7, v6, s[82:83]
  v_cndmask_b32 v153, v6, v7, s[84:85]
  v_cndmask_b32 v25, v7, v6, s[84:85]
  v_cndmask_b32 v154, v6, v7, s[86:87]
  v_cndmask_b32 v26, v7, v6, s[86:87]
  v_cndmask_b32 v155, v6, v7, s[88:89]
  v_cndmask_b32 v27, v7, v6, s[88:89]
  v_cmp_le_i32 s[82:83], 0, v5
  v_cmp_le_i32 s[84:85], 1, v5
  v_cmp_le_i32 s[86:87], 2, v5
  v_cmp_le_i32 s[88:89], 3, v5
  v_cndmask_b32 v156, v6, v7, s[82:83]
  v_cndmask_b32 v28, v7, v6, s[82:83]
  v_cndmask_b32 v157, v6, v7, s[84:85]
  v_cndmask_b32 v29, v7, v6, s[84:85]
  v_cndmask_b32 v158, v6, v7, s[86:87]
  v_cndmask_b32 v30, v7, v6, s[86:87]
  v_cndmask_b32 v159, v6, v7, s[88:89]
  v_cndmask_b32 v31, v7, v6, s[88:89]
  s_add_u32 s82, s59, 0
  s_cmp_ge_u32 s82, 8
  s_cselect_b32 s83, 0, 0xf149f2ca
  v_min_f32 v16, s83, v16
  v_min_f32 v17, s83, v17
  v_min_f32 v18, s83, v18
  v_min_f32 v19, s83, v19
  v_min_f32 v20, s83, v20
  v_min_f32 v21, s83, v21
  v_min_f32 v22, s83, v22
  v_min_f32 v23, s83, v23
  v_min_f32 v24, s83, v24
  v_min_f32 v25, s83, v25
  v_min_f32 v26, s83, v26
  v_min_f32 v27, s83, v27
  v_min_f32 v28, s83, v28
  v_min_f32 v29, s83, v29
  v_min_f32 v30, s83, v30
  v_min_f32 v31, s83, v31
  s_add_u32 s82, s59, 1
  s_cmp_ge_u32 s82, 8
  s_cselect_b32 s83, 0, 0xf149f2ca
  v_mov_b32 v32, s83
  v_mov_b32 v33, s83
  v_mov_b32 v34, s83
  v_mov_b32 v35, s83
  v_mov_b32 v36, s83
  v_mov_b32 v37, s83
  v_mov_b32 v38, s83
  v_mov_b32 v39, s83
  v_mov_b32 v40, s83
  v_mov_b32 v41, s83
  v_mov_b32 v42, s83
  v_mov_b32 v43, s83
  v_mov_b32 v44, s83
  v_mov_b32 v45, s83
  v_mov_b32 v46, s83
  v_mov_b32 v47, s83
  s_add_u32 s82, s59, 2
  s_cmp_ge_u32 s82, 8
  s_cselect_b32 s83, 0, 0xf149f2ca
  v_mov_b32 v48, s83
  v_mov_b32 v49, s83
  v_mov_b32 v50, s83
  v_mov_b32 v51, s83
  v_mov_b32 v52, s83
  v_mov_b32 v53, s83
  v_mov_b32 v54, s83
  v_mov_b32 v55, s83
  v_mov_b32 v56, s83
  v_mov_b32 v57, s83
  v_mov_b32 v58, s83
  v_mov_b32 v59, s83
  v_mov_b32 v60, s83
  v_mov_b32 v61, s83
  v_mov_b32 v62, s83
  v_mov_b32 v63, s83
  s_add_u32 s82, s59, 3
  s_cmp_ge_u32 s82, 8
  s_cselect_b32 s83, 0, 0xf149f2ca
  v_mov_b32 v64, s83
  v_mov_b32 v65, s83
  v_mov_b32 v66, s83
  v_mov_b32 v67, s83
  v_mov_b32 v68, s83
  v_mov_b32 v69, s83
  v_mov_b32 v70, s83
  v_mov_b32 v71, s83
  v_mov_b32 v72, s83
  v_mov_b32 v73, s83
  v_mov_b32 v74, s83
  v_mov_b32 v75, s83
  v_mov_b32 v76, s83
  v_mov_b32 v77, s83
  v_mov_b32 v78, s83
  v_mov_b32 v79, s83
  s_add_u32 s82, s59, 4
  s_cmp_ge_u32 s82, 8
  s_cselect_b32 s83, 0, 0xf149f2ca
  v_mov_b32 v80, s83
  v_mov_b32 v81, s83
  v_mov_b32 v82, s83
  v_mov_b32 v83, s83
  v_mov_b32 v84, s83
  v_mov_b32 v85, s83
  v_mov_b32 v86, s83
  v_mov_b32 v87, s83
  v_mov_b32 v88, s83
  v_mov_b32 v89, s83
  v_mov_b32 v90, s83
  v_mov_b32 v91, s83
  v_mov_b32 v92, s83
  v_mov_b32 v93, s83
  v_mov_b32 v94, s83
  v_mov_b32 v95, s83
  s_add_u32 s82, s59, 5
  s_cmp_ge_u32 s82, 8
  s_cselect_b32 s83, 0, 0xf149f2ca
  v_mov_b32 v96, s83
  v_mov_b32 v97, s83
  v_mov_b32 v98, s83
  v_mov_b32 v99, s83
  v_mov_b32 v100, s83
  v_mov_b32 v101, s83
  v_mov_b32 v102, s83
  v_mov_b32 v103, s83
  v_mov_b32 v104, s83
  v_mov_b32 v105, s83
  v_mov_b32 v106, s83
  v_mov_b32 v107, s83
  v_mov_b32 v108, s83
  v_mov_b32 v109, s83
  v_mov_b32 v110, s83
  v_mov_b32 v111, s83
  s_add_u32 s82, s59, 6
  s_cmp_ge_u32 s82, 8
  s_cselect_b32 s83, 0, 0xf149f2ca
  v_mov_b32 v112, s83
  v_mov_b32 v113, s83
  v_mov_b32 v114, s83
  v_mov_b32 v115, s83
  v_mov_b32 v116, s83
  v_mov_b32 v117, s83
  v_mov_b32 v118, s83
  v_mov_b32 v119, s83
  v_mov_b32 v120, s83
  v_mov_b32 v121, s83
  v_mov_b32 v122, s83
  v_mov_b32 v123, s83
  v_mov_b32 v124, s83
  v_mov_b32 v125, s83
  v_mov_b32 v126, s83
  v_mov_b32 v127, s83
  s_add_u32 s82, s59, 7
  s_cmp_ge_u32 s82, 8
  s_cselect_b32 s83, 0, 0xf149f2ca
  v_mov_b32 v128, s83
  v_mov_b32 v129, s83
  v_mov_b32 v130, s83
  v_mov_b32 v131, s83
  v_mov_b32 v132, s83
  v_mov_b32 v133, s83
  v_mov_b32 v134, s83
  v_mov_b32 v135, s83
  v_mov_b32 v136, s83
  v_mov_b32 v137, s83
  v_mov_b32 v138, s83
  v_mov_b32 v139, s83
  v_mov_b32 v140, s83
  v_mov_b32 v141, s83
  v_mov_b32 v142, s83
  v_mov_b32 v143, s83
  s_sub_u32 s62, s61, 32
  s_add_u32 s82, s59, 0
  s_sub_u32 s83, s60, 32768
  s_cmp_ge_u32 s82, 8
  s_cselect_b32 s84, s83, 2130706432
  s_add_u32 s82, s59, 1
  s_sub_u32 s83, s60, 28672
  s_cmp_ge_u32 s82, 8
  s_cselect_b32 s85, s83, 2130706432
  s_add_u32 s82, s59, 2
  s_sub_u32 s83, s60, 24576
  s_cmp_ge_u32 s82, 8
  s_cselect_b32 s86, s83, 2130706432
  s_add_u32 s82, s59, 3
  s_sub_u32 s83, s60, 20480
  s_cmp_ge_u32 s82, 8
  s_cselect_b32 s87, s83, 2130706432
  s_add_u32 s82, s59, 4
  s_sub_u32 s83, s60, 16384
  s_cmp_ge_u32 s82, 8
  s_cselect_b32 s88, s83, 2130706432
  s_add_u32 s82, s59, 5
  s_sub_u32 s83, s60, 12288
  s_cmp_ge_u32 s82, 8
  s_cselect_b32 s89, s83, 2130706432
  s_add_u32 s82, s59, 6
  s_sub_u32 s83, s60, 8192
  s_cmp_ge_u32 s82, 8
  s_cselect_b32 s90, s83, 2130706432
  s_add_u32 s82, s59, 7
  s_sub_u32 s83, s60, 4096
  s_cmp_ge_u32 s82, 8
  s_cselect_b32 s91, s83, 2130706432
  v_and_b32 v5, 7, v1
  v_lshlrev_b32 v11, 2, v5
  s_sub_u32 s83, 8, s59
  s_max_i32 s83, s83, 0
  s_lshl_b32 s83, 1, s83
  s_sub_u32 s83, s83, 1
  s_mov_b32 s101, 0
L_f1_6:
  buffer_load_dword v10, v11, s[48:51], s62 offen sc1
  s_waitcnt vmcnt(0)
  v_cmp_eq_u32 vcc, s55, v10
  s_nop 3
  s_mov_b32 s82, vcc_lo
  s_or_b32 s82, s82, s83
  s_and_b32 s82, s82, 0xff
  s_cmp_eq_u32 s82, 0xff
  s_cbranch_scc1 L_f1ok_7
  s_add_u32 s101, s101, 1
  s_cmp_lt_u32 s101, 131072
  s_cbranch_scc1 L_f1_6
  v_mov_b32 v5, 7
  v_mov_b32 v6, 0
  buffer_store_dword v5, v6, s[4:7], 0 offen
  s_nop 0
L_f1ok_7:
  buffer_load_dwordx4 a[0:3], v2, s[48:51], s84 offen offset:0 sc1
  buffer_load_dwordx4 a[4:7], v2, s[48:51], s84 offen offset:1024 sc1
  buffer_load_dwordx4 a[8:11], v2, s[48:51], s85 offen offset:0 sc1
  buffer_load_dwordx4 a[12:15], v2, s[48:51], s85 offen offset:1024 sc1
  buffer_load_dwordx4 a[16:19], v2, s[48:51], s86 offen offset:0 sc1
  buffer_load_dwordx4 a[20:23], v2, s[48:51], s86 offen offset:1024 sc1
  buffer_load_dwordx4 a[24:27], v2, s[48:51], s87 offen offset:0 sc1
  buffer_load_dwordx4 a[28:31], v2, s[48:51], s87 offen offset:1024 sc1
  buffer_load_dwordx4 a[32:35], v2, s[48:51], s88 offen offset:0 sc1
  buffer_load_dwordx4 a[36:39], v2, s[48:51], s88 offen offset:1024 sc1
  buffer_load_dwordx4 a[40:43], v2, s[48:51], s89 offen offset:0 sc1
  buffer_load_dwordx4 a[44:47], v2, s[48:51], s89 offen offset:1024 sc1
  buffer_load_dwordx4 a[48:51], v2, s[48:51], s90 offen offset:0 sc1
  buffer_load_dwordx4 a[52:55], v2, s[48:51], s90 offen offset:1024 sc1
  buffer_load_dwordx4 a[56:59], v2, s[48:51], s91 offen offset:0 sc1
  buffer_load_dwordx4 a[60:63], v2, s[48:51], s91 offen offset:1024 sc1
  s_lshl_b32 s75, s54, 16
  s_lshl_b32 s76, s52, 14
  s_add_u32 s75, s75, s76
  s_add_u32 s75, s75, 1048576
  v_lshrrev_b32 v6, 2, v3
  v_lshlrev_b32 v6, 3, v6
  v_and_b32 v7, 3, v3
  v_add_u32 v6, v6, v7
  s_lshr_b32 s82, s52, 1
  s_lshl_b32 s82, s82, 5
  s_and_b32 s83, s52, 1
  s_lshl_b32 s83, s83, 2
  s_add_u32 s82, s82, s83
  s_lshl_b32 s83, s53, 6
  s_add_u32 s82, s82, s83
  v_add_u32 v6, s82, v6
  v_mul_u32_u24 v6, 896, v6
  v_lshlrev_b32 v7, 4, v4
  v_add_u32 v247, v6, v7
  s_mul_i32 s67, s54, 112
  v_mfma_f32_16x16x32_bf16 v[144:147], v[208:211], v[224:227], v[144:147]
  v_mfma_f32_16x16x32_bf16 v[152:155], v[208:211], v[228:231], v[152:155]
  v_mfma_f32_16x16x32_bf16 v[148:151], v[212:215], v[224:227], v[148:151]
  v_mfma_f32_16x16x32_bf16 v[156:159], v[212:215], v[228:231], v[156:159]
  s_waitcnt vmcnt(15)
  v_mfma_f32_16x16x32_bf16 v[16:19], a[0:3], v[224:227], v[16:19]
  v_mfma_f32_16x16x32_bf16 v[24:27], a[0:3], v[228:231], v[24:27]
  buffer_load_dwordx4 a[64:67], v2, s[48:51], s84 offen offset:2048 sc1
  s_waitcnt vmcnt(15)
  v_mfma_f32_16x16x32_bf16 v[20:23], a[4:7], v[224:227], v[20:23]
  v_mfma_f32_16x16x32_bf16 v[28:31], a[4:7], v[228:231], v[28:31]
  buffer_load_dwordx4 a[68:71], v2, s[48:51], s84 offen offset:3072 sc1
  v_max3_f32 v176, v144, v145, v146
  v_max3_f32 v178, v152, v153, v154
  v_max3_f32 v176, v176, v147, v148
  v_max3_f32 v178, v178, v155, v156
  v_max3_f32 v176, v176, v149, v150
  v_max3_f32 v178, v178, v157, v158
  v_max_f32 v176, v176, v151
  v_max_f32 v178, v178, v159
  s_waitcnt vmcnt(15)
  v_mfma_f32_16x16x32_bf16 v[32:35], a[8:11], v[224:227], v[32:35]
  v_mfma_f32_16x16x32_bf16 v[40:43], a[8:11], v[228:231], v[40:43]
  buffer_load_dwordx4 a[72:75], v2, s[48:51], s85 offen offset:2048 sc1
  s_waitcnt vmcnt(15)
  v_mfma_f32_16x16x32_bf16 v[36:39], a[12:15], v[224:227], v[36:39]
  v_mfma_f32_16x16x32_bf16 v[44:47], a[12:15], v[228:231], v[44:47]
  buffer_load_dwordx4 a[76:79], v2, s[48:51], s85 offen offset:3072 sc1
  v_max3_f32 v176, v176, v16, v17
  v_max3_f32 v178, v178, v24, v25
  v_max3_f32 v176, v176, v18, v19
  v_max3_f32 v178, v178, v26, v27
  v_max3_f32 v176, v176, v20, v21
  v_max3_f32 v178, v178, v28, v29
  v_max3_f32 v176, v176, v22, v23
  v_max3_f32 v178, v178, v30, v31
  s_waitcnt vmcnt(15)
  v_mfma_f32_16x16x32_bf16 v[48:51], a[16:19], v[224:227], v[48:51]
  v_mfma_f32_16x16x32_bf16 v[56:59], a[16:19], v[228:231], v[56:59]
  buffer_load_dwordx4 a[80:83], v2, s[48:51], s86 offen offset:2048 sc1
  s_waitcnt vmcnt(15)
  v_mfma_f32_16x16x32_bf16 v[52:55], a[20:23], v[224:227], v[52:55]
  v_mfma_f32_16x16x32_bf16 v[60:63], a[20:23], v[228:231], v[60:63]
  buffer_load_dwordx4 a[84:87], v2, s[48:51], s86 offen offset:3072 sc1
  v_max3_f32 v176, v176, v32, v33
  v_max3_f32 v178, v178, v40, v41
  v_max3_f32 v176, v176, v34, v35
  v_max3_f32 v178, v178, v42, v43
  v_max3_f32 v176, v176, v36, v37
  v_max3_f32 v178, v178, v44, v45
  v_max3_f32 v176, v176, v38, v39
  v_max3_f32 v178, v178, v46, v47
  s_waitcnt vmcnt(15)
  v_mfma_f32_16x16x32_bf16 v[64:67], a[24:27], v[224:227], v[64:67]
  v_mfma_f32_16x16x32_bf16 v[72:75], a[24:27], v[228:231], v[72:75]
  buffer_load_dwordx4 a[88:91], v2, s[48:51], s87 offen offset:2048 sc1
  s_waitcnt vmcnt(15)
  v_mfma_f32_16x16x32_bf16 v[68:71], a[28:31], v[224:227], v[68:71]
  v_mfma_f32_16x16x32_bf16 v[76:79], a[28:31], v[228:231], v[76:79]
  buffer_load_dwordx4 a[92:95], v2, s[48:51], s87 offen offset:3072 sc1
  v_max3_f32 v176, v176, v48, v49
  v_max3_f32 v178, v178, v56, v57
  v_max3_f32 v176, v176, v50, v51
  v_max3_f32 v178, v178, v58, v59
  v_max3_f32 v176, v176, v52, v53
  v_max3_f32 v178, v178, v60, v61
  v_max3_f32 v176, v176, v54, v55
  v_max3_f32 v178, v178, v62, v63
  s_waitcnt vmcnt(15)
  v_mfma_f32_16x16x32_bf16 v[80:83], a[32:35], v[224:227], v[80:83]
  v_mfma_f32_16x16x32_bf16 v[88:91], a[32:35], v[228:231], v[88:91]
  buffer_load_dwordx4 a[96:99], v2, s[48:51], s88 offen offset:2048 sc1
  s_waitcnt vmcnt(15)
  v_mfma_f32_16x16x32_bf16 v[84:87], a[36:39], v[224:227], v[84:87]
  v_mfma_f32_16x16x32_bf16 v[92:95], a[36:39], v[228:231], v[92:95]
  buffer_load_dwordx4 a[100:103], v2, s[48:51], s88 offen offset:3072 sc1
  v_max3_f32 v176, v176, v64, v65
  v_max3_f32 v178, v178, v72, v73
  v_max3_f32 v176, v176, v66, v67
  v_max3_f32 v178, v178, v74, v75
  v_max3_f32 v176, v176, v68, v69
  v_max3_f32 v178, v178, v76, v77
  v_max3_f32 v176, v176, v70, v71
  v_max3_f32 v178, v178, v78, v79
  s_waitcnt vmcnt(15)
  v_mfma_f32_16x16x32_bf16 v[96:99], a[40:43], v[224:227], v[96:99]
  v_mfma_f32_16x16x32_bf16 v[104:107], a[40:43], v[228:231], v[104:107]
  buffer_load_dwordx4 a[104:107], v2, s[48:51], s89 offen offset:2048 sc1
  s_waitcnt vmcnt(15)
  v_mfma_f32_16x16x32_bf16 v[100:103], a[44:47], v[224:227], v[100:103]
  v_mfma_f32_16x16x32_bf16 v[108:111], a[44:47], v[228:231], v[108:111]
  buffer_load_dwordx4 a[108:111], v2, s[48:51], s89 offen offset:3072 sc1
  v_max3_f32 v176, v176, v80, v81
  v_max3_f32 v178, v178, v88, v89
  v_max3_f32 v176, v176, v82, v83
  v_max3_f32 v178, v178, v90, v91
  v_max3_f32 v176, v176, v84, v85
  v_max3_f32 v178, v178, v92, v93
  v_max3_f32 v176, v176, v86, v87
  v_max3_f32 v178, v178, v94, v95
  s_waitcnt vmcnt(15)
  v_mfma_f32_16x16x32_bf16 v[112:115], a[48:51], v[224:227], v[112:115]
  v_mfma_f32_16x16x32_bf16 v[120:123], a[48:51], v[228:231], v[120:123]
  buffer_load_dwordx4 a[112:115], v2, s[48:51], s90 offen offset:2048 sc1
  s_waitcnt vmcnt(15)
  v_mfma_f32_16x16x32_bf16 v[116:119], a[52:55], v[224:227], v[116:119]
  v_mfma_f32_16x16x32_bf16 v[124:127], a[52:55], v[228:231], v[124:127]
  buffer_load_dwordx4 a[116:119], v2, s[48:51], s90 offen offset:3072 sc1
  v_max3_f32 v176, v176, v96, v97
  v_max3_f32 v178, v178, v104, v105
  v_max3_f32 v176, v176, v98, v99
  v_max3_f32 v178, v178, v106, v107
  v_max3_f32 v176, v176, v100, v101
  v_max3_f32 v178, v178, v108, v109
  v_max3_f32 v176, v176, v102, v103
  v_max3_f32 v178, v178, v110, v111
  s_waitcnt vmcnt(15)
  v_mfma_f32_16x16x32_bf16 v[128:131], a[56:59], v[224:227], v[128:131]
  v_mfma_f32_16x16x32_bf16 v[136:139], a[56:59], v[228:231], v[136:139]
  buffer_load_dwordx4 a[120:123], v2, s[48:51], s91 offen offset:2048 sc1
  s_waitcnt vmcnt(15)
  v_mfma_f32_16x16x32_bf16 v[132:135], a[60:63], v[224:227], v[132:135]
  v_mfma_f32_16x16x32_bf16 v[140:143], a[60:63], v[228:231], v[140:143]
  buffer_load_dwordx4 a[124:127], v2, s[48:51], s91 offen offset:3072 sc1
  v_max3_f32 v176, v176, v112, v113
  v_max3_f32 v178, v178, v120, v121
  v_max3_f32 v176, v176, v114, v115
  v_max3_f32 v178, v178, v122, v123
  v_max3_f32 v176, v176, v116, v117
  v_max3_f32 v178, v178, v124, v125
  v_max3_f32 v176, v176, v118, v119
  v_max3_f32 v178, v178, v126, v127
  v_max3_f32 v176, v176, v128, v129
  v_max3_f32 v178, v178, v136, v137
  v_max3_f32 v176, v176, v130, v131
  v_max3_f32 v178, v178, v138, v139
  v_max3_f32 v176, v176, v132, v133
  v_max3_f32 v178, v178, v140, v141
  v_max3_f32 v176, v176, v134, v135
  v_max3_f32 v178, v178, v142, v143
  v_mov_b32 v5, v176
  v_mov_b32 v6, v178
  s_nop 0
  v_permlane32_swap_b32 v176, v5
  v_permlane32_swap_b32 v178, v6
  v_max_f32 v176, v176, v5
  v_max_f32 v178, v178, v6
  v_mov_b32 v5, v176
  v_mov_b32 v6, v178
  s_nop 0
  v_permlane16_swap_b32 v176, v5
  v_permlane16_swap_b32 v178, v6
  v_max_f32 v176, v176, v5
  v_max_f32 v178, v178, v6
  v_pk_add_f32 v[144:145], v[144:145], v[176:177] op_sel_hi:[1,0] neg_lo:[0,1] neg_hi:[0,1]
  v_pk_add_f32 v[146:147], v[146:147], v[176:177] op_sel_hi:[1,0] neg_lo:[0,1] neg_hi:[0,1]
  v_pk_add_f32 v[148:149], v[148:149], v[176:177] op_sel_hi:[1,0] neg_lo:[0,1] neg_hi:[0,1]
  v_pk_add_f32 v[150:151], v[150:151], v[176:177] op_sel_hi:[1,0] neg_lo:[0,1] neg_hi:[0,1]
  v_exp_f32 v144, v144
  v_exp_f32 v145, v145
  v_exp_f32 v146, v146
  v_exp_f32 v147, v147
  v_exp_f32 v148, v148
  v_exp_f32 v149, v149
  s_add_u32 s81, s75, 0
  s_add_u32 m0, s76, 0
  s_nop 0
  buffer_load_dwordx4 v2, s[48:51], s81 offen sc1 lds
  v_exp_f32 v150, v150
  v_exp_f32 v151, v151
  s_add_u32 s81, s75, 1024
  s_add_u32 m0, s76, 1024
  s_nop 0
  buffer_load_dwordx4 v2, s[48:51], s81 offen sc1 lds
  v_cvt_pk_bf16_f32 v144, v144, v145
  v_cvt_pk_bf16_f32 v145, v146, v147
  v_cvt_pk_bf16_f32 v146, v148, v149
  v_cvt_pk_bf16_f32 v147, v150, v151
  v_pk_add_f32 v[152:153], v[152:153], v[178:179] op_sel_hi:[1,0] neg_lo:[0,1] neg_hi:[0,1]
  v_pk_add_f32 v[154:155], v[154:155], v[178:179] op_sel_hi:[1,0] neg_lo:[0,1] neg_hi:[0,1]
  v_pk_add_f32 v[156:157], v[156:157], v[178:179] op_sel_hi:[1,0] neg_lo:[0,1] neg_hi:[0,1]
  v_pk_add_f32 v[158:159], v[158:159], v[178:179] op_sel_hi:[1,0] neg_lo:[0,1] neg_hi:[0,1]
  v_exp_f32 v152, v152
  v_exp_f32 v153, v153
  v_mfma_f32_16x16x32_bf16 v[160:163], v[216:219], v[144:147], 0
  v_exp_f32 v154, v154
  v_exp_f32 v155, v155
  v_mfma_f32_16x16x32_bf16 v[168:171], v[220:223], v[144:147], 0
  v_exp_f32 v156, v156
  v_exp_f32 v157, v157
  s_add_u32 s81, s75, 2048
  s_add_u32 m0, s76, 2048
  s_nop 0
  buffer_load_dwordx4 v2, s[48:51], s81 offen sc1 lds
  v_exp_f32 v158, v158
  v_exp_f32 v159, v159
  v_cvt_pk_bf16_f32 v152, v152, v153
  v_cvt_pk_bf16_f32 v153, v154, v155
  v_cvt_pk_bf16_f32 v154, v156, v157
  v_cvt_pk_bf16_f32 v155, v158, v159
  v_pk_add_f32 v[16:17], v[16:17], v[176:177] op_sel_hi:[1,0] neg_lo:[0,1] neg_hi:[0,1]
  v_pk_add_f32 v[18:19], v[18:19], v[176:177] op_sel_hi:[1,0] neg_lo:[0,1] neg_hi:[0,1]
  v_pk_add_f32 v[20:21], v[20:21], v[176:177] op_sel_hi:[1,0] neg_lo:[0,1] neg_hi:[0,1]
  v_pk_add_f32 v[22:23], v[22:23], v[176:177] op_sel_hi:[1,0] neg_lo:[0,1] neg_hi:[0,1]
  v_exp_f32 v16, v16
  v_exp_f32 v17, v17
  v_mfma_f32_16x16x32_bf16 v[164:167], v[216:219], v[152:155], 0
  v_exp_f32 v18, v18
  v_exp_f32 v19, v19
  v_mfma_f32_16x16x32_bf16 v[172:175], v[220:223], v[152:155], 0
  v_exp_f32 v20, v20
  v_exp_f32 v21, v21
  s_add_u32 s81, s75, 3072
  s_add_u32 m0, s76, 3072
  s_nop 0
  buffer_load_dwordx4 v2, s[48:51], s81 offen sc1 lds
  v_exp_f32 v22, v22
  v_exp_f32 v23, v23
  s_add_u32 s81, s75, 4096
  s_add_u32 m0, s76, 4096
  s_nop 0
  buffer_load_dwordx4 v2, s[48:51], s81 offen sc1 lds
  v_cvt_pk_bf16_f32 v16, v16, v17
  v_cvt_pk_bf16_f32 v17, v18, v19
  v_cvt_pk_bf16_f32 v18, v20, v21
  v_cvt_pk_bf16_f32 v19, v22, v23
  v_pk_add_f32 v[24:25], v[24:25], v[178:179] op_sel_hi:[1,0] neg_lo:[0,1] neg_hi:[0,1]
  v_pk_add_f32 v[26:27], v[26:27], v[178:179] op_sel_hi:[1,0] neg_lo:[0,1] neg_hi:[0,1]
  v_pk_add_f32 v[28:29], v[28:29], v[178:179] op_sel_hi:[1,0] neg_lo:[0,1] neg_hi:[0,1]
  v_pk_add_f32 v[30:31], v[30:31], v[178:179] op_sel_hi:[1,0] neg_lo:[0,1] neg_hi:[0,1]
  v_exp_f32 v24, v24
  v_exp_f32 v25, v25
  s_waitcnt vmcnt(20)
  v_mfma_f32_16x16x32_bf16 v[160:163], a[64:67], v[16:19], v[160:163]
  v_exp_f32 v26, v26
  v_exp_f32 v27, v27
  s_waitcnt vmcnt(19)
  v_mfma_f32_16x16x32_bf16 v[168:171], a[68:71], v[16:19], v[168:171]
  v_exp_f32 v28, v28
  v_exp_f32 v29, v29
  s_add_u32 s81, s75, 5120
  s_add_u32 m0, s76, 5120
  s_nop 0
  buffer_load_dwordx4 v2, s[48:51], s81 offen sc1 lds
  v_exp_f32 v30, v30
  v_exp_f32 v31, v31
  v_cvt_pk_bf16_f32 v24, v24, v25
  v_cvt_pk_bf16_f32 v25, v26, v27
  v_cvt_pk_bf16_f32 v26, v28, v29
  v_cvt_pk_bf16_f32 v27, v30, v31
  v_pk_add_f32 v[32:33], v[32:33], v[176:177] op_sel_hi:[1,0] neg_lo:[0,1] neg_hi:[0,1]
  v_pk_add_f32 v[34:35], v[34:35], v[176:177] op_sel_hi:[1,0] neg_lo:[0,1] neg_hi:[0,1]
  v_pk_add_f32 v[36:37], v[36:37], v[176:177] op_sel_hi:[1,0] neg_lo:[0,1] neg_hi:[0,1]
  v_pk_add_f32 v[38:39], v[38:39], v[176:177] op_sel_hi:[1,0] neg_lo:[0,1] neg_hi:[0,1]
  v_exp_f32 v32, v32
  v_exp_f32 v33, v33
  v_mfma_f32_16x16x32_bf16 v[164:167], a[64:67], v[24:27], v[164:167]
  v_exp_f32 v34, v34
  v_exp_f32 v35, v35
  v_mfma_f32_16x16x32_bf16 v[172:175], a[68:71], v[24:27], v[172:175]
  v_exp_f32 v36, v36
  v_exp_f32 v37, v37
  s_add_u32 s81, s75, 6144
  s_add_u32 m0, s76, 6144
  s_nop 0
  buffer_load_dwordx4 v2, s[48:51], s81 offen sc1 lds
  v_exp_f32 v38, v38
  v_exp_f32 v39, v39
  s_add_u32 s81, s75, 7168
  s_add_u32 m0, s76, 7168
  s_nop 0
  buffer_load_dwordx4 v2, s[48:51], s81 offen sc1 lds
  v_cvt_pk_bf16_f32 v32, v32, v33
  v_cvt_pk_bf16_f32 v33, v34, v35
  v_cvt_pk_bf16_f32 v34, v36, v37
  v_cvt_pk_bf16_f32 v35, v38, v39
  v_pk_add_f32 v[40:41], v[40:41], v[178:179] op_sel_hi:[1,0] neg_lo:[0,1] neg_hi:[0,1]
  v_pk_add_f32 v[42:43], v[42:43], v[178:179] op_sel_hi:[1,0] neg_lo:[0,1] neg_hi:[0,1]
  v_pk_add_f32 v[44:45], v[44:45], v[178:179] op_sel_hi:[1,0] neg_lo:[0,1] neg_hi:[0,1]
  v_pk_add_f32 v[46:47], v[46:47], v[178:179] op_sel_hi:[1,0] neg_lo:[0,1] neg_hi:[0,1]
  v_exp_f32 v40, v40
  v_exp_f32 v41, v41
  s_waitcnt vmcnt(21)
  v_mfma_f32_16x16x32_bf16 v[160:163], a[72:75], v[32:35], v[160:163]
  v_exp_f32 v42, v42
  v_exp_f32 v43, v43
  s_waitcnt vmcnt(20)
  v_mfma_f32_16x16x32_bf16 v[168:171], a[76:79], v[32:35], v[168:171]
  v_exp_f32 v44, v44
  v_exp_f32 v45, v45
  s_add_u32 s81, s75, 8192
  s_add_u32 m0, s76, 8192
  s_nop 0
  buffer_load_dwordx4 v2, s[48:51], s81 offen sc1 lds
  v_exp_f32 v46, v46
  v_exp_f32 v47, v47
  v_cvt_pk_bf16_f32 v40, v40, v41
  v_cvt_pk_bf16_f32 v41, v42, v43
  v_cvt_pk_bf16_f32 v42, v44, v45
  v_cvt_pk_bf16_f32 v43, v46, v47
  v_pk_add_f32 v[48:49], v[48:49], v[176:177] op_sel_hi:[1,0] neg_lo:[0,1] neg_hi:[0,1]
  v_pk_add_f32 v[50:51], v[50:51], v[176:177] op_sel_hi:[1,0] neg_lo:[0,1] neg_hi:[0,1]
  v_pk_add_f32 v[52:53], v[52:53], v[176:177] op_sel_hi:[1,0] neg_lo:[0,1] neg_hi:[0,1]
  v_pk_add_f32 v[54:55], v[54:55], v[176:177] op_sel_hi:[1,0] neg_lo:[0,1] neg_hi:[0,1]
  v_exp_f32 v48, v48
  v_exp_f32 v49, v49
  v_mfma_f32_16x16x32_bf16 v[164:167], a[72:75], v[40:43], v[164:167]
  v_exp_f32 v50, v50
  v_exp_f32 v51, v51
  v_mfma_f32_16x16x32_bf16 v[172:175], a[76:79], v[40:43], v[172:175]
  v_exp_f32 v52, v52
  v_exp_f32 v53, v53
  s_add_u32 s81, s75, 9216
  s_add_u32 m0, s76, 9216
  s_nop 0
  buffer_load_dwordx4 v2, s[48:51], s81 offen sc1 lds
  v_exp_f32 v54, v54
  v_exp_f32 v55, v55
  s_add_u32 s81, s75, 10240
  s_add_u32 m0, s76, 10240
  s_nop 0
  buffer_load_dwordx4 v2, s[48:51], s81 offen sc1 lds
  v_cvt_pk_bf16_f32 v48, v48, v49
  v_cvt_pk_bf16_f32 v49, v50, v51
  v_cvt_pk_bf16_f32 v50, v52, v53
  v_cvt_pk_bf16_f32 v51, v54, v55
  v_pk_add_f32 v[56:57], v[56:57], v[178:179] op_sel_hi:[1,0] neg_lo:[0,1] neg_hi:[0,1]
  v_pk_add_f32 v[58:59], v[58:59], v[178:179] op_sel_hi:[1,0] neg_lo:[0,1] neg_hi:[0,1]
  v_pk_add_f32 v[60:61], v[60:61], v[178:179] op_sel_hi:[1,0] neg_lo:[0,1] neg_hi:[0,1]
  v_pk_add_f32 v[62:63], v[62:63], v[178:179] op_sel_hi:[1,0] neg_lo:[0,1] neg_hi:[0,1]
  v_exp_f32 v56, v56
  v_exp_f32 v57, v57
  s_waitcnt vmcnt(22)
  v_mfma_f32_16x16x32_bf16 v[160:163], a[80:83], v[48:51], v[160:163]
  v_exp_f32 v58, v58
  v_exp_f32 v59, v59
  s_waitcnt vmcnt(21)
  v_mfma_f32_16x16x32_bf16 v[168:171], a[84:87], v[48:51], v[168:171]
  v_exp_f32 v60, v60
  v_exp_f32 v61, v61
  s_add_u32 s81, s75, 11264
  s_add_u32 m0, s76, 11264
  s_nop 0
  buffer_load_dwordx4 v2, s[48:51], s81 offen sc1 lds
  v_exp_f32 v62, v62
  v_exp_f32 v63, v63
  v_cvt_pk_bf16_f32 v56, v56, v57
  v_cvt_pk_bf16_f32 v57, v58, v59
  v_cvt_pk_bf16_f32 v58, v60, v61
  v_cvt_pk_bf16_f32 v59, v62, v63
  v_pk_add_f32 v[64:65], v[64:65], v[176:177] op_sel_hi:[1,0] neg_lo:[0,1] neg_hi:[0,1]
  v_pk_add_f32 v[66:67], v[66:67], v[176:177] op_sel_hi:[1,0] neg_lo:[0,1] neg_hi:[0,1]
  v_pk_add_f32 v[68:69], v[68:69], v[176:177] op_sel_hi:[1,0] neg_lo:[0,1] neg_hi:[0,1]
  v_pk_add_f32 v[70:71], v[70:71], v[176:177] op_sel_hi:[1,0] neg_lo:[0,1] neg_hi:[0,1]
  v_exp_f32 v64, v64
  v_exp_f32 v65, v65
  v_mfma_f32_16x16x32_bf16 v[164:167], a[80:83], v[56:59], v[164:167]
  v_exp_f32 v66, v66
  v_exp_f32 v67, v67
  v_mfma_f32_16x16x32_bf16 v[172:175], a[84:87], v[56:59], v[172:175]
  v_exp_f32 v68, v68
  v_exp_f32 v69, v69
  s_add_u32 s81, s75, 12288
  s_add_u32 m0, s76, 12288
  s_nop 0
  buffer_load_dwordx4 v2, s[48:51], s81 offen sc1 lds
  v_exp_f32 v70, v70
  v_exp_f32 v71, v71
  s_add_u32 s81, s75, 13312
  s_add_u32 m0, s76, 13312
  s_nop 0
  buffer_load_dwordx4 v2, s[48:51], s81 offen sc1 lds
  v_cvt_pk_bf16_f32 v64, v64, v65
  v_cvt_pk_bf16_f32 v65, v66, v67
  v_cvt_pk_bf16_f32 v66, v68, v69
  v_cvt_pk_bf16_f32 v67, v70, v71
  v_pk_add_f32 v[72:73], v[72:73], v[178:179] op_sel_hi:[1,0] neg_lo:[0,1] neg_hi:[0,1]
  v_pk_add_f32 v[74:75], v[74:75], v[178:179] op_sel_hi:[1,0] neg_lo:[0,1] neg_hi:[0,1]
  v_pk_add_f32 v[76:77], v[76:77], v[178:179] op_sel_hi:[1,0] neg_lo:[0,1] neg_hi:[0,1]
  v_pk_add_f32 v[78:79], v[78:79], v[178:179] op_sel_hi:[1,0] neg_lo:[0,1] neg_hi:[0,1]
  v_exp_f32 v72, v72
  v_exp_f32 v73, v73
  s_waitcnt vmcnt(23)
  v_mfma_f32_16x16x32_bf16 v[160:163], a[88:91], v[64:67], v[160:163]
  v_exp_f32 v74, v74
  v_exp_f32 v75, v75
  s_waitcnt vmcnt(22)
  v_mfma_f32_16x16x32_bf16 v[168:171], a[92:95], v[64:67], v[168:171]
  v_exp_f32 v76, v76
  v_exp_f32 v77, v77
  s_add_u32 s81, s75, 14336
  s_add_u32 m0, s76, 14336
  s_nop 0
  buffer_load_dwordx4 v2, s[48:51], s81 offen sc1 lds
  v_exp_f32 v78, v78
  v_exp_f32 v79, v79
  v_cvt_pk_bf16_f32 v72, v72, v73
  v_cvt_pk_bf16_f32 v73, v74, v75
  v_cvt_pk_bf16_f32 v74, v76, v77
  v_cvt_pk_bf16_f32 v75, v78, v79
  v_pk_add_f32 v[80:81], v[80:81], v[176:177] op_sel_hi:[1,0] neg_lo:[0,1] neg_hi:[0,1]
  v_pk_add_f32 v[82:83], v[82:83], v[176:177] op_sel_hi:[1,0] neg_lo:[0,1] neg_hi:[0,1]
  v_pk_add_f32 v[84:85], v[84:85], v[176:177] op_sel_hi:[1,0] neg_lo:[0,1] neg_hi:[0,1]
  v_pk_add_f32 v[86:87], v[86:87], v[176:177] op_sel_hi:[1,0] neg_lo:[0,1] neg_hi:[0,1]
  v_exp_f32 v80, v80
  v_exp_f32 v81, v81
  v_mfma_f32_16x16x32_bf16 v[164:167], a[88:91], v[72:75], v[164:167]
  v_exp_f32 v82, v82
  v_exp_f32 v83, v83
  v_mfma_f32_16x16x32_bf16 v[172:175], a[92:95], v[72:75], v[172:175]
  v_exp_f32 v84, v84
  v_exp_f32 v85, v85
  s_add_u32 s81, s75, 15360
  s_add_u32 m0, s76, 15360
  s_nop 0
  buffer_load_dwordx4 v2, s[48:51], s81 offen sc1 lds
  v_exp_f32 v86, v86
  v_exp_f32 v87, v87
  buffer_load_dwordx4 v[188:191], v247, s[8:11], s67 offen
  v_cvt_pk_bf16_f32 v80, v80, v81
  v_cvt_pk_bf16_f32 v81, v82, v83
  v_cvt_pk_bf16_f32 v82, v84, v85
  v_cvt_pk_bf16_f32 v83, v86, v87
  v_pk_add_f32 v[88:89], v[88:89], v[178:179] op_sel_hi:[1,0] neg_lo:[0,1] neg_hi:[0,1]
  v_pk_add_f32 v[90:91], v[90:91], v[178:179] op_sel_hi:[1,0] neg_lo:[0,1] neg_hi:[0,1]
  v_pk_add_f32 v[92:93], v[92:93], v[178:179] op_sel_hi:[1,0] neg_lo:[0,1] neg_hi:[0,1]
  v_pk_add_f32 v[94:95], v[94:95], v[178:179] op_sel_hi:[1,0] neg_lo:[0,1] neg_hi:[0,1]
  v_exp_f32 v88, v88
  v_exp_f32 v89, v89
  s_waitcnt vmcnt(24)
  v_mfma_f32_16x16x32_bf16 v[160:163], a[96:99], v[80:83], v[160:163]
  v_exp_f32 v90, v90
  v_exp_f32 v91, v91
  s_waitcnt vmcnt(23)
  v_mfma_f32_16x16x32_bf16 v[168:171], a[100:103], v[80:83], v[168:171]
  v_exp_f32 v92, v92
  v_exp_f32 v93, v93
  buffer_load_dwordx4 v[192:195], v247, s[8:11], s67 offen offset:64
  v_exp_f32 v94, v94
  v_exp_f32 v95, v95
  v_cvt_pk_bf16_f32 v88, v88, v89
  v_cvt_pk_bf16_f32 v89, v90, v91
  v_cvt_pk_bf16_f32 v90, v92, v93
  v_cvt_pk_bf16_f32 v91, v94, v95
  v_pk_add_f32 v[96:97], v[96:97], v[176:177] op_sel_hi:[1,0] neg_lo:[0,1] neg_hi:[0,1]
  v_pk_add_f32 v[98:99], v[98:99], v[176:177] op_sel_hi:[1,0] neg_lo:[0,1] neg_hi:[0,1]
  v_pk_add_f32 v[100:101], v[100:101], v[176:177] op_sel_hi:[1,0] neg_lo:[0,1] neg_hi:[0,1]
  v_pk_add_f32 v[102:103], v[102:103], v[176:177] op_sel_hi:[1,0] neg_lo:[0,1] neg_hi:[0,1]
  v_exp_f32 v96, v96
  v_exp_f32 v97, v97
  v_mfma_f32_16x16x32_bf16 v[164:167], a[96:99], v[88:91], v[164:167]
  v_exp_f32 v98, v98
  v_exp_f32 v99, v99
  v_mfma_f32_16x16x32_bf16 v[172:175], a[100:103], v[88:91], v[172:175]
  v_exp_f32 v100, v100
  v_exp_f32 v101, v101
  v_exp_f32 v102, v102
  v_exp_f32 v103, v103
  v_cvt_pk_bf16_f32 v96, v96, v97
  v_cvt_pk_bf16_f32 v97, v98, v99
  v_cvt_pk_bf16_f32 v98, v100, v101
  v_cvt_pk_bf16_f32 v99, v102, v103
  v_pk_add_f32 v[104:105], v[104:105], v[178:179] op_sel_hi:[1,0] neg_lo:[0,1] neg_hi:[0,1]
  v_pk_add_f32 v[106:107], v[106:107], v[178:179] op_sel_hi:[1,0] neg_lo:[0,1] neg_hi:[0,1]
  v_pk_add_f32 v[108:109], v[108:109], v[178:179] op_sel_hi:[1,0] neg_lo:[0,1] neg_hi:[0,1]
  v_pk_add_f32 v[110:111], v[110:111], v[178:179] op_sel_hi:[1,0] neg_lo:[0,1] neg_hi:[0,1]
  v_exp_f32 v104, v104
  v_exp_f32 v105, v105
  s_waitcnt vmcnt(23)
  v_mfma_f32_16x16x32_bf16 v[160:163], a[104:107], v[96:99], v[160:163]
  v_exp_f32 v106, v106
  v_exp_f32 v107, v107
  s_waitcnt vmcnt(22)
  v_mfma_f32_16x16x32_bf16 v[168:171], a[108:111], v[96:99], v[168:171]
  v_exp_f32 v108, v108
  v_exp_f32 v109, v109
  v_exp_f32 v110, v110
  v_exp_f32 v111, v111
  v_cvt_pk_bf16_f32 v104, v104, v105
  v_cvt_pk_bf16_f32 v105, v106, v107
  v_cvt_pk_bf16_f32 v106, v108, v109
  v_cvt_pk_bf16_f32 v107, v110, v111
  v_pk_add_f32 v[112:113], v[112:113], v[176:177] op_sel_hi:[1,0] neg_lo:[0,1] neg_hi:[0,1]
  v_pk_add_f32 v[114:115], v[114:115], v[176:177] op_sel_hi:[1,0] neg_lo:[0,1] neg_hi:[0,1]
  v_pk_add_f32 v[116:117], v[116:117], v[176:177] op_sel_hi:[1,0] neg_lo:[0,1] neg_hi:[0,1]
  v_pk_add_f32 v[118:119], v[118:119], v[176:177] op_sel_hi:[1,0] neg_lo:[0,1] neg_hi:[0,1]
  v_exp_f32 v112, v112
  v_exp_f32 v113, v113
  v_mfma_f32_16x16x32_bf16 v[164:167], a[104:107], v[104:107], v[164:167]
  v_exp_f32 v114, v114
  v_exp_f32 v115, v115
  v_mfma_f32_16x16x32_bf16 v[172:175], a[108:111], v[104:107], v[172:175]
  v_exp_f32 v116, v116
  v_exp_f32 v117, v117
  v_exp_f32 v118, v118
  v_exp_f32 v119, v119
  v_cvt_pk_bf16_f32 v112, v112, v113
  v_cvt_pk_bf16_f32 v113, v114, v115
  v_cvt_pk_bf16_f32 v114, v116, v117
  v_cvt_pk_bf16_f32 v115, v118, v119
  v_pk_add_f32 v[120:121], v[120:121], v[178:179] op_sel_hi:[1,0] neg_lo:[0,1] neg_hi:[0,1]
  v_pk_add_f32 v[122:123], v[122:123], v[178:179] op_sel_hi:[1,0] neg_lo:[0,1] neg_hi:[0,1]
  v_pk_add_f32 v[124:125], v[124:125], v[178:179] op_sel_hi:[1,0] neg_lo:[0,1] neg_hi:[0,1]
  v_pk_add_f32 v[126:127], v[126:127], v[178:179] op_sel_hi:[1,0] neg_lo:[0,1] neg_hi:[0,1]
  v_exp_f32 v120, v120
  v_exp_f32 v121, v121
  s_waitcnt vmcnt(21)
  v_mfma_f32_16x16x32_bf16 v[160:163], a[112:115], v[112:115], v[160:163]
  v_exp_f32 v122, v122
  v_exp_f32 v123, v123
  s_waitcnt vmcnt(20)
  v_mfma_f32_16x16x32_bf16 v[168:171], a[116:119], v[112:115], v[168:171]
  v_exp_f32 v124, v124
  v_exp_f32 v125, v125
  v_exp_f32 v126, v126
  v_exp_f32 v127, v127
  v_cvt_pk_bf16_f32 v120, v120, v121
  v_cvt_pk_bf16_f32 v121, v122, v123
  v_cvt_pk_bf16_f32 v122, v124, v125
  v_cvt_pk_bf16_f32 v123, v126, v127
  v_pk_add_f32 v[128:129], v[128:129], v[176:177] op_sel_hi:[1,0] neg_lo:[0,1] neg_hi:[0,1]
  v_pk_add_f32 v[130:131], v[130:131], v[176:177] op_sel_hi:[1,0] neg_lo:[0,1] neg_hi:[0,1]
  v_pk_add_f32 v[132:133], v[132:133], v[176:177] op_sel_hi:[1,0] neg_lo:[0,1] neg_hi:[0,1]
  v_pk_add_f32 v[134:135], v[134:135], v[176:177] op_sel_hi:[1,0] neg_lo:[0,1] neg_hi:[0,1]
  v_exp_f32 v128, v128
  v_exp_f32 v129, v129
  v_mfma_f32_16x16x32_bf16 v[164:167], a[112:115], v[120:123], v[164:167]
  v_exp_f32 v130, v130
  v_exp_f32 v131, v131
  v_mfma_f32_16x16x32_bf16 v[172:175], a[116:119], v[120:123], v[172:175]
  v_exp_f32 v132, v132
  v_exp_f32 v133, v133
  v_exp_f32 v134, v134
  v_exp_f32 v135, v135
  v_cvt_pk_bf16_f32 v128, v128, v129
  v_cvt_pk_bf16_f32 v129, v130, v131
  v_cvt_pk_bf16_f32 v130, v132, v133
  v_cvt_pk_bf16_f32 v131, v134, v135
  v_pk_add_f32 v[136:137], v[136:137], v[178:179] op_sel_hi:[1,0] neg_lo:[0,1] neg_hi:[0,1]
  v_pk_add_f32 v[138:139], v[138:139], v[178:179] op_sel_hi:[1,0] neg_lo:[0,1] neg_hi:[0,1]
  v_pk_add_f32 v[140:141], v[140:141], v[178:179] op_sel_hi:[1,0] neg_lo:[0,1] neg_hi:[0,1]
  v_pk_add_f32 v[142:143], v[142:143], v[178:179] op_sel_hi:[1,0] neg_lo:[0,1] neg_hi:[0,1]
  v_exp_f32 v136, v136
  v_exp_f32 v137, v137
  s_waitcnt vmcnt(19)
  v_mfma_f32_16x16x32_bf16 v[160:163], a[120:123], v[128:131], v[160:163]
  v_exp_f32 v138, v138
  v_exp_f32 v139, v139
  s_waitcnt vmcnt(18)
  v_mfma_f32_16x16x32_bf16 v[168:171], a[124:127], v[128:131], v[168:171]
  v_exp_f32 v140, v140
  v_exp_f32 v141, v141
  v_exp_f32 v142, v142
  v_exp_f32 v143, v143
  v_cvt_pk_bf16_f32 v136, v136, v137
  v_cvt_pk_bf16_f32 v137, v138, v139
  v_cvt_pk_bf16_f32 v138, v140, v141
  v_cvt_pk_bf16_f32 v139, v142, v143
  s_nop 1
  v_mfma_f32_16x16x32_bf16 v[164:167], a[120:123], v[136:139], v[164:167]
  v_mfma_f32_16x16x32_bf16 v[172:175], a[124:127], v[136:139], v[172:175]
  s_lshl_b32 s82, s54, 1
  s_add_u32 s82, s82, 1
  s_lshl_b32 s82, s82, 3
  s_lshl_b32 s83, s52, 1
  s_add_u32 s83, s83, 0
  s_add_u32 s82, s82, s83
  s_mul_i32 s82, s82, 14336
  s_add_u32 s82, s82, 2097152
  s_cmp_lt_u32 s83, 7
  s_cselect_b32 s77, s82, 2130706432
  s_lshl_b32 s82, s54, 1
  s_add_u32 s82, s82, 1
  s_lshl_b32 s82, s82, 3
  s_lshl_b32 s83, s52, 1
  s_add_u32 s83, s83, 1
  s_add_u32 s82, s82, s83
  s_mul_i32 s82, s82, 14336
  s_add_u32 s82, s82, 2097152
  s_cmp_lt_u32 s83, 7
  s_cselect_b32 s78, s82, 2130706432
  s_lshr_b32 s82, s52, 1
  s_lshl_b32 s82, s82, 1
  s_lshl_b32 s83, s53, 2
  s_add_u32 s82, s82, s83
  s_lshl_b32 s82, s82, 4
  s_add_u32 s82, s82, s58
  s_lshl_b32 s82, s82, 10
  s_add_u32 s64, s82, 9437184
  s_add_u32 s65, s64, 16384
  s_lshl_b32 s82, s53, 7
  s_add_u32 s62, s82, 16384
  s_lshl_b32 s83, s54, 2
  s_add_u32 s66, s62, s83
  v_mov_b32 v8, v168
  v_mov_b32 v9, v168
  v_mov_b32 v10, v172
  v_mov_b32 v11, v172
  v_permlane32_swap_b32 v8, v9
  s_nop 0
  v_permlane32_swap_b32 v10, v11
  v_mov_b32 v8, v9
  v_mov_b32 v10, v11
  s_nop 0
  v_permlane16_swap_b32 v8, v9
  v_permlane16_swap_b32 v10, v11
  v_rcp_f32 v8, v9
  v_rcp_f32 v10, v11
  v_pk_mul_f32 v[160:161], v[160:161], v[8:9] op_sel_hi:[1,0]
  v_pk_mul_f32 v[162:163], v[162:163], v[8:9] op_sel_hi:[1,0]
  v_cvt_pk_bf16_f32 v180, v160, v161
  v_cvt_pk_bf16_f32 v181, v162, v163
  v_pk_mul_f32 v[168:169], v[168:169], v[8:9] op_sel_hi:[1,0]
  v_pk_mul_f32 v[170:171], v[170:171], v[8:9] op_sel_hi:[1,0]
  v_cvt_pk_bf16_f32 v182, v168, v169
  v_cvt_pk_bf16_f32 v183, v170, v171
  buffer_store_dwordx4 v[180:183], v2, s[48:51], s64 offen sc1
  v_pk_mul_f32 v[164:165], v[164:165], v[10:11] op_sel_hi:[1,0]
  v_pk_mul_f32 v[166:167], v[166:167], v[10:11] op_sel_hi:[1,0]
  v_cvt_pk_bf16_f32 v184, v164, v165
  v_cvt_pk_bf16_f32 v185, v166, v167
  v_pk_mul_f32 v[172:173], v[172:173], v[10:11] op_sel_hi:[1,0]
  v_pk_mul_f32 v[174:175], v[174:175], v[10:11] op_sel_hi:[1,0]
  v_cvt_pk_bf16_f32 v186, v172, v173
  v_cvt_pk_bf16_f32 v187, v174, v175
  buffer_store_dwordx4 v[184:187], v2, s[48:51], s65 offen sc1
  s_add_u32 s81, s77, 0
  buffer_load_dwordx4 a[128:131], v2, s[48:51], s81 offen offset:0 sc1
  s_add_u32 s81, s78, 0
  buffer_load_dwordx4 a[184:187], v2, s[48:51], s81 offen offset:0 sc1
  s_add_u32 s81, s77, 0
  buffer_load_dwordx4 a[132:135], v2, s[48:51], s81 offen offset:1024 sc1
  s_add_u32 s81, s78, 0
  buffer_load_dwordx4 a[188:191], v2, s[48:51], s81 offen offset:1024 sc1
  s_waitcnt vmcnt(4)
  s_barrier
  s_cmp_eq_u32 s52, 0
  s_cbranch_scc0 L_pub_8
  v_mov_b32 v5, s55
  s_mov_b64 exec, 1
  buffer_store_dword v5, off, s[48:51], s66 sc1
  s_mov_b64 exec, -1
L_pub_8:
  v_lshrrev_b32 v7, 5, v1
  v_lshlrev_b32 v7, 3, v7
  v_bfe_u32 v8, v1, 3, 2
  v_add_u32 v7, v7, v8
  v_lshlrev_b32 v7, 12, v7
  v_and_b32 v12, 7, v1
  v_xor_b32 v12, v12, v4
  v_xor_b32 v13, 4, v12
  v_lshlrev_b32 v12, 4, v12
  v_lshlrev_b32 v13, 4, v13
  v_add_u32 v12, v7, v12
  v_add_u32 v13, v7, v13
  s_lshl_b32 s72, s53, 18
  s_lshl_b32 s82, s52, 10
  s_add_u32 s72, s72, s82
  s_lshl_b32 s73, s52, 13
  s_add_u32 s73, s73, 0
  v_lshrrev_b32 v14, 1, v3
  v_xor_b32 v14, v14, v4
  v_xor_b32 v15, 4, v14
  v_lshlrev_b32 v14, 4, v14
  v_lshlrev_b32 v15, 4, v15
  v_lshlrev_b32 v7, 7, v3
  v_add_u32 v14, v14, v7
  v_add_u32 v15, v15, v7
  v_add_u32 v14, s73, v14
  v_add_u32 v15, s73, v15
  s_lshl_b32 s84, s53, 2
  s_add_u32 s84, s84, s52
  s_lshl_b32 s84, s84, 14
  s_add_u32 s84, s84, 9437184
  s_add_u32 s85, s84, 4096
  s_add_u32 s86, s84, 8192
  s_add_u32 s87, s84, 12288
  v_and_b32 v5, 7, v1
  v_lshlrev_b32 v11, 2, v5
  s_mov_b32 s101, 0
  s_nop 0
L_f2_9:
  buffer_load_dword v10, v11, s[48:51], s62 offen sc1
  s_waitcnt vmcnt(0)
  v_cmp_eq_u32 vcc, s55, v10
  s_nop 3
  s_mov_b32 s82, vcc_lo
  s_and_b32 s82, s82, 0xff
  s_cmp_eq_u32 s82, 0xff
  s_cbranch_scc1 L_f2ok_10
  s_add_u32 s101, s101, 1
  s_cmp_lt_u32 s101, 131072
  s_cbranch_scc1 L_f2_9
  v_mov_b32 v5, 10
  v_mov_b32 v6, 0
  buffer_store_dword v5, v6, s[4:7], 0 offen
  s_nop 0
L_f2ok_10:
  buffer_load_dwordx4 v[16:19], v2, s[48:51], s84 offen offset:0 sc1
  buffer_load_dwordx4 v[20:23], v2, s[48:51], s84 offen offset:1024 sc1
  buffer_load_dwordx4 v[24:27], v2, s[48:51], s84 offen offset:2048 sc1
  buffer_load_dwordx4 v[28:31], v2, s[48:51], s84 offen offset:3072 sc1
  buffer_load_dwordx4 v[32:35], v2, s[48:51], s85 offen offset:0 sc1
  buffer_load_dwordx4 v[36:39], v2, s[48:51], s85 offen offset:1024 sc1
  buffer_load_dwordx4 v[40:43], v2, s[48:51], s85 offen offset:2048 sc1
  buffer_load_dwordx4 v[44:47], v2, s[48:51], s85 offen offset:3072 sc1
  buffer_load_dwordx4 v[48:51], v2, s[48:51], s86 offen offset:0 sc1
  buffer_load_dwordx4 v[52:55], v2, s[48:51], s86 offen offset:1024 sc1
  buffer_load_dwordx4 v[56:59], v2, s[48:51], s86 offen offset:2048 sc1
  buffer_load_dwordx4 v[60:63], v2, s[48:51], s86 offen offset:3072 sc1
  buffer_load_dwordx4 v[64:67], v2, s[48:51], s87 offen offset:0 sc1
  buffer_load_dwordx4 v[68:71], v2, s[48:51], s87 offen offset:1024 sc1
  buffer_load_dwordx4 v[72:75], v2, s[48:51], s87 offen offset:2048 sc1
  buffer_load_dwordx4 v[76:79], v2, s[48:51], s87 offen offset:3072 sc1
  v_add_u32 v7, 0, v2
  v_lshlrev_b32 v8, 4, v4
  s_mul_i32 s82, s54, 112
  s_add_u32 s82, s82, 157696
  v_add_u32 v8, s82, v8
  ds_read_b128 v[144:147], v8
  ds_read_b128 v[148:151], v8 offset:64
  ds_read_b128 v[152:155], v8 offset:1792
  ds_read_b128 v[156:159], v8 offset:1856
  v_cmp_gt_u32 vcc, 3, v4
  s_nop 1
  v_cndmask_b32 v9, 0, -1, vcc
  s_waitcnt lgkmcnt(0)
  v_and_b32 v192, v9, v192
  v_and_b32 v193, v9, v193
  v_and_b32 v194, v9, v194
  v_and_b32 v195, v9, v195
  v_lshlrev_b32 v160, 16, v188
  v_and_b32 v161, s100, v188
  v_lshlrev_b32 v196, 16, v144
  v_and_b32 v197, s100, v144
  v_lshlrev_b32 v162, 16, v189
  v_and_b32 v163, s100, v189
  v_lshlrev_b32 v198, 16, v145
  v_and_b32 v199, s100, v145
  v_lshlrev_b32 v164, 16, v190
  v_and_b32 v165, s100, v190
  v_lshlrev_b32 v200, 16, v146
  v_and_b32 v201, s100, v146
  v_lshlrev_b32 v166, 16, v191
  v_and_b32 v167, s100, v191
  v_lshlrev_b32 v202, 16, v147
  v_and_b32 v203, s100, v147
  v_lshlrev_b32 v168, 16, v192
  v_and_b32 v169, s100, v192
  v_lshlrev_b32 v204, 16, v148
  v_and_b32 v205, s100, v148
  v_lshlrev_b32 v170, 16, v193
  v_and_b32 v171, s100, v193
  v_lshlrev_b32 v206, 16, v149
  v_and_b32 v207, s100, v149
  v_lshlrev_b32 v172, 16, v194
  v_and_b32 v173, s100, v194
  v_lshlrev_b32 v208, 16, v150
  v_and_b32 v209, s100, v150
  v_lshlrev_b32 v174, 16, v195
  v_and_b32 v175, s100, v195
  v_lshlrev_b32 v210, 16, v151
  v_and_b32 v211, s100, v151
  v_lshlrev_b32 v212, 16, v152
  v_and_b32 v213, s100, v152
  v_lshlrev_b32 v214, 16, v153
  v_and_b32 v215, s100, v153
  v_lshlrev_b32 v216, 16, v154
  v_and_b32 v217, s100, v154
  v_lshlrev_b32 v218, 16, v155
  v_and_b32 v219, s100, v155
  v_lshlrev_b32 v220, 16, v156
  v_and_b32 v221, s100, v156
  v_lshlrev_b32 v222, 16, v157
  v_and_b32 v223, s100, v157
  v_lshlrev_b32 v224, 16, v158
  v_and_b32 v225, s100, v158
  v_lshlrev_b32 v226, 16, v159
  v_and_b32 v227, s100, v159
  ds_read_b128 v[96:99], v7 offset:0
  ds_read_b128 v[100:103], v7 offset:1024
  ds_read_b128 v[104:107], v7 offset:2048
  ds_read_b128 v[108:111], v7 offset:3072
  ds_read_b128 v[112:115], v7 offset:4096
  ds_read_b128 v[116:119], v7 offset:5120
  ds_read_b128 v[120:123], v7 offset:6144
  ds_read_b128 v[124:127], v7 offset:7168
  s_waitcnt vmcnt(15)
  s_waitcnt lgkmcnt(4)
  v_mfma_f32_16x16x32_bf16 v[80:83], v[96:99], v[16:19], 0
  ds_read_b128 v[128:131], v7 offset:8192
  v_mfma_f32_16x16x32_bf16 v[84:87], v[100:103], v[16:19], 0
  ds_read_b128 v[132:135], v7 offset:9216
  v_mfma_f32_16x16x32_bf16 v[88:91], v[104:107], v[16:19], 0
  ds_read_b128 v[136:139], v7 offset:10240
  v_mfma_f32_16x16x32_bf16 v[92:95], v[108:111], v[16:19], 0
  ds_read_b128 v[140:143], v7 offset:11264
  s_waitcnt vmcnt(14)
  s_waitcnt lgkmcnt(4)
  v_mfma_f32_16x16x32_bf16 v[80:83], v[112:115], v[20:23], v[80:83]
  ds_read_b128 v[96:99], v7 offset:12288
  v_mfma_f32_16x16x32_bf16 v[84:87], v[116:119], v[20:23], v[84:87]
  ds_read_b128 v[100:103], v7 offset:13312
  v_mfma_f32_16x16x32_bf16 v[88:91], v[120:123], v[20:23], v[88:91]
  ds_read_b128 v[104:107], v7 offset:14336
  v_mfma_f32_16x16x32_bf16 v[92:95], v[124:127], v[20:23], v[92:95]
  ds_read_b128 v[108:111], v7 offset:15360
  s_waitcnt vmcnt(13)
  s_waitcnt lgkmcnt(4)
  v_mfma_f32_16x16x32_bf16 v[80:83], v[128:131], v[24:27], v[80:83]
  ds_read_b128 v[112:115], v7 offset:16384
  v_mfma_f32_16x16x32_bf16 v[84:87], v[132:135], v[24:27], v[84:87]
  ds_read_b128 v[116:119], v7 offset:17408
  v_mfma_f32_16x16x32_bf16 v[88:91], v[136:139], v[24:27], v[88:91]
  ds_read_b128 v[120:123], v7 offset:18432
  v_mfma_f32_16x16x32_bf16 v[92:95], v[140:143], v[24:27], v[92:95]
  ds_read_b128 v[124:127], v7 offset:19456
  s_waitcnt vmcnt(12)
  s_waitcnt lgkmcnt(4)
  v_mfma_f32_16x16x32_bf16 v[80:83], v[96:99], v[28:31], v[80:83]
  ds_read_b128 v[128:131], v7 offset:20480
  v_mfma_f32_16x16x32_bf16 v[84:87], v[100:103], v[28:31], v[84:87]
  ds_read_b128 v[132:135], v7 offset:21504
  v_mfma_f32_16x16x32_bf16 v[88:91], v[104:107], v[28:31], v[88:91]
  ds_read_b128 v[136:139], v7 offset:22528
  v_mfma_f32_16x16x32_bf16 v[92:95], v[108:111], v[28:31], v[92:95]
  ds_read_b128 v[140:143], v7 offset:23552
  s_waitcnt vmcnt(11)
  s_waitcnt lgkmcnt(4)
  v_mfma_f32_16x16x32_bf16 v[80:83], v[112:115], v[32:35], v[80:83]
  ds_read_b128 v[96:99], v7 offset:24576
  v_mfma_f32_16x16x32_bf16 v[84:87], v[116:119], v[32:35], v[84:87]
  ds_read_b128 v[100:103], v7 offset:25600
  v_mfma_f32_16x16x32_bf16 v[88:91], v[120:123], v[32:35], v[88:91]
  ds_read_b128 v[104:107], v7 offset:26624
  v_mfma_f32_16x16x32_bf16 v[92:95], v[124:127], v[32:35], v[92:95]
  ds_read_b128 v[108:111], v7 offset:27648
  s_waitcnt vmcnt(10)
  s_waitcnt lgkmcnt(4)
  v_mfma_f32_16x16x32_bf16 v[80:83], v[128:131], v[36:39], v[80:83]
  ds_read_b128 v[112:115], v7 offset:28672
  v_mfma_f32_16x16x32_bf16 v[84:87], v[132:135], v[36:39], v[84:87]
  ds_read_b128 v[116:119], v7 offset:29696
  v_mfma_f32_16x16x32_bf16 v[88:91], v[136:139], v[36:39], v[88:91]
  ds_read_b128 v[120:123], v7 offset:30720
  v_mfma_f32_16x16x32_bf16 v[92:95], v[140:143], v[36:39], v[92:95]
  ds_read_b128 v[124:127], v7 offset:31744
  s_waitcnt vmcnt(9)
  s_waitcnt lgkmcnt(4)
  v_mfma_f32_16x16x32_bf16 v[80:83], v[96:99], v[40:43], v[80:83]
  ds_read_b128 v[128:131], v7 offset:32768
  v_mfma_f32_16x16x32_bf16 v[84:87], v[100:103], v[40:43], v[84:87]
  ds_read_b128 v[132:135], v7 offset:33792
  v_mfma_f32_16x16x32_bf16 v[88:91], v[104:107], v[40:43], v[88:91]
  ds_read_b128 v[136:139], v7 offset:34816
  v_mfma_f32_16x16x32_bf16 v[92:95], v[108:111], v[40:43], v[92:95]
  ds_read_b128 v[140:143], v7 offset:35840
  s_waitcnt vmcnt(8)
  s_waitcnt lgkmcnt(4)
  v_mfma_f32_16x16x32_bf16 v[80:83], v[112:115], v[44:47], v[80:83]
  ds_read_b128 v[96:99], v7 offset:36864
  v_mfma_f32_16x16x32_bf16 v[84:87], v[116:119], v[44:47], v[84:87]
  ds_read_b128 v[100:103], v7 offset:37888
  v_mfma_f32_16x16x32_bf16 v[88:91], v[120:123], v[44:47], v[88:91]
  ds_read_b128 v[104:107], v7 offset:38912
  v_mfma_f32_16x16x32_bf16 v[92:95], v[124:127], v[44:47], v[92:95]
  ds_read_b128 v[108:111], v7 offset:39936
  s_waitcnt vmcnt(7)
  s_waitcnt lgkmcnt(4)
  v_mfma_f32_16x16x32_bf16 v[80:83], v[128:131], v[48:51], v[80:83]
  ds_read_b128 v[112:115], v7 offset:40960
  v_mfma_f32_16x16x32_bf16 v[84:87], v[132:135], v[48:51], v[84:87]
  ds_read_b128 v[116:119], v7 offset:41984
  v_mfma_f32_16x16x32_bf16 v[88:91], v[136:139], v[48:51], v[88:91]
  ds_read_b128 v[120:123], v7 offset:43008
  v_mfma_f32_16x16x32_bf16 v[92:95], v[140:143], v[48:51], v[92:95]
  ds_read_b128 v[124:127], v7 offset:44032
  s_waitcnt vmcnt(6)
  s_waitcnt lgkmcnt(4)
  v_mfma_f32_16x16x32_bf16 v[80:83], v[96:99], v[52:55], v[80:83]
  ds_read_b128 v[128:131], v7 offset:45056
  v_mfma_f32_16x16x32_bf16 v[84:87], v[100:103], v[52:55], v[84:87]
  ds_read_b128 v[132:135], v7 offset:46080
  v_mfma_f32_16x16x32_bf16 v[88:91], v[104:107], v[52:55], v[88:91]
  ds_read_b128 v[136:139], v7 offset:47104
  v_mfma_f32_16x16x32_bf16 v[92:95], v[108:111], v[52:55], v[92:95]
  ds_read_b128 v[140:143], v7 offset:48128
  s_waitcnt vmcnt(5)
  s_waitcnt lgkmcnt(4)
  v_mfma_f32_16x16x32_bf16 v[80:83], v[112:115], v[56:59], v[80:83]
  ds_read_b128 v[96:99], v7 offset:49152
  v_mfma_f32_16x16x32_bf16 v[84:87], v[116:119], v[56:59], v[84:87]
  ds_read_b128 v[100:103], v7 offset:50176
  v_mfma_f32_16x16x32_bf16 v[88:91], v[120:123], v[56:59], v[88:91]
  ds_read_b128 v[104:107], v7 offset:51200
  v_mfma_f32_16x16x32_bf16 v[92:95], v[124:127], v[56:59], v[92:95]
  ds_read_b128 v[108:111], v7 offset:52224
  s_waitcnt vmcnt(4)
  s_waitcnt lgkmcnt(4)
  v_mfma_f32_16x16x32_bf16 v[80:83], v[128:131], v[60:63], v[80:83]
  ds_read_b128 v[112:115], v7 offset:53248
  v_mfma_f32_16x16x32_bf16 v[84:87], v[132:135], v[60:63], v[84:87]
  ds_read_b128 v[116:119], v7 offset:54272
  v_mfma_f32_16x16x32_bf16 v[88:91], v[136:139], v[60:63], v[88:91]
  ds_read_b128 v[120:123], v7 offset:55296
  v_mfma_f32_16x16x32_bf16 v[92:95], v[140:143], v[60:63], v[92:95]
  ds_read_b128 v[124:127], v7 offset:56320
  s_waitcnt vmcnt(3)
  s_waitcnt lgkmcnt(4)
  v_mfma_f32_16x16x32_bf16 v[80:83], v[96:99], v[64:67], v[80:83]
  ds_read_b128 v[128:131], v7 offset:57344
  v_mfma_f32_16x16x32_bf16 v[84:87], v[100:103], v[64:67], v[84:87]
  ds_read_b128 v[132:135], v7 offset:58368
  v_mfma_f32_16x16x32_bf16 v[88:91], v[104:107], v[64:67], v[88:91]
  ds_read_b128 v[136:139], v7 offset:59392
  v_mfma_f32_16x16x32_bf16 v[92:95], v[108:111], v[64:67], v[92:95]
  ds_read_b128 v[140:143], v7 offset:60416
  s_waitcnt vmcnt(2)
  s_waitcnt lgkmcnt(4)
  v_mfma_f32_16x16x32_bf16 v[80:83], v[112:115], v[68:71], v[80:83]
  ds_read_b128 v[96:99], v7 offset:61440
  v_mfma_f32_16x16x32_bf16 v[84:87], v[116:119], v[68:71], v[84:87]
  ds_read_b128 v[100:103], v7 offset:62464
  v_mfma_f32_16x16x32_bf16 v[88:91], v[120:123], v[68:71], v[88:91]
  ds_read_b128 v[104:107], v7 offset:63488
  v_mfma_f32_16x16x32_bf16 v[92:95], v[124:127], v[68:71], v[92:95]
  ds_read_b128 v[108:111], v7 offset:64512
  s_waitcnt vmcnt(1)
  s_waitcnt lgkmcnt(4)
  v_mfma_f32_16x16x32_bf16 v[80:83], v[128:131], v[72:75], v[80:83]
  v_mfma_f32_16x16x32_bf16 v[84:87], v[132:135], v[72:75], v[84:87]
  v_mfma_f32_16x16x32_bf16 v[88:91], v[136:139], v[72:75], v[88:91]
  v_mfma_f32_16x16x32_bf16 v[92:95], v[140:143], v[72:75], v[92:95]
  s_waitcnt vmcnt(0)
  s_waitcnt lgkmcnt(0)
  v_mfma_f32_16x16x32_bf16 v[80:83], v[96:99], v[76:79], v[80:83]
  v_mfma_f32_16x16x32_bf16 v[84:87], v[100:103], v[76:79], v[84:87]
  v_mfma_f32_16x16x32_bf16 v[88:91], v[104:107], v[76:79], v[88:91]
  v_mfma_f32_16x16x32_bf16 v[92:95], v[108:111], v[76:79], v[92:95]
  s_nop 4
  v_pk_fma_f32 v[160:161], v[196:197], v[80:81], v[160:161]
  v_pk_fma_f32 v[162:163], v[198:199], v[82:83], v[162:163]
  v_pk_fma_f32 v[164:165], v[200:201], v[84:85], v[164:165]
  v_pk_fma_f32 v[166:167], v[202:203], v[86:87], v[166:167]
  v_pk_fma_f32 v[168:169], v[204:205], v[88:89], v[168:169]
  v_pk_fma_f32 v[170:171], v[206:207], v[90:91], v[170:171]
  v_pk_fma_f32 v[172:173], v[208:209], v[92:93], v[172:173]
  v_pk_fma_f32 v[174:175], v[210:211], v[94:95], v[174:175]
  v_cvt_pk_bf16_f32 v248, v160, v161
  v_cvt_pk_bf16_f32 v249, v162, v163
  v_cvt_pk_bf16_f32 v250, v164, v165
  v_cvt_pk_bf16_f32 v251, v166, v167
  v_cvt_pk_bf16_f32 v252, v168, v169
  v_cvt_pk_bf16_f32 v253, v170, v171
  v_cvt_pk_bf16_f32 v254, v172, v173
  v_cvt_pk_bf16_f32 v255, v174, v175
  v_lshlrev_b32 v160, 16, v248
  v_and_b32 v161, s100, v248
  v_lshlrev_b32 v162, 16, v249
  v_and_b32 v163, s100, v249
  v_lshlrev_b32 v164, 16, v250
  v_and_b32 v165, s100, v250
  v_lshlrev_b32 v166, 16, v251
  v_and_b32 v167, s100, v251
  v_lshlrev_b32 v168, 16, v252
  v_and_b32 v169, s100, v252
  v_lshlrev_b32 v170, 16, v253
  v_and_b32 v171, s100, v253
  v_lshlrev_b32 v172, 16, v254
  v_and_b32 v173, s100, v254
  v_lshlrev_b32 v174, 16, v255
  v_and_b32 v175, s100, v255
  v_pk_mul_f32 v[212:213], v[212:213], v[160:161]
  v_pk_mul_f32 v[214:215], v[214:215], v[162:163]
  v_pk_mul_f32 v[216:217], v[216:217], v[164:165]
  v_pk_mul_f32 v[218:219], v[218:219], v[166:167]
  v_pk_mul_f32 v[220:221], v[220:221], v[168:169]
  v_pk_mul_f32 v[222:223], v[222:223], v[170:171]
  v_pk_mul_f32 v[224:225], v[224:225], v[172:173]
  v_pk_mul_f32 v[226:227], v[226:227], v[174:175]
  v_cvt_pk_bf16_f32 v64, v212, v213
  v_cvt_pk_bf16_f32 v65, v214, v215
  v_cvt_pk_bf16_f32 v66, v216, v217
  v_cvt_pk_bf16_f32 v67, v218, v219
  v_cvt_pk_bf16_f32 v68, v220, v221
  v_cvt_pk_bf16_f32 v69, v222, v223
  v_cvt_pk_bf16_f32 v70, v224, v225
  v_cvt_pk_bf16_f32 v71, v226, v227
  s_lshl_b32 s82, s53, 2
  s_add_u32 s82, s82, s52
  s_mul_i32 s82, s82, 14336
  s_mul_i32 s83, s54, 1792
  s_add_u32 s82, s82, s83
  s_add_u32 s82, s82, 11534336
  buffer_store_dwordx4 v[64:67], v2, s[48:51], s82 offen sc1
  s_mov_b32 exec_hi, 0x0000ffff
  buffer_store_dwordx4 v[68:71], v2, s[48:51], s82 offen offset:1024 sc1
  s_mov_b32 exec_hi, -1
  v_pk_add_f32 v[72:73], v[160:161], v[162:163]
  v_pk_mul_f32 v[74:75], v[160:161], v[160:161]
  v_pk_add_f32 v[72:73], v[72:73], v[164:165]
  v_pk_add_f32 v[72:73], v[72:73], v[166:167]
  v_pk_add_f32 v[72:73], v[72:73], v[168:169]
  v_pk_add_f32 v[72:73], v[72:73], v[170:171]
  v_pk_add_f32 v[72:73], v[72:73], v[172:173]
  v_pk_add_f32 v[72:73], v[72:73], v[174:175]
  v_pk_fma_f32 v[74:75], v[162:163], v[162:163], v[74:75]
  v_pk_fma_f32 v[74:75], v[164:165], v[164:165], v[74:75]
  v_pk_fma_f32 v[74:75], v[166:167], v[166:167], v[74:75]
  v_pk_fma_f32 v[74:75], v[168:169], v[168:169], v[74:75]
  v_pk_fma_f32 v[74:75], v[170:171], v[170:171], v[74:75]
  v_pk_fma_f32 v[74:75], v[172:173], v[172:173], v[74:75]
  v_pk_fma_f32 v[74:75], v[174:175], v[174:175], v[74:75]
  v_add_f32 v72, v72, v73
  v_add_f32 v73, v74, v75
  v_mov_b32 v5, v72
  v_mov_b32 v6, v73
  s_nop 0
  v_permlane32_swap_b32 v72, v5
  v_permlane32_swap_b32 v73, v6
  v_add_f32 v72, v72, v5
  v_add_f32 v73, v73, v6
  v_mov_b32 v5, v72
  v_mov_b32 v6, v73
  s_nop 0
  v_permlane16_swap_b32 v72, v5
  v_permlane16_swap_b32 v73, v6
  v_add_f32 v72, v72, v5
  v_add_f32 v73, v73, v6
  s_lshl_b32 s82, s53, 3
  s_add_u32 s82, s82, s54
  s_lshl_b32 s82, s82, 9
  s_lshl_b32 s83, s52, 7
  s_add_u32 s82, s82, s83
  s_add_u32 s82, s82, 65536
  v_lshlrev_b32 v7, 3, v3
  s_mov_b32 exec_lo, 0xffff
  s_mov_b32 exec_hi, 0
  buffer_store_dwordx2 v[72:73], v7, s[48:51], s82 offen sc1
  s_mov_b64 exec, -1
  s_lshl_b32 s82, s53, 7
  s_add_u32 s62, s82, 20480
  s_lshl_b32 s83, s54, 2
  s_add_u32 s66, s62, s83
  s_add_u32 s81, s77, 0
  buffer_load_dwordx4 a[136:139], v2, s[48:51], s81 offen offset:2048 sc1
  s_add_u32 s81, s78, 0
  buffer_load_dwordx4 a[192:195], v2, s[48:51], s81 offen offset:2048 sc1
  s_add_u32 s81, s77, 0
  buffer_load_dwordx4 a[140:143], v2, s[48:51], s81 offen offset:3072 sc1
  s_add_u32 s81, s78, 0
  buffer_load_dwordx4 a[196:199], v2, s[48:51], s81 offen offset:3072 sc1
  s_add_u32 s81, s77, 4096
  buffer_load_dwordx4 a[144:147], v2, s[48:51], s81 offen offset:0 sc1
  s_add_u32 s81, s78, 4096
  buffer_load_dwordx4 a[200:203], v2, s[48:51], s81 offen offset:0 sc1
  s_add_u32 s81, s77, 4096
  buffer_load_dwordx4 a[148:151], v2, s[48:51], s81 offen offset:1024 sc1
  s_add_u32 s81, s78, 4096
  buffer_load_dwordx4 a[204:207], v2, s[48:51], s81 offen offset:1024 sc1
  s_add_u32 s81, s77, 4096
  buffer_load_dwordx4 a[152:155], v2, s[48:51], s81 offen offset:2048 sc1
  s_add_u32 s81, s78, 4096
  buffer_load_dwordx4 a[208:211], v2, s[48:51], s81 offen offset:2048 sc1
  s_add_u32 s81, s77, 4096
  buffer_load_dwordx4 a[156:159], v2, s[48:51], s81 offen offset:3072 sc1
  s_add_u32 s81, s78, 4096
  buffer_load_dwordx4 a[212:215], v2, s[48:51], s81 offen offset:3072 sc1
  s_waitcnt vmcnt(12)
  s_barrier
  s_cmp_eq_u32 s52, 0
  s_cbranch_scc0 L_pub_11
  v_mov_b32 v5, s55
  s_mov_b64 exec, 1
  buffer_store_dword v5, off, s[48:51], s66 sc1
  s_mov_b64 exec, -1
L_pub_11:
  s_add_u32 s81, s77, 8192
  buffer_load_dwordx4 a[160:163], v2, s[48:51], s81 offen offset:0 sc1
  s_add_u32 s81, s78, 8192
  buffer_load_dwordx4 a[216:219], v2, s[48:51], s81 offen offset:0 sc1
  s_add_u32 s81, s77, 8192
  buffer_load_dwordx4 a[164:167], v2, s[48:51], s81 offen offset:1024 sc1
  s_add_u32 s81, s78, 8192
  buffer_load_dwordx4 a[220:223], v2, s[48:51], s81 offen offset:1024 sc1
  s_add_u32 s81, s77, 8192
  buffer_load_dwordx4 a[168:171], v2, s[48:51], s81 offen offset:2048 sc1
  s_add_u32 s81, s78, 8192
  buffer_load_dwordx4 a[224:227], v2, s[48:51], s81 offen offset:2048 sc1
  s_add_u32 s81, s77, 8192
  buffer_load_dwordx4 a[172:175], v2, s[48:51], s81 offen offset:3072 sc1
  s_add_u32 s81, s78, 8192
  buffer_load_dwordx4 a[228:231], v2, s[48:51], s81 offen offset:3072 sc1
  s_add_u32 s81, s77, 12288
  buffer_load_dwordx4 a[176:179], v2, s[48:51], s81 offen offset:0 sc1
  s_add_u32 s81, s78, 12288
  buffer_load_dwordx4 a[232:235], v2, s[48:51], s81 offen offset:0 sc1
  s_add_u32 s81, s77, 12288
  buffer_load_dwordx4 a[180:183], v2, s[48:51], s81 offen offset:1024 sc1
  s_add_u32 s81, s78, 12288
  buffer_load_dwordx4 a[236:239], v2, s[48:51], s81 offen offset:1024 sc1
  s_mov_b32 s68, 0xbdd2d3e8
  s_mov_b32 s69, 0xc0135761
  s_mov_b32 s70, 1.0
  s_mov_b32 s71, 1.0
  s_lshl_b32 s84, s53, 2
  s_add_u32 s84, s84, s52
  s_mul_i32 s84, s84, 14336
  s_add_u32 s84, s84, 11534336
  s_add_u32 s85, s84, 4096
  s_add_u32 s86, s84, 8192
  s_add_u32 s87, s84, 12288
  s_mul_i32 s88, s52, 14336
  s_add_u32 s88, s88, 65536
  v_lshlrev_b32 v7, 10, v4
  v_lshlrev_b32 v8, 3, v3
  v_add_u32 v7, v7, v8
  s_lshl_b32 s89, s53, 12
  s_lshl_b32 s90, s52, 7
  s_add_u32 s89, s89, s90
  s_add_u32 s89, s89, 65536
  v_and_b32 v5, 7, v1
  v_lshlrev_b32 v11, 2, v5
  s_mov_b32 s101, 0
  s_nop 0
L_f3_12:
  buffer_load_dword v10, v11, s[48:51], s62 offen sc1
  s_waitcnt vmcnt(0)
  v_cmp_eq_u32 vcc, s55, v10
  s_nop 3
  s_mov_b32 s82, vcc_lo
  s_and_b32 s82, s82, 0xff
  s_cmp_eq_u32 s82, 0xff
  s_cbranch_scc1 L_f3ok_13
  s_add_u32 s101, s101, 1
  s_cmp_lt_u32 s101, 131072
  s_cbranch_scc1 L_f3_12
  v_mov_b32 v5, 13
  v_mov_b32 v6, 0
  buffer_store_dword v5, v6, s[4:7], 0 offen
  s_nop 0
L_f3ok_13:
  buffer_load_dwordx2 v[204:205], v7, s[48:51], s89 offen sc1
  buffer_load_dwordx2 v[206:207], v7, s[48:51], s89 offen offset:512 sc1
  s_add_u32 m0, s88, 0
  s_nop 0
  buffer_load_dwordx4 v2, s[48:51], s84 offen offset:0 sc1 lds
  buffer_load_dwordx4 v2, s[48:51], s84 offen offset:1024 sc1 lds
  buffer_load_dwordx4 v2, s[48:51], s84 offen offset:2048 sc1 lds
  buffer_load_dwordx4 v2, s[48:51], s84 offen offset:3072 sc1 lds
  s_add_u32 m0, s88, 4096
  s_nop 0
  buffer_load_dwordx4 v2, s[48:51], s85 offen offset:0 sc1 lds
  buffer_load_dwordx4 v2, s[48:51], s85 offen offset:1024 sc1 lds
  buffer_load_dwordx4 v2, s[48:51], s85 offen offset:2048 sc1 lds
  buffer_load_dwordx4 v2, s[48:51], s85 offen offset:3072 sc1 lds
  s_add_u32 m0, s88, 8192
  s_nop 0
  buffer_load_dwordx4 v2, s[48:51], s86 offen offset:0 sc1 lds
  buffer_load_dwordx4 v2, s[48:51], s86 offen offset:1024 sc1 lds
  buffer_load_dwordx4 v2, s[48:51], s86 offen offset:2048 sc1 lds
  buffer_load_dwordx4 v2, s[48:51], s86 offen offset:3072 sc1 lds
  s_add_u32 m0, s88, 12288
  s_nop 0
  buffer_load_dwordx4 v2, s[48:51], s87 offen offset:0 sc1 lds
  buffer_load_dwordx4 v2, s[48:51], s87 offen offset:1024 sc1 lds
  v_and_b32 v8, 1, v3
  v_mul_u32_u24 v8, 896, v8
  v_lshlrev_b32 v9, 4, v4
  v_sub_u32 v8, v9, v8
  v_add_u32 v8, 159488, v8
  ds_read_b128 v[176:179], v8 offset:0
  ds_read_b128 v[180:183], v8 offset:64
  s_waitcnt lgkmcnt(1)
  v_mfma_f32_16x16x32_bf16 v[128:131], a[128:131], v[176:179], 0
  ds_read_b128 v[184:187], v8 offset:128
  v_mfma_f32_16x16x32_bf16 v[132:135], a[184:187], v[176:179], 0
  s_waitcnt lgkmcnt(1)
  v_mfma_f32_16x16x32_bf16 v[128:131], a[132:135], v[180:183], v[128:131]
  ds_read_b128 v[176:179], v8 offset:192
  v_mfma_f32_16x16x32_bf16 v[132:135], a[188:191], v[180:183], v[132:135]
  s_waitcnt lgkmcnt(1)
  v_mfma_f32_16x16x32_bf16 v[128:131], a[136:139], v[184:187], v[128:131]
  ds_read_b128 v[180:183], v8 offset:256
  v_mfma_f32_16x16x32_bf16 v[132:135], a[192:195], v[184:187], v[132:135]
  s_waitcnt lgkmcnt(1)
  v_mfma_f32_16x16x32_bf16 v[128:131], a[140:143], v[176:179], v[128:131]
  ds_read_b128 v[184:187], v8 offset:320
  v_mfma_f32_16x16x32_bf16 v[132:135], a[196:199], v[176:179], v[132:135]
  s_waitcnt lgkmcnt(1)
  v_mfma_f32_16x16x32_bf16 v[128:131], a[144:147], v[180:183], v[128:131]
  ds_read_b128 v[176:179], v8 offset:384
  v_mfma_f32_16x16x32_bf16 v[132:135], a[200:203], v[180:183], v[132:135]
  s_waitcnt lgkmcnt(1)
  v_mfma_f32_16x16x32_bf16 v[128:131], a[148:151], v[184:187], v[128:131]
  ds_read_b128 v[180:183], v8 offset:448
  v_mfma_f32_16x16x32_bf16 v[132:135], a[204:207], v[184:187], v[132:135]
  s_waitcnt lgkmcnt(1)
  v_mfma_f32_16x16x32_bf16 v[128:131], a[152:155], v[176:179], v[128:131]
  ds_read_b128 v[184:187], v8 offset:512
  v_mfma_f32_16x16x32_bf16 v[132:135], a[208:211], v[176:179], v[132:135]
  s_waitcnt lgkmcnt(1)
  v_mfma_f32_16x16x32_bf16 v[128:131], a[156:159], v[180:183], v[128:131]
  ds_read_b128 v[176:179], v8 offset:576
  v_mfma_f32_16x16x32_bf16 v[132:135], a[212:215], v[180:183], v[132:135]
  s_waitcnt lgkmcnt(1)
  v_mfma_f32_16x16x32_bf16 v[128:131], a[160:163], v[184:187], v[128:131]
  ds_read_b128 v[180:183], v8 offset:640
  v_mfma_f32_16x16x32_bf16 v[132:135], a[216:219], v[184:187], v[132:135]
  s_waitcnt lgkmcnt(1)
  v_mfma_f32_16x16x32_bf16 v[128:131], a[164:167], v[176:179], v[128:131]
  ds_read_b128 v[184:187], v8 offset:704
  v_mfma_f32_16x16x32_bf16 v[132:135], a[220:223], v[176:179], v[132:135]
  s_waitcnt lgkmcnt(1)
  v_mfma_f32_16x16x32_bf16 v[128:131], a[168:171], v[180:183], v[128:131]
  ds_read_b128 v[176:179], v8 offset:768
  v_mfma_f32_16x16x32_bf16 v[132:135], a[224:227], v[180:183], v[132:135]
  s_waitcnt lgkmcnt(1)
  v_mfma_f32_16x16x32_bf16 v[128:131], a[172:175], v[184:187], v[128:131]
  ds_read_b128 v[180:183], v8 offset:832
  v_mfma_f32_16x16x32_bf16 v[132:135], a[228:231], v[184:187], v[132:135]
  s_waitcnt lgkmcnt(1)
  v_mfma_f32_16x16x32_bf16 v[128:131], a[176:179], v[176:179], v[128:131]
  v_mfma_f32_16x16x32_bf16 v[132:135], a[232:235], v[176:179], v[132:135]
  s_waitcnt lgkmcnt(0)
  v_mfma_f32_16x16x32_bf16 v[128:131], a[180:183], v[180:183], v[128:131]
  v_mfma_f32_16x16x32_bf16 v[132:135], a[236:239], v[180:183], v[132:135]
  s_add_u32 m0, s73, 0
  s_add_u32 s81, s72, 0
  buffer_load_dwordx4 v12, s[24:27], s81 offen lds
  s_add_u32 m0, s73, 1024
  s_add_u32 s81, s72, 65536
  buffer_load_dwordx4 v13, s[24:27], s81 offen lds
  s_add_u32 m0, s73, 2048
  s_add_u32 s81, s72, 16384
  buffer_load_dwordx4 v12, s[24:27], s81 offen lds
  s_add_u32 m0, s73, 3072
  s_add_u32 s81, s72, 81920
  buffer_load_dwordx4 v13, s[24:27], s81 offen lds
  s_add_u32 m0, s73, 4096
  s_add_u32 s81, s72, 131072
  buffer_load_dwordx4 v12, s[24:27], s81 offen lds
  s_add_u32 m0, s73, 5120
  s_add_u32 s81, s72, 196608
  buffer_load_dwordx4 v13, s[24:27], s81 offen lds
  s_add_u32 m0, s73, 6144
  s_add_u32 s81, s72, 147456
  buffer_load_dwordx4 v12, s[24:27], s81 offen lds
  s_add_u32 m0, s73, 7168
  s_add_u32 s81, s72, 212992
  buffer_load_dwordx4 v13, s[24:27], s81 offen lds
  s_add_u32 m0, s73, 32768
  s_add_u32 s81, s72, 128
  buffer_load_dwordx4 v12, s[24:27], s81 offen lds
  s_add_u32 m0, s73, 33792
  s_add_u32 s81, s72, 65664
  buffer_load_dwordx4 v13, s[24:27], s81 offen lds
  s_add_u32 m0, s73, 34816
  s_add_u32 s81, s72, 16512
  buffer_load_dwordx4 v12, s[24:27], s81 offen lds
  s_add_u32 m0, s73, 35840
  s_add_u32 s81, s72, 82048
  buffer_load_dwordx4 v13, s[24:27], s81 offen lds
  s_add_u32 m0, s73, 36864
  s_add_u32 s81, s72, 131200
  buffer_load_dwordx4 v12, s[24:27], s81 offen lds
  s_add_u32 m0, s73, 37888
  s_add_u32 s81, s72, 196736
  buffer_load_dwordx4 v13, s[24:27], s81 offen lds
  s_add_u32 m0, s73, 38912
  s_add_u32 s81, s72, 147584
  buffer_load_dwordx4 v12, s[24:27], s81 offen lds
  s_add_u32 m0, s73, 39936
  s_add_u32 s81, s72, 213120
  buffer_load_dwordx4 v13, s[24:27], s81 offen lds
  s_waitcnt vmcnt(30)
  v_add_f32 v204, v204, v206
  v_add_f32 v205, v205, v207
  v_mov_b32 v5, v204
  v_mov_b32 v6, v205
  s_nop 0
  v_permlane32_swap_b32 v204, v5
  v_permlane32_swap_b32 v205, v6
  v_add_f32 v204, v204, v5
  v_add_f32 v205, v205, v6
  v_mov_b32 v5, v204
  v_mov_b32 v6, v205
  s_nop 0
  v_permlane16_swap_b32 v204, v5
  v_permlane16_swap_b32 v205, v6
  v_add_f32 v204, v204, v5
  v_add_f32 v205, v205, v6
  v_mul_f32 v204, 0x3b124925, v204
  v_mul_f32 v205, 0x3b124925, v205
  v_fma_f32 v205, -v204, v204, v205
  v_max_f32 v205, 0, v205
  v_add_f32 v205, 0x3727c5ac, v205
  v_rsq_f32 v206, v205
  v_mov_b32 v207, v204
  s_lshl_b32 s82, s52, 7
  s_add_u32 s82, s82, 131072
  v_lshlrev_b32 v7, 3, v3
  v_add_u32 v7, s82, v7
  ds_write_b64 v7, v[206:207]
  v_mov_b32_dpp v144, v128 quad_perm:[0,0,2,2] row_mask:0xf bank_mask:0xf
  v_mov_b32_dpp v160, v128 quad_perm:[1,1,3,3] row_mask:0xf bank_mask:0xf
  v_mov_b32_dpp v145, v129 quad_perm:[0,0,2,2] row_mask:0xf bank_mask:0xf
  v_mov_b32_dpp v161, v129 quad_perm:[1,1,3,3] row_mask:0xf bank_mask:0xf
  v_mov_b32_dpp v146, v130 quad_perm:[0,0,2,2] row_mask:0xf bank_mask:0xf
  v_mov_b32_dpp v162, v130 quad_perm:[1,1,3,3] row_mask:0xf bank_mask:0xf
  v_mov_b32_dpp v147, v131 quad_perm:[0,0,2,2] row_mask:0xf bank_mask:0xf
  v_mov_b32_dpp v163, v131 quad_perm:[1,1,3,3] row_mask:0xf bank_mask:0xf
  v_mov_b32_dpp v148, v132 quad_perm:[0,0,2,2] row_mask:0xf bank_mask:0xf
  v_mov_b32_dpp v164, v132 quad_perm:[1,1,3,3] row_mask:0xf bank_mask:0xf
  v_mov_b32_dpp v149, v133 quad_perm:[0,0,2,2] row_mask:0xf bank_mask:0xf
  v_mov_b32_dpp v165, v133 quad_perm:[1,1,3,3] row_mask:0xf bank_mask:0xf
  v_mov_b32_dpp v150, v134 quad_perm:[0,0,2,2] row_mask:0xf bank_mask:0xf
  v_mov_b32_dpp v166, v134 quad_perm:[1,1,3,3] row_mask:0xf bank_mask:0xf
  v_mov_b32_dpp v151, v135 quad_perm:[0,0,2,2] row_mask:0xf bank_mask:0xf
  v_mov_b32_dpp v167, v135 quad_perm:[1,1,3,3] row_mask:0xf bank_mask:0xf
  s_waitcnt vmcnt(16)
  s_waitcnt lgkmcnt(0)
  s_barrier
  v_lshlrev_b32 v7, 3, v3
  v_add_u32 v7, 131072, v7
  ds_read_b64 v[188:189], v7 offset:0
  ds_read_b64 v[190:191], v7 offset:128
  ds_read_b64 v[192:193], v7 offset:256
  ds_read_b64 v[194:195], v7 offset:384
  s_lshl_b32 s82, s54, 1
  s_add_u32 s82, s82, 0
  s_lshl_b32 s82, s82, 3
  s_lshl_b32 s83, s52, 1
  s_add_u32 s83, s83, 0
  s_add_u32 s82, s82, s83
  s_mul_i32 s82, s82, 14336
  s_add_u32 s82, s82, 2097152
  s_cmp_lt_u32 s83, 7
  s_cselect_b32 s77, s82, 2130706432
  s_lshl_b32 s82, s54, 1
  s_add_u32 s82, s82, 0
  s_lshl_b32 s82, s82, 3
  s_lshl_b32 s83, s52, 1
  s_add_u32 s83, s83, 1
  s_add_u32 s82, s82, s83
  s_mul_i32 s82, s82, 14336
  s_add_u32 s82, s82, 2097152
  s_cmp_lt_u32 s83, 7
  s_cselect_b32 s78, s82, 2130706432
  v_add_u32 v7, 65536, v2
  ds_read_b128 v[80:83], v7 offset:0
  ds_read_b128 v[84:87], v7 offset:14336
  ds_read_b128 v[88:91], v7 offset:28672
  ds_read_b128 v[92:95], v7 offset:43008
  ds_read_b128 v[96:99], v7 offset:1024
  ds_read_b128 v[100:103], v7 offset:15360
  ds_read_b128 v[104:107], v7 offset:29696
  ds_read_b128 v[108:111], v7 offset:44032
  s_waitcnt lgkmcnt(4)
  v_mfma_f32_16x16x32_bf16 v[16:19], a[128:131], v[80:83], 0
  ds_read_b128 v[112:115], v7 offset:2048
  v_mfma_f32_16x16x32_bf16 v[20:23], a[128:131], v[84:87], 0
  v_mfma_f32_16x16x32_bf16 v[24:27], a[128:131], v[88:91], 0
  ds_read_b128 v[116:119], v7 offset:16384
  v_mfma_f32_16x16x32_bf16 v[28:31], a[128:131], v[92:95], 0
  s_add_u32 s81, s77, 0
  buffer_load_dwordx4 a[0:3], v2, s[48:51], s81 offen offset:0 sc1
  v_mfma_f32_16x16x32_bf16 v[32:35], a[184:187], v[80:83], 0
  ds_read_b128 v[120:123], v7 offset:30720
  v_mfma_f32_16x16x32_bf16 v[36:39], a[184:187], v[84:87], 0
  v_mfma_f32_16x16x32_bf16 v[40:43], a[184:187], v[88:91], 0
  ds_read_b128 v[124:127], v7 offset:45056
  v_mfma_f32_16x16x32_bf16 v[44:47], a[184:187], v[92:95], 0
  s_add_u32 s81, s78, 0
  buffer_load_dwordx4 a[56:59], v2, s[48:51], s81 offen offset:0 sc1
  s_waitcnt lgkmcnt(4)
  v_mfma_f32_16x16x32_bf16 v[16:19], a[132:135], v[96:99], v[16:19]
  ds_read_b128 v[80:83], v7 offset:3072
  v_mfma_f32_16x16x32_bf16 v[20:23], a[132:135], v[100:103], v[20:23]
  v_mfma_f32_16x16x32_bf16 v[24:27], a[132:135], v[104:107], v[24:27]
  ds_read_b128 v[84:87], v7 offset:17408
  v_mfma_f32_16x16x32_bf16 v[28:31], a[132:135], v[108:111], v[28:31]
  s_add_u32 s81, s77, 0
  buffer_load_dwordx4 a[4:7], v2, s[48:51], s81 offen offset:1024 sc1
  v_mfma_f32_16x16x32_bf16 v[32:35], a[188:191], v[96:99], v[32:35]
  ds_read_b128 v[88:91], v7 offset:31744
  v_mfma_f32_16x16x32_bf16 v[36:39], a[188:191], v[100:103], v[36:39]
  v_mfma_f32_16x16x32_bf16 v[40:43], a[188:191], v[104:107], v[40:43]
  ds_read_b128 v[92:95], v7 offset:46080
  v_mfma_f32_16x16x32_bf16 v[44:47], a[188:191], v[108:111], v[44:47]
  s_add_u32 s81, s78, 0
  buffer_load_dwordx4 a[60:63], v2, s[48:51], s81 offen offset:1024 sc1
  s_waitcnt lgkmcnt(4)
  v_mfma_f32_16x16x32_bf16 v[16:19], a[136:139], v[112:115], v[16:19]
  ds_read_b128 v[96:99], v7 offset:4096
  v_mfma_f32_16x16x32_bf16 v[20:23], a[136:139], v[116:119], v[20:23]
  v_mfma_f32_16x16x32_bf16 v[24:27], a[136:139], v[120:123], v[24:27]
  ds_read_b128 v[100:103], v7 offset:18432
  v_mfma_f32_16x16x32_bf16 v[28:31], a[136:139], v[124:127], v[28:31]
  s_add_u32 s81, s77, 0
  buffer_load_dwordx4 a[8:11], v2, s[48:51], s81 offen offset:2048 sc1
  v_mfma_f32_16x16x32_bf16 v[32:35], a[192:195], v[112:115], v[32:35]
  ds_read_b128 v[104:107], v7 offset:32768
  v_mfma_f32_16x16x32_bf16 v[36:39], a[192:195], v[116:119], v[36:39]
  v_mfma_f32_16x16x32_bf16 v[40:43], a[192:195], v[120:123], v[40:43]
  ds_read_b128 v[108:111], v7 offset:47104
  v_mfma_f32_16x16x32_bf16 v[44:47], a[192:195], v[124:127], v[44:47]
  s_add_u32 s81, s78, 0
  buffer_load_dwordx4 a[64:67], v2, s[48:51], s81 offen offset:2048 sc1
  s_waitcnt lgkmcnt(4)
  v_mfma_f32_16x16x32_bf16 v[16:19], a[140:143], v[80:83], v[16:19]
  ds_read_b128 v[112:115], v7 offset:5120
  v_mfma_f32_16x16x32_bf16 v[20:23], a[140:143], v[84:87], v[20:23]
  v_mfma_f32_16x16x32_bf16 v[24:27], a[140:143], v[88:91], v[24:27]
  ds_read_b128 v[116:119], v7 offset:19456
  v_mfma_f32_16x16x32_bf16 v[28:31], a[140:143], v[92:95], v[28:31]
  s_add_u32 s81, s77, 0
  buffer_load_dwordx4 a[12:15], v2, s[48:51], s81 offen offset:3072 sc1
  v_mfma_f32_16x16x32_bf16 v[32:35], a[196:199], v[80:83], v[32:35]
  ds_read_b128 v[120:123], v7 offset:33792
  v_mfma_f32_16x16x32_bf16 v[36:39], a[196:199], v[84:87], v[36:39]
  v_mfma_f32_16x16x32_bf16 v[40:43], a[196:199], v[88:91], v[40:43]
  ds_read_b128 v[124:127], v7 offset:48128
  v_mfma_f32_16x16x32_bf16 v[44:47], a[196:199], v[92:95], v[44:47]
  s_add_u32 s81, s78, 0
  buffer_load_dwordx4 a[68:71], v2, s[48:51], s81 offen offset:3072 sc1
  s_waitcnt lgkmcnt(4)
  v_mfma_f32_16x16x32_bf16 v[16:19], a[144:147], v[96:99], v[16:19]
  ds_read_b128 v[80:83], v7 offset:6144
  v_mfma_f32_16x16x32_bf16 v[20:23], a[144:147], v[100:103], v[20:23]
  v_mfma_f32_16x16x32_bf16 v[24:27], a[144:147], v[104:107], v[24:27]
  ds_read_b128 v[84:87], v7 offset:20480
  v_mfma_f32_16x16x32_bf16 v[28:31], a[144:147], v[108:111], v[28:31]
  s_add_u32 s81, s77, 4096
  buffer_load_dwordx4 a[16:19], v2, s[48:51], s81 offen offset:0 sc1
  v_mfma_f32_16x16x32_bf16 v[32:35], a[200:203], v[96:99], v[32:35]
  ds_read_b128 v[88:91], v7 offset:34816
  v_mfma_f32_16x16x32_bf16 v[36:39], a[200:203], v[100:103], v[36:39]
  v_mfma_f32_16x16x32_bf16 v[40:43], a[200:203], v[104:107], v[40:43]
  ds_read_b128 v[92:95], v7 offset:49152
  v_mfma_f32_16x16x32_bf16 v[44:47], a[200:203], v[108:111], v[44:47]
  s_add_u32 s81, s78, 4096
  buffer_load_dwordx4 a[72:75], v2, s[48:51], s81 offen offset:0 sc1
  s_waitcnt lgkmcnt(4)
  v_mfma_f32_16x16x32_bf16 v[16:19], a[148:151], v[112:115], v[16:19]
  ds_read_b128 v[96:99], v7 offset:7168
  v_mfma_f32_16x16x32_bf16 v[20:23], a[148:151], v[116:119], v[20:23]
  v_mfma_f32_16x16x32_bf16 v[24:27], a[148:151], v[120:123], v[24:27]
  ds_read_b128 v[100:103], v7 offset:21504
  v_mfma_f32_16x16x32_bf16 v[28:31], a[148:151], v[124:127], v[28:31]
  s_add_u32 s81, s77, 4096
  buffer_load_dwordx4 a[20:23], v2, s[48:51], s81 offen offset:1024 sc1
  v_mfma_f32_16x16x32_bf16 v[32:35], a[204:207], v[112:115], v[32:35]
  ds_read_b128 v[104:107], v7 offset:35840
  v_mfma_f32_16x16x32_bf16 v[36:39], a[204:207], v[116:119], v[36:39]
  v_mfma_f32_16x16x32_bf16 v[40:43], a[204:207], v[120:123], v[40:43]
  ds_read_b128 v[108:111], v7 offset:50176
  v_mfma_f32_16x16x32_bf16 v[44:47], a[204:207], v[124:127], v[44:47]
  s_add_u32 s81, s78, 4096
  buffer_load_dwordx4 a[76:79], v2, s[48:51], s81 offen offset:1024 sc1
  s_waitcnt lgkmcnt(4)
  v_mfma_f32_16x16x32_bf16 v[16:19], a[152:155], v[80:83], v[16:19]
  ds_read_b128 v[112:115], v7 offset:8192
  v_mfma_f32_16x16x32_bf16 v[20:23], a[152:155], v[84:87], v[20:23]
  v_mfma_f32_16x16x32_bf16 v[24:27], a[152:155], v[88:91], v[24:27]
  ds_read_b128 v[116:119], v7 offset:22528
  v_mfma_f32_16x16x32_bf16 v[28:31], a[152:155], v[92:95], v[28:31]
  s_add_u32 s81, s77, 4096
  buffer_load_dwordx4 a[24:27], v2, s[48:51], s81 offen offset:2048 sc1
  v_mfma_f32_16x16x32_bf16 v[32:35], a[208:211], v[80:83], v[32:35]
  ds_read_b128 v[120:123], v7 offset:36864
  v_mfma_f32_16x16x32_bf16 v[36:39], a[208:211], v[84:87], v[36:39]
  v_mfma_f32_16x16x32_bf16 v[40:43], a[208:211], v[88:91], v[40:43]
  ds_read_b128 v[124:127], v7 offset:51200
  v_mfma_f32_16x16x32_bf16 v[44:47], a[208:211], v[92:95], v[44:47]
  s_add_u32 s81, s78, 4096
  buffer_load_dwordx4 a[80:83], v2, s[48:51], s81 offen offset:2048 sc1
  s_waitcnt lgkmcnt(4)
  v_mfma_f32_16x16x32_bf16 v[16:19], a[156:159], v[96:99], v[16:19]
  ds_read_b128 v[80:83], v7 offset:9216
  v_mfma_f32_16x16x32_bf16 v[20:23], a[156:159], v[100:103], v[20:23]
  v_mfma_f32_16x16x32_bf16 v[24:27], a[156:159], v[104:107], v[24:27]
  ds_read_b128 v[84:87], v7 offset:23552
  v_mfma_f32_16x16x32_bf16 v[28:31], a[156:159], v[108:111], v[28:31]
  s_add_u32 s81, s77, 4096
  buffer_load_dwordx4 a[28:31], v2, s[48:51], s81 offen offset:3072 sc1
  v_mfma_f32_16x16x32_bf16 v[32:35], a[212:215], v[96:99], v[32:35]
  ds_read_b128 v[88:91], v7 offset:37888
  v_mfma_f32_16x16x32_bf16 v[36:39], a[212:215], v[100:103], v[36:39]
  v_mfma_f32_16x16x32_bf16 v[40:43], a[212:215], v[104:107], v[40:43]
  ds_read_b128 v[92:95], v7 offset:52224
  v_mfma_f32_16x16x32_bf16 v[44:47], a[212:215], v[108:111], v[44:47]
  s_add_u32 s81, s78, 4096
  buffer_load_dwordx4 a[84:87], v2, s[48:51], s81 offen offset:3072 sc1
  s_waitcnt lgkmcnt(4)
  v_mfma_f32_16x16x32_bf16 v[16:19], a[160:163], v[112:115], v[16:19]
  ds_read_b128 v[96:99], v7 offset:10240
  v_mfma_f32_16x16x32_bf16 v[20:23], a[160:163], v[116:119], v[20:23]
  v_mfma_f32_16x16x32_bf16 v[24:27], a[160:163], v[120:123], v[24:27]
  ds_read_b128 v[100:103], v7 offset:24576
  v_mfma_f32_16x16x32_bf16 v[28:31], a[160:163], v[124:127], v[28:31]
  s_add_u32 s81, s77, 8192
  buffer_load_dwordx4 a[32:35], v2, s[48:51], s81 offen offset:0 sc1
  v_mfma_f32_16x16x32_bf16 v[32:35], a[216:219], v[112:115], v[32:35]
  ds_read_b128 v[104:107], v7 offset:38912
  v_mfma_f32_16x16x32_bf16 v[36:39], a[216:219], v[116:119], v[36:39]
  v_mfma_f32_16x16x32_bf16 v[40:43], a[216:219], v[120:123], v[40:43]
  ds_read_b128 v[108:111], v7 offset:53248
  v_mfma_f32_16x16x32_bf16 v[44:47], a[216:219], v[124:127], v[44:47]
  s_add_u32 s81, s78, 8192
  buffer_load_dwordx4 a[88:91], v2, s[48:51], s81 offen offset:0 sc1
  s_waitcnt lgkmcnt(4)
  v_mfma_f32_16x16x32_bf16 v[16:19], a[164:167], v[80:83], v[16:19]
  ds_read_b128 v[112:115], v7 offset:11264
  v_mfma_f32_16x16x32_bf16 v[20:23], a[164:167], v[84:87], v[20:23]
  v_mfma_f32_16x16x32_bf16 v[24:27], a[164:167], v[88:91], v[24:27]
  ds_read_b128 v[116:119], v7 offset:25600
  v_mfma_f32_16x16x32_bf16 v[28:31], a[164:167], v[92:95], v[28:31]
  s_add_u32 s81, s77, 8192
  buffer_load_dwordx4 a[36:39], v2, s[48:51], s81 offen offset:1024 sc1
  v_mfma_f32_16x16x32_bf16 v[32:35], a[220:223], v[80:83], v[32:35]
  ds_read_b128 v[120:123], v7 offset:39936
  v_mfma_f32_16x16x32_bf16 v[36:39], a[220:223], v[84:87], v[36:39]
  v_mfma_f32_16x16x32_bf16 v[40:43], a[220:223], v[88:91], v[40:43]
  ds_read_b128 v[124:127], v7 offset:54272
  v_mfma_f32_16x16x32_bf16 v[44:47], a[220:223], v[92:95], v[44:47]
  s_add_u32 s81, s78, 8192
  buffer_load_dwordx4 a[92:95], v2, s[48:51], s81 offen offset:1024 sc1
  s_waitcnt lgkmcnt(4)
  v_mfma_f32_16x16x32_bf16 v[16:19], a[168:171], v[96:99], v[16:19]
  ds_read_b128 v[80:83], v7 offset:12288
  v_mfma_f32_16x16x32_bf16 v[20:23], a[168:171], v[100:103], v[20:23]
  v_mfma_f32_16x16x32_bf16 v[24:27], a[168:171], v[104:107], v[24:27]
  ds_read_b128 v[84:87], v7 offset:26624
  v_mfma_f32_16x16x32_bf16 v[28:31], a[168:171], v[108:111], v[28:31]
  s_add_u32 s81, s77, 8192
  buffer_load_dwordx4 a[40:43], v2, s[48:51], s81 offen offset:2048 sc1
  v_mfma_f32_16x16x32_bf16 v[32:35], a[224:227], v[96:99], v[32:35]
  ds_read_b128 v[88:91], v7 offset:40960
  v_mfma_f32_16x16x32_bf16 v[36:39], a[224:227], v[100:103], v[36:39]
  v_mfma_f32_16x16x32_bf16 v[40:43], a[224:227], v[104:107], v[40:43]
  ds_read_b128 v[92:95], v7 offset:55296
  v_mfma_f32_16x16x32_bf16 v[44:47], a[224:227], v[108:111], v[44:47]
  s_add_u32 s81, s78, 8192
  buffer_load_dwordx4 a[96:99], v2, s[48:51], s81 offen offset:2048 sc1
  s_waitcnt lgkmcnt(4)
  v_mfma_f32_16x16x32_bf16 v[16:19], a[172:175], v[112:115], v[16:19]
  ds_read_b128 v[96:99], v7 offset:13312
  v_mfma_f32_16x16x32_bf16 v[20:23], a[172:175], v[116:119], v[20:23]
  v_mfma_f32_16x16x32_bf16 v[24:27], a[172:175], v[120:123], v[24:27]
  ds_read_b128 v[100:103], v7 offset:27648
  v_mfma_f32_16x16x32_bf16 v[28:31], a[172:175], v[124:127], v[28:31]
  s_add_u32 s81, s77, 8192
  buffer_load_dwordx4 a[44:47], v2, s[48:51], s81 offen offset:3072 sc1
  v_mfma_f32_16x16x32_bf16 v[32:35], a[228:231], v[112:115], v[32:35]
  ds_read_b128 v[104:107], v7 offset:41984
  v_mfma_f32_16x16x32_bf16 v[36:39], a[228:231], v[116:119], v[36:39]
  v_mfma_f32_16x16x32_bf16 v[40:43], a[228:231], v[120:123], v[40:43]
  ds_read_b128 v[108:111], v7 offset:56320
  v_mfma_f32_16x16x32_bf16 v[44:47], a[228:231], v[124:127], v[44:47]
  s_add_u32 s81, s78, 8192
  buffer_load_dwordx4 a[100:103], v2, s[48:51], s81 offen offset:3072 sc1
  s_waitcnt lgkmcnt(4)
  v_mfma_f32_16x16x32_bf16 v[16:19], a[176:179], v[80:83], v[16:19]
  v_mfma_f32_16x16x32_bf16 v[20:23], a[176:179], v[84:87], v[20:23]
  v_mfma_f32_16x16x32_bf16 v[24:27], a[176:179], v[88:91], v[24:27]
  v_mfma_f32_16x16x32_bf16 v[28:31], a[176:179], v[92:95], v[28:31]
  s_add_u32 s81, s77, 12288
  buffer_load_dwordx4 a[48:51], v2, s[48:51], s81 offen offset:0 sc1
  v_mfma_f32_16x16x32_bf16 v[32:35], a[232:235], v[80:83], v[32:35]
  v_mfma_f32_16x16x32_bf16 v[36:39], a[232:235], v[84:87], v[36:39]
  v_mfma_f32_16x16x32_bf16 v[40:43], a[232:235], v[88:91], v[40:43]
  v_mfma_f32_16x16x32_bf16 v[44:47], a[232:235], v[92:95], v[44:47]
  s_add_u32 s81, s78, 12288
  buffer_load_dwordx4 a[104:107], v2, s[48:51], s81 offen offset:0 sc1
  s_waitcnt lgkmcnt(0)
  v_mfma_f32_16x16x32_bf16 v[16:19], a[180:183], v[96:99], v[16:19]
  v_mfma_f32_16x16x32_bf16 v[20:23], a[180:183], v[100:103], v[20:23]
  v_mfma_f32_16x16x32_bf16 v[24:27], a[180:183], v[104:107], v[24:27]
  v_mfma_f32_16x16x32_bf16 v[28:31], a[180:183], v[108:111], v[28:31]
  s_add_u32 s81, s77, 12288
  buffer_load_dwordx4 a[52:55], v2, s[48:51], s81 offen offset:1024 sc1
  v_mfma_f32_16x16x32_bf16 v[32:35], a[236:239], v[96:99], v[32:35]
  v_mfma_f32_16x16x32_bf16 v[36:39], a[236:239], v[100:103], v[36:39]
  v_mfma_f32_16x16x32_bf16 v[40:43], a[236:239], v[104:107], v[40:43]
  v_mfma_f32_16x16x32_bf16 v[44:47], a[236:239], v[108:111], v[44:47]
  s_add_u32 s81, s78, 12288
  buffer_load_dwordx4 a[108:111], v2, s[48:51], s81 offen offset:1024 sc1
  s_waitcnt vmcnt(36)
  ds_read_b128 a[128:131], v14 offset:0
  ds_read_b128 a[132:135], v14 offset:2048
  ds_read_b128 a[136:139], v14 offset:4096
  ds_read_b128 a[140:143], v14 offset:6144
  ds_read_b128 a[144:147], v15 offset:0
  ds_read_b128 a[148:151], v15 offset:2048
  ds_read_b128 a[152:155], v15 offset:4096
  ds_read_b128 a[156:159], v15 offset:6144
  s_waitcnt vmcnt(28)
  ds_read_b128 a[160:163], v14 offset:32768
  ds_read_b128 a[164:167], v14 offset:34816
  ds_read_b128 a[168:171], v14 offset:36864
  ds_read_b128 a[172:175], v14 offset:38912
  ds_read_b128 a[176:179], v15 offset:32768
  ds_read_b128 a[180:183], v15 offset:34816
  ds_read_b128 a[184:187], v15 offset:36864
  ds_read_b128 a[188:191], v15 offset:38912
  v_pk_fma_f32 v[16:17], v[144:145], v[188:189], v[16:17] op_sel:[0,1,0] op_sel_hi:[1,1,1] neg_lo:[0,1,0] neg_hi:[0,1,0]
  v_pk_fma_f32 v[18:19], v[146:147], v[188:189], v[18:19] op_sel:[0,1,0] op_sel_hi:[1,1,1] neg_lo:[0,1,0] neg_hi:[0,1,0]
  v_pk_fma_f32 v[16:17], v[16:17], v[188:189], v[160:161] op_sel:[0,0,0] op_sel_hi:[1,0,1]
  v_pk_fma_f32 v[18:19], v[18:19], v[188:189], v[162:163] op_sel:[0,0,0] op_sel_hi:[1,0,1]
  v_pk_mul_f32 v[208:209], v[16:17], v[16:17]
  v_pk_mul_f32 v[210:211], v[18:19], v[18:19]
  v_pk_fma_f32 v[208:209], v[208:209], s[68:69], s[68:69] op_sel:[0,0,1] op_sel_hi:[1,0,1]
  v_pk_fma_f32 v[210:211], v[210:211], s[68:69], s[68:69] op_sel:[0,0,1] op_sel_hi:[1,0,1]
  v_pk_mul_f32 v[208:209], v[208:209], v[16:17]
  v_pk_mul_f32 v[210:211], v[210:211], v[18:19]
  v_exp_f32 v208, v208
  v_exp_f32 v209, v209
  v_exp_f32 v210, v210
  v_exp_f32 v211, v211
  v_pk_add_f32 v[208:209], v[208:209], s[70:71]
  v_pk_add_f32 v[210:211], v[210:211], s[70:71]
  v_rcp_f32 v208, v208
  v_rcp_f32 v209, v209
  v_rcp_f32 v210, v210
  v_rcp_f32 v211, v211
  v_pk_mul_f32 v[16:17], v[16:17], v[208:209]
  v_pk_mul_f32 v[18:19], v[18:19], v[210:211]
  v_pk_fma_f32 v[20:21], v[144:145], v[190:191], v[20:21] op_sel:[0,1,0] op_sel_hi:[1,1,1] neg_lo:[0,1,0] neg_hi:[0,1,0]
  v_pk_fma_f32 v[22:23], v[146:147], v[190:191], v[22:23] op_sel:[0,1,0] op_sel_hi:[1,1,1] neg_lo:[0,1,0] neg_hi:[0,1,0]
  v_pk_fma_f32 v[20:21], v[20:21], v[190:191], v[160:161] op_sel:[0,0,0] op_sel_hi:[1,0,1]
  v_pk_fma_f32 v[22:23], v[22:23], v[190:191], v[162:163] op_sel:[0,0,0] op_sel_hi:[1,0,1]
  v_pk_mul_f32 v[212:213], v[20:21], v[20:21]
  v_pk_mul_f32 v[214:215], v[22:23], v[22:23]
  v_pk_fma_f32 v[212:213], v[212:213], s[68:69], s[68:69] op_sel:[0,0,1] op_sel_hi:[1,0,1]
  v_pk_fma_f32 v[214:215], v[214:215], s[68:69], s[68:69] op_sel:[0,0,1] op_sel_hi:[1,0,1]
  v_pk_mul_f32 v[212:213], v[212:213], v[20:21]
  v_pk_mul_f32 v[214:215], v[214:215], v[22:23]
  v_exp_f32 v212, v212
  v_exp_f32 v213, v213
  v_exp_f32 v214, v214
  v_exp_f32 v215, v215
  v_pk_add_f32 v[212:213], v[212:213], s[70:71]
  v_pk_add_f32 v[214:215], v[214:215], s[70:71]
  v_rcp_f32 v212, v212
  v_rcp_f32 v213, v213
  v_rcp_f32 v214, v214
  v_rcp_f32 v215, v215
  v_pk_mul_f32 v[20:21], v[20:21], v[212:213]
  v_pk_mul_f32 v[22:23], v[22:23], v[214:215]
  v_pk_fma_f32 v[24:25], v[144:145], v[192:193], v[24:25] op_sel:[0,1,0] op_sel_hi:[1,1,1] neg_lo:[0,1,0] neg_hi:[0,1,0]
  v_pk_fma_f32 v[26:27], v[146:147], v[192:193], v[26:27] op_sel:[0,1,0] op_sel_hi:[1,1,1] neg_lo:[0,1,0] neg_hi:[0,1,0]
  v_pk_fma_f32 v[24:25], v[24:25], v[192:193], v[160:161] op_sel:[0,0,0] op_sel_hi:[1,0,1]
  v_pk_fma_f32 v[26:27], v[26:27], v[192:193], v[162:163] op_sel:[0,0,0] op_sel_hi:[1,0,1]
  v_pk_mul_f32 v[208:209], v[24:25], v[24:25]
  v_pk_mul_f32 v[210:211], v[26:27], v[26:27]
  v_pk_fma_f32 v[208:209], v[208:209], s[68:69], s[68:69] op_sel:[0,0,1] op_sel_hi:[1,0,1]
  v_pk_fma_f32 v[210:211], v[210:211], s[68:69], s[68:69] op_sel:[0,0,1] op_sel_hi:[1,0,1]
  v_pk_mul_f32 v[208:209], v[208:209], v[24:25]
  v_pk_mul_f32 v[210:211], v[210:211], v[26:27]
  v_exp_f32 v208, v208
  v_exp_f32 v209, v209
  v_exp_f32 v210, v210
  v_exp_f32 v211, v211
  v_pk_add_f32 v[208:209], v[208:209], s[70:71]
  v_pk_add_f32 v[210:211], v[210:211], s[70:71]
  v_rcp_f32 v208, v208
  v_rcp_f32 v209, v209
  v_rcp_f32 v210, v210
  v_rcp_f32 v211, v211
  v_pk_mul_f32 v[24:25], v[24:25], v[208:209]
  v_pk_mul_f32 v[26:27], v[26:27], v[210:211]
  v_pk_fma_f32 v[28:29], v[144:145], v[194:195], v[28:29] op_sel:[0,1,0] op_sel_hi:[1,1,1] neg_lo:[0,1,0] neg_hi:[0,1,0]
  v_pk_fma_f32 v[30:31], v[146:147], v[194:195], v[30:31] op_sel:[0,1,0] op_sel_hi:[1,1,1] neg_lo:[0,1,0] neg_hi:[0,1,0]
  v_pk_fma_f32 v[28:29], v[28:29], v[194:195], v[160:161] op_sel:[0,0,0] op_sel_hi:[1,0,1]
  v_pk_fma_f32 v[30:31], v[30:31], v[194:195], v[162:163] op_sel:[0,0,0] op_sel_hi:[1,0,1]
  v_pk_mul_f32 v[212:213], v[28:29], v[28:29]
  v_pk_mul_f32 v[214:215], v[30:31], v[30:31]
  v_pk_fma_f32 v[212:213], v[212:213], s[68:69], s[68:69] op_sel:[0,0,1] op_sel_hi:[1,0,1]
  v_pk_fma_f32 v[214:215], v[214:215], s[68:69], s[68:69] op_sel:[0,0,1] op_sel_hi:[1,0,1]
  v_pk_mul_f32 v[212:213], v[212:213], v[28:29]
  v_pk_mul_f32 v[214:215], v[214:215], v[30:31]
  v_exp_f32 v212, v212
  v_exp_f32 v213, v213
  v_exp_f32 v214, v214
  v_exp_f32 v215, v215
  v_pk_add_f32 v[212:213], v[212:213], s[70:71]
  v_pk_add_f32 v[214:215], v[214:215], s[70:71]
  v_rcp_f32 v212, v212
  v_rcp_f32 v213, v213
  v_rcp_f32 v214, v214
  v_rcp_f32 v215, v215
  v_pk_mul_f32 v[28:29], v[28:29], v[212:213]
  v_pk_mul_f32 v[30:31], v[30:31], v[214:215]
  v_pk_fma_f32 v[32:33], v[148:149], v[188:189], v[32:33] op_sel:[0,1,0] op_sel_hi:[1,1,1] neg_lo:[0,1,0] neg_hi:[0,1,0]
  v_pk_fma_f32 v[34:35], v[150:151], v[188:189], v[34:35] op_sel:[0,1,0] op_sel_hi:[1,1,1] neg_lo:[0,1,0] neg_hi:[0,1,0]
  v_pk_fma_f32 v[32:33], v[32:33], v[188:189], v[164:165] op_sel:[0,0,0] op_sel_hi:[1,0,1]
  v_pk_fma_f32 v[34:35], v[34:35], v[188:189], v[166:167] op_sel:[0,0,0] op_sel_hi:[1,0,1]
  v_pk_mul_f32 v[208:209], v[32:33], v[32:33]
  v_pk_mul_f32 v[210:211], v[34:35], v[34:35]
  v_pk_fma_f32 v[208:209], v[208:209], s[68:69], s[68:69] op_sel:[0,0,1] op_sel_hi:[1,0,1]
  v_pk_fma_f32 v[210:211], v[210:211], s[68:69], s[68:69] op_sel:[0,0,1] op_sel_hi:[1,0,1]
  v_pk_mul_f32 v[208:209], v[208:209], v[32:33]
  v_pk_mul_f32 v[210:211], v[210:211], v[34:35]
  v_exp_f32 v208, v208
  v_exp_f32 v209, v209
  v_exp_f32 v210, v210
  v_exp_f32 v211, v211
  v_pk_add_f32 v[208:209], v[208:209], s[70:71]
  v_pk_add_f32 v[210:211], v[210:211], s[70:71]
  v_rcp_f32 v208, v208
  v_rcp_f32 v209, v209
  v_rcp_f32 v210, v210
  v_rcp_f32 v211, v211
  v_pk_mul_f32 v[32:33], v[32:33], v[208:209]
  v_pk_mul_f32 v[34:35], v[34:35], v[210:211]
  v_pk_fma_f32 v[36:37], v[148:149], v[190:191], v[36:37] op_sel:[0,1,0] op_sel_hi:[1,1,1] neg_lo:[0,1,0] neg_hi:[0,1,0]
  v_pk_fma_f32 v[38:39], v[150:151], v[190:191], v[38:39] op_sel:[0,1,0] op_sel_hi:[1,1,1] neg_lo:[0,1,0] neg_hi:[0,1,0]
  v_pk_fma_f32 v[36:37], v[36:37], v[190:191], v[164:165] op_sel:[0,0,0] op_sel_hi:[1,0,1]
  v_pk_fma_f32 v[38:39], v[38:39], v[190:191], v[166:167] op_sel:[0,0,0] op_sel_hi:[1,0,1]
  v_pk_mul_f32 v[212:213], v[36:37], v[36:37]
  v_pk_mul_f32 v[214:215], v[38:39], v[38:39]
  v_pk_fma_f32 v[212:213], v[212:213], s[68:69], s[68:69] op_sel:[0,0,1] op_sel_hi:[1,0,1]
  v_pk_fma_f32 v[214:215], v[214:215], s[68:69], s[68:69] op_sel:[0,0,1] op_sel_hi:[1,0,1]
  v_pk_mul_f32 v[212:213], v[212:213], v[36:37]
  v_pk_mul_f32 v[214:215], v[214:215], v[38:39]
  v_exp_f32 v212, v212
  v_exp_f32 v213, v213
  v_exp_f32 v214, v214
  v_exp_f32 v215, v215
  v_pk_add_f32 v[212:213], v[212:213], s[70:71]
  v_pk_add_f32 v[214:215], v[214:215], s[70:71]
  v_rcp_f32 v212, v212
  v_rcp_f32 v213, v213
  v_rcp_f32 v214, v214
  v_rcp_f32 v215, v215
  v_pk_mul_f32 v[36:37], v[36:37], v[212:213]
  v_pk_mul_f32 v[38:39], v[38:39], v[214:215]
  v_pk_fma_f32 v[40:41], v[148:149], v[192:193], v[40:41] op_sel:[0,1,0] op_sel_hi:[1,1,1] neg_lo:[0,1,0] neg_hi:[0,1,0]
  v_pk_fma_f32 v[42:43], v[150:151], v[192:193], v[42:43] op_sel:[0,1,0] op_sel_hi:[1,1,1] neg_lo:[0,1,0] neg_hi:[0,1,0]
  v_pk_fma_f32 v[40:41], v[40:41], v[192:193], v[164:165] op_sel:[0,0,0] op_sel_hi:[1,0,1]
  v_pk_fma_f32 v[42:43], v[42:43], v[192:193], v[166:167] op_sel:[0,0,0] op_sel_hi:[1,0,1]
  v_pk_mul_f32 v[208:209], v[40:41], v[40:41]
  v_pk_mul_f32 v[210:211], v[42:43], v[42:43]
  v_pk_fma_f32 v[208:209], v[208:209], s[68:69], s[68:69] op_sel:[0,0,1] op_sel_hi:[1,0,1]
  v_pk_fma_f32 v[210:211], v[210:211], s[68:69], s[68:69] op_sel:[0,0,1] op_sel_hi:[1,0,1]
  v_pk_mul_f32 v[208:209], v[208:209], v[40:41]
  v_pk_mul_f32 v[210:211], v[210:211], v[42:43]
  v_exp_f32 v208, v208
  v_exp_f32 v209, v209
  v_exp_f32 v210, v210
  v_exp_f32 v211, v211
  v_pk_add_f32 v[208:209], v[208:209], s[70:71]
  v_pk_add_f32 v[210:211], v[210:211], s[70:71]
  v_rcp_f32 v208, v208
  v_rcp_f32 v209, v209
  v_rcp_f32 v210, v210
  v_rcp_f32 v211, v211
  v_pk_mul_f32 v[40:41], v[40:41], v[208:209]
  v_pk_mul_f32 v[42:43], v[42:43], v[210:211]
  v_pk_fma_f32 v[44:45], v[148:149], v[194:195], v[44:45] op_sel:[0,1,0] op_sel_hi:[1,1,1] neg_lo:[0,1,0] neg_hi:[0,1,0]
  v_pk_fma_f32 v[46:47], v[150:151], v[194:195], v[46:47] op_sel:[0,1,0] op_sel_hi:[1,1,1] neg_lo:[0,1,0] neg_hi:[0,1,0]
  v_pk_fma_f32 v[44:45], v[44:45], v[194:195], v[164:165] op_sel:[0,0,0] op_sel_hi:[1,0,1]
  v_pk_fma_f32 v[46:47], v[46:47], v[194:195], v[166:167] op_sel:[0,0,0] op_sel_hi:[1,0,1]
  v_pk_mul_f32 v[212:213], v[44:45], v[44:45]
  v_pk_mul_f32 v[214:215], v[46:47], v[46:47]
  v_pk_fma_f32 v[212:213], v[212:213], s[68:69], s[68:69] op_sel:[0,0,1] op_sel_hi:[1,0,1]
  v_pk_fma_f32 v[214:215], v[214:215], s[68:69], s[68:69] op_sel:[0,0,1] op_sel_hi:[1,0,1]
  v_pk_mul_f32 v[212:213], v[212:213], v[44:45]
  v_pk_mul_f32 v[214:215], v[214:215], v[46:47]
  v_exp_f32 v212, v212
  v_exp_f32 v213, v213
  v_exp_f32 v214, v214
  v_exp_f32 v215, v215
  v_pk_add_f32 v[212:213], v[212:213], s[70:71]
  v_pk_add_f32 v[214:215], v[214:215], s[70:71]
  v_rcp_f32 v212, v212
  v_rcp_f32 v213, v213
  v_rcp_f32 v214, v214
  v_rcp_f32 v215, v215
  v_pk_mul_f32 v[44:45], v[44:45], v[212:213]
  v_pk_mul_f32 v[46:47], v[46:47], v[214:215]
  v_pk_add_f32 v[208:209], v[16:17], v[18:19]
  v_pk_mul_f32 v[216:217], v[16:17], v[16:17]
  v_pk_add_f32 v[208:209], v[208:209], v[32:33]
  v_pk_fma_f32 v[216:217], v[18:19], v[18:19], v[216:217]
  v_pk_add_f32 v[208:209], v[208:209], v[34:35]
  v_pk_fma_f32 v[216:217], v[32:33], v[32:33], v[216:217]
  v_pk_fma_f32 v[216:217], v[34:35], v[34:35], v[216:217]
  v_pk_add_f32 v[210:211], v[20:21], v[22:23]
  v_pk_mul_f32 v[218:219], v[20:21], v[20:21]
  v_pk_add_f32 v[210:211], v[210:211], v[36:37]
  v_pk_fma_f32 v[218:219], v[22:23], v[22:23], v[218:219]
  v_pk_add_f32 v[210:211], v[210:211], v[38:39]
  v_pk_fma_f32 v[218:219], v[36:37], v[36:37], v[218:219]
  v_pk_fma_f32 v[218:219], v[38:39], v[38:39], v[218:219]
  v_pk_add_f32 v[212:213], v[24:25], v[26:27]
  v_pk_mul_f32 v[220:221], v[24:25], v[24:25]
  v_pk_add_f32 v[212:213], v[212:213], v[40:41]
  v_pk_fma_f32 v[220:221], v[26:27], v[26:27], v[220:221]
  v_pk_add_f32 v[212:213], v[212:213], v[42:43]
  v_pk_fma_f32 v[220:221], v[40:41], v[40:41], v[220:221]
  v_pk_fma_f32 v[220:221], v[42:43], v[42:43], v[220:221]
  v_pk_add_f32 v[214:215], v[28:29], v[30:31]
  v_pk_mul_f32 v[222:223], v[28:29], v[28:29]
  v_pk_add_f32 v[214:215], v[214:215], v[44:45]
  v_pk_fma_f32 v[222:223], v[30:31], v[30:31], v[222:223]
  v_pk_add_f32 v[214:215], v[214:215], v[46:47]
  v_pk_fma_f32 v[222:223], v[44:45], v[44:45], v[222:223]
  v_pk_fma_f32 v[222:223], v[46:47], v[46:47], v[222:223]
  v_add_f32 v208, v208, v209
  v_add_f32 v216, v216, v217
  v_add_f32 v210, v210, v211
  v_add_f32 v218, v218, v219
  v_add_f32 v212, v212, v213
  v_add_f32 v220, v220, v221
  v_add_f32 v214, v214, v215
  v_add_f32 v222, v222, v223
  v_permlane32_swap_b32 v208, v212
  v_permlane32_swap_b32 v210, v214
  v_add_f32 v208, v208, v212
  v_add_f32 v210, v210, v214
  s_nop 1
  v_permlane16_swap_b32 v208, v210
  v_add_f32 v208, v208, v210
  v_permlane32_swap_b32 v216, v220
  v_permlane32_swap_b32 v218, v222
  v_add_f32 v216, v216, v220
  v_add_f32 v218, v218, v222
  s_nop 1
  v_permlane16_swap_b32 v216, v218
  v_add_f32 v216, v216, v218
  v_mov_b32 v209, v216
  s_lshl_b32 s82, s52, 9
  s_add_u32 s82, s82, 132096
  v_lshlrev_b32 v7, 3, v1
  v_add_u32 v7, s82, v7
  ds_write_b64 v7, v[208:209]
  v_lshlrev_b32 v7, 9, v4
  v_lshlrev_b32 v8, 3, v3
  v_add_u32 v7, v7, v8
  s_lshl_b32 s82, s52, 7
  s_add_u32 s82, s82, 132096
  v_add_u32 v7, s82, v7
  s_lshl_b32 s82, s53, 3
  s_add_u32 s82, s82, s54
  s_lshl_b32 s82, s82, 10
  s_lshl_b32 s83, s52, 8
  s_add_u32 s82, s82, s83
  s_add_u32 s84, s82, 196608
  v_lshlrev_b32 v8, 4, v3
  s_waitcnt lgkmcnt(0)
  s_barrier
  ds_read_b64 v[208:209], v7
  s_waitcnt lgkmcnt(0)
  v_mov_b32 v5, v208
  v_mov_b32 v6, v209
  s_nop 0
  v_permlane32_swap_b32 v208, v5
  v_permlane32_swap_b32 v209, v6
  v_add_f32 v208, v208, v5
  v_add_f32 v209, v209, v6
  v_mov_b32 v5, v208
  v_mov_b32 v6, v209
  s_nop 0
  v_permlane16_swap_b32 v208, v5
  v_permlane16_swap_b32 v209, v6
  v_add_f32 v208, v208, v5
  v_add_f32 v209, v209, v6
  v_mov_b32 v210, v209
  v_mov_b32 v209, s55
  v_mov_b32 v211, s55
  s_mov_b32 exec_lo, 0xffff
  s_mov_b32 exec_hi, 0
  buffer_store_dwordx4 v[208:211], v8, s[48:51], s84 offen sc1
  s_mov_b64 exec, -1
  v_and_b32 v8, 1, v3
  v_mul_u32_u24 v8, 896, v8
  v_lshlrev_b32 v9, 4, v4
  v_sub_u32 v8, v9, v8
  v_add_u32 v8, 159488, v8
  s_waitcnt vmcnt(1)
  ds_read_b128 v[176:179], v8 offset:0
  ds_read_b128 v[180:183], v8 offset:64
  s_waitcnt lgkmcnt(1)
  v_mfma_f32_16x16x32_bf16 v[136:139], a[0:3], v[176:179], 0
  ds_read_b128 v[184:187], v8 offset:128
  v_mfma_f32_16x16x32_bf16 v[140:143], a[56:59], v[176:179], 0
  s_waitcnt lgkmcnt(1)
  v_mfma_f32_16x16x32_bf16 v[136:139], a[4:7], v[180:183], v[136:139]
  ds_read_b128 v[176:179], v8 offset:192
  v_mfma_f32_16x16x32_bf16 v[140:143], a[60:63], v[180:183], v[140:143]
  s_waitcnt lgkmcnt(1)
  v_mfma_f32_16x16x32_bf16 v[136:139], a[8:11], v[184:187], v[136:139]
  ds_read_b128 v[180:183], v8 offset:256
  v_mfma_f32_16x16x32_bf16 v[140:143], a[64:67], v[184:187], v[140:143]
  s_waitcnt lgkmcnt(1)
  v_mfma_f32_16x16x32_bf16 v[136:139], a[12:15], v[176:179], v[136:139]
  ds_read_b128 v[184:187], v8 offset:320
  v_mfma_f32_16x16x32_bf16 v[140:143], a[68:71], v[176:179], v[140:143]
  s_waitcnt lgkmcnt(1)
  v_mfma_f32_16x16x32_bf16 v[136:139], a[16:19], v[180:183], v[136:139]
  ds_read_b128 v[176:179], v8 offset:384
  v_mfma_f32_16x16x32_bf16 v[140:143], a[72:75], v[180:183], v[140:143]
  s_waitcnt lgkmcnt(1)
  v_mfma_f32_16x16x32_bf16 v[136:139], a[20:23], v[184:187], v[136:139]
  ds_read_b128 v[180:183], v8 offset:448
  v_mfma_f32_16x16x32_bf16 v[140:143], a[76:79], v[184:187], v[140:143]
  s_waitcnt lgkmcnt(1)
  v_mfma_f32_16x16x32_bf16 v[136:139], a[24:27], v[176:179], v[136:139]
  ds_read_b128 v[184:187], v8 offset:512
  v_mfma_f32_16x16x32_bf16 v[140:143], a[80:83], v[176:179], v[140:143]
  s_waitcnt lgkmcnt(1)
  v_mfma_f32_16x16x32_bf16 v[136:139], a[28:31], v[180:183], v[136:139]
  ds_read_b128 v[176:179], v8 offset:576
  v_mfma_f32_16x16x32_bf16 v[140:143], a[84:87], v[180:183], v[140:143]
  s_waitcnt lgkmcnt(1)
  v_mfma_f32_16x16x32_bf16 v[136:139], a[32:35], v[184:187], v[136:139]
  ds_read_b128 v[180:183], v8 offset:640
  v_mfma_f32_16x16x32_bf16 v[140:143], a[88:91], v[184:187], v[140:143]
  s_waitcnt lgkmcnt(1)
  v_mfma_f32_16x16x32_bf16 v[136:139], a[36:39], v[176:179], v[136:139]
  ds_read_b128 v[184:187], v8 offset:704
  v_mfma_f32_16x16x32_bf16 v[140:143], a[92:95], v[176:179], v[140:143]
  s_waitcnt lgkmcnt(1)
  v_mfma_f32_16x16x32_bf16 v[136:139], a[40:43], v[180:183], v[136:139]
  ds_read_b128 v[176:179], v8 offset:768
  v_mfma_f32_16x16x32_bf16 v[140:143], a[96:99], v[180:183], v[140:143]
  s_waitcnt lgkmcnt(1)
  v_mfma_f32_16x16x32_bf16 v[136:139], a[44:47], v[184:187], v[136:139]
  ds_read_b128 v[180:183], v8 offset:832
  v_mfma_f32_16x16x32_bf16 v[140:143], a[100:103], v[184:187], v[140:143]
  s_waitcnt lgkmcnt(1)
  v_mfma_f32_16x16x32_bf16 v[136:139], a[48:51], v[176:179], v[136:139]
  v_mfma_f32_16x16x32_bf16 v[140:143], a[104:107], v[176:179], v[140:143]
  s_waitcnt lgkmcnt(0)
  v_mfma_f32_16x16x32_bf16 v[136:139], a[52:55], v[180:183], v[136:139]
  v_mfma_f32_16x16x32_bf16 v[140:143], a[108:111], v[180:183], v[140:143]
  v_lshlrev_b32 v204, 11, v4
  v_lshlrev_b32 v205, 4, v3
  v_add_u32 v204, v204, v205
  s_lshl_b32 s82, s53, 13
  s_lshl_b32 s83, s52, 8
  s_add_u32 s82, s82, s83
  s_add_u32 s64, s82, 196608
  v_add_u32 v7, 65536, v2
  ds_read_b128 v[80:83], v7 offset:0
  ds_read_b128 v[84:87], v7 offset:14336
  ds_read_b128 v[88:91], v7 offset:28672
  ds_read_b128 v[92:95], v7 offset:43008
  ds_read_b128 v[96:99], v7 offset:1024
  ds_read_b128 v[100:103], v7 offset:15360
  ds_read_b128 v[104:107], v7 offset:29696
  ds_read_b128 v[108:111], v7 offset:44032
  s_waitcnt lgkmcnt(4)
  v_mfma_f32_16x16x32_bf16 v[48:51], a[0:3], v[80:83], 0
  ds_read_b128 v[112:115], v7 offset:2048
  v_mfma_f32_16x16x32_bf16 v[52:55], a[0:3], v[84:87], 0
  v_mfma_f32_16x16x32_bf16 v[56:59], a[0:3], v[88:91], 0
  ds_read_b128 v[116:119], v7 offset:16384
  v_mfma_f32_16x16x32_bf16 v[60:63], a[0:3], v[92:95], 0
  s_add_u32 m0, s73, 0
  s_add_u32 s81, s72, 256
  buffer_load_dwordx4 v12, s[24:27], s81 offen lds
  v_mfma_f32_16x16x32_bf16 v[64:67], a[56:59], v[80:83], 0
  ds_read_b128 v[120:123], v7 offset:30720
  v_mfma_f32_16x16x32_bf16 v[68:71], a[56:59], v[84:87], 0
  v_mfma_f32_16x16x32_bf16 v[72:75], a[56:59], v[88:91], 0
  ds_read_b128 v[124:127], v7 offset:45056
  v_mfma_f32_16x16x32_bf16 v[76:79], a[56:59], v[92:95], 0
  s_add_u32 m0, s73, 1024
  s_add_u32 s81, s72, 65792
  buffer_load_dwordx4 v13, s[24:27], s81 offen lds
  s_waitcnt lgkmcnt(4)
  v_mfma_f32_16x16x32_bf16 v[48:51], a[4:7], v[96:99], v[48:51]
  ds_read_b128 v[80:83], v7 offset:3072
  v_mfma_f32_16x16x32_bf16 v[52:55], a[4:7], v[100:103], v[52:55]
  v_mfma_f32_16x16x32_bf16 v[56:59], a[4:7], v[104:107], v[56:59]
  ds_read_b128 v[84:87], v7 offset:17408
  v_mfma_f32_16x16x32_bf16 v[60:63], a[4:7], v[108:111], v[60:63]
  s_add_u32 m0, s73, 2048
  s_add_u32 s81, s72, 16640
  buffer_load_dwordx4 v12, s[24:27], s81 offen lds
  v_mfma_f32_16x16x32_bf16 v[64:67], a[60:63], v[96:99], v[64:67]
  ds_read_b128 v[88:91], v7 offset:31744
  v_mfma_f32_16x16x32_bf16 v[68:71], a[60:63], v[100:103], v[68:71]
  v_mfma_f32_16x16x32_bf16 v[72:75], a[60:63], v[104:107], v[72:75]
  ds_read_b128 v[92:95], v7 offset:46080
  v_mfma_f32_16x16x32_bf16 v[76:79], a[60:63], v[108:111], v[76:79]
  s_add_u32 m0, s73, 3072
  s_add_u32 s81, s72, 82176
  buffer_load_dwordx4 v13, s[24:27], s81 offen lds
  s_waitcnt lgkmcnt(4)
  v_mfma_f32_16x16x32_bf16 v[48:51], a[8:11], v[112:115], v[48:51]
  ds_read_b128 v[96:99], v7 offset:4096
  v_mfma_f32_16x16x32_bf16 v[52:55], a[8:11], v[116:119], v[52:55]
  v_mfma_f32_16x16x32_bf16 v[56:59], a[8:11], v[120:123], v[56:59]
  ds_read_b128 v[100:103], v7 offset:18432
  v_mfma_f32_16x16x32_bf16 v[60:63], a[8:11], v[124:127], v[60:63]
  s_add_u32 m0, s73, 4096
  s_add_u32 s81, s72, 131328
  buffer_load_dwordx4 v12, s[24:27], s81 offen lds
  v_mfma_f32_16x16x32_bf16 v[64:67], a[64:67], v[112:115], v[64:67]
  ds_read_b128 v[104:107], v7 offset:32768
  v_mfma_f32_16x16x32_bf16 v[68:71], a[64:67], v[116:119], v[68:71]
  v_mfma_f32_16x16x32_bf16 v[72:75], a[64:67], v[120:123], v[72:75]
  ds_read_b128 v[108:111], v7 offset:47104
  v_mfma_f32_16x16x32_bf16 v[76:79], a[64:67], v[124:127], v[76:79]
  s_add_u32 m0, s73, 5120
  s_add_u32 s81, s72, 196864
  buffer_load_dwordx4 v13, s[24:27], s81 offen lds
  s_waitcnt lgkmcnt(4)
  v_mfma_f32_16x16x32_bf16 v[48:51], a[12:15], v[80:83], v[48:51]
  ds_read_b128 v[112:115], v7 offset:5120
  v_mfma_f32_16x16x32_bf16 v[52:55], a[12:15], v[84:87], v[52:55]
  v_mfma_f32_16x16x32_bf16 v[56:59], a[12:15], v[88:91], v[56:59]
  ds_read_b128 v[116:119], v7 offset:19456
  v_mfma_f32_16x16x32_bf16 v[60:63], a[12:15], v[92:95], v[60:63]
  s_add_u32 m0, s73, 6144
  s_add_u32 s81, s72, 147712
  buffer_load_dwordx4 v12, s[24:27], s81 offen lds
  v_mfma_f32_16x16x32_bf16 v[64:67], a[68:71], v[80:83], v[64:67]
  ds_read_b128 v[120:123], v7 offset:33792
  v_mfma_f32_16x16x32_bf16 v[68:71], a[68:71], v[84:87], v[68:71]
  v_mfma_f32_16x16x32_bf16 v[72:75], a[68:71], v[88:91], v[72:75]
  ds_read_b128 v[124:127], v7 offset:48128
  v_mfma_f32_16x16x32_bf16 v[76:79], a[68:71], v[92:95], v[76:79]
  s_add_u32 m0, s73, 7168
  s_add_u32 s81, s72, 213248
  buffer_load_dwordx4 v13, s[24:27], s81 offen lds
  s_waitcnt lgkmcnt(4)
  v_mfma_f32_16x16x32_bf16 v[48:51], a[16:19], v[96:99], v[48:51]
  ds_read_b128 v[80:83], v7 offset:6144
  v_mfma_f32_16x16x32_bf16 v[52:55], a[16:19], v[100:103], v[52:55]
  v_mfma_f32_16x16x32_bf16 v[56:59], a[16:19], v[104:107], v[56:59]
  ds_read_b128 v[84:87], v7 offset:20480
  v_mfma_f32_16x16x32_bf16 v[60:63], a[16:19], v[108:111], v[60:63]
  s_add_u32 m0, s73, 32768
  s_add_u32 s81, s72, 384
  buffer_load_dwordx4 v12, s[24:27], s81 offen lds
  v_mfma_f32_16x16x32_bf16 v[64:67], a[72:75], v[96:99], v[64:67]
  ds_read_b128 v[88:91], v7 offset:34816
  v_mfma_f32_16x16x32_bf16 v[68:71], a[72:75], v[100:103], v[68:71]
  v_mfma_f32_16x16x32_bf16 v[72:75], a[72:75], v[104:107], v[72:75]
  ds_read_b128 v[92:95], v7 offset:49152
  v_mfma_f32_16x16x32_bf16 v[76:79], a[72:75], v[108:111], v[76:79]
  s_add_u32 m0, s73, 33792
  s_add_u32 s81, s72, 65920
  buffer_load_dwordx4 v13, s[24:27], s81 offen lds
  s_waitcnt lgkmcnt(4)
  v_mfma_f32_16x16x32_bf16 v[48:51], a[20:23], v[112:115], v[48:51]
  ds_read_b128 v[96:99], v7 offset:7168
  v_mfma_f32_16x16x32_bf16 v[52:55], a[20:23], v[116:119], v[52:55]
  v_mfma_f32_16x16x32_bf16 v[56:59], a[20:23], v[120:123], v[56:59]
  ds_read_b128 v[100:103], v7 offset:21504
  v_mfma_f32_16x16x32_bf16 v[60:63], a[20:23], v[124:127], v[60:63]
  s_add_u32 m0, s73, 34816
  s_add_u32 s81, s72, 16768
  buffer_load_dwordx4 v12, s[24:27], s81 offen lds
  v_mfma_f32_16x16x32_bf16 v[64:67], a[76:79], v[112:115], v[64:67]
  ds_read_b128 v[104:107], v7 offset:35840
  v_mfma_f32_16x16x32_bf16 v[68:71], a[76:79], v[116:119], v[68:71]
  v_mfma_f32_16x16x32_bf16 v[72:75], a[76:79], v[120:123], v[72:75]
  ds_read_b128 v[108:111], v7 offset:50176
  v_mfma_f32_16x16x32_bf16 v[76:79], a[76:79], v[124:127], v[76:79]
  s_add_u32 m0, s73, 35840
  s_add_u32 s81, s72, 82304
  buffer_load_dwordx4 v13, s[24:27], s81 offen lds
  s_waitcnt lgkmcnt(4)
  v_mfma_f32_16x16x32_bf16 v[48:51], a[24:27], v[80:83], v[48:51]
  ds_read_b128 v[112:115], v7 offset:8192
  v_mfma_f32_16x16x32_bf16 v[52:55], a[24:27], v[84:87], v[52:55]
  v_mfma_f32_16x16x32_bf16 v[56:59], a[24:27], v[88:91], v[56:59]
  ds_read_b128 v[116:119], v7 offset:22528
  v_mfma_f32_16x16x32_bf16 v[60:63], a[24:27], v[92:95], v[60:63]
  s_add_u32 m0, s73, 36864
  s_add_u32 s81, s72, 131456
  buffer_load_dwordx4 v12, s[24:27], s81 offen lds
  v_mfma_f32_16x16x32_bf16 v[64:67], a[80:83], v[80:83], v[64:67]
  ds_read_b128 v[120:123], v7 offset:36864
  v_mfma_f32_16x16x32_bf16 v[68:71], a[80:83], v[84:87], v[68:71]
  v_mfma_f32_16x16x32_bf16 v[72:75], a[80:83], v[88:91], v[72:75]
  ds_read_b128 v[124:127], v7 offset:51200
  v_mfma_f32_16x16x32_bf16 v[76:79], a[80:83], v[92:95], v[76:79]
  s_add_u32 m0, s73, 37888
  s_add_u32 s81, s72, 196992
  buffer_load_dwordx4 v13, s[24:27], s81 offen lds
  s_waitcnt lgkmcnt(4)
  v_mfma_f32_16x16x32_bf16 v[48:51], a[28:31], v[96:99], v[48:51]
  ds_read_b128 v[80:83], v7 offset:9216
  v_mfma_f32_16x16x32_bf16 v[52:55], a[28:31], v[100:103], v[52:55]
  v_mfma_f32_16x16x32_bf16 v[56:59], a[28:31], v[104:107], v[56:59]
  ds_read_b128 v[84:87], v7 offset:23552
  v_mfma_f32_16x16x32_bf16 v[60:63], a[28:31], v[108:111], v[60:63]
  s_add_u32 m0, s73, 38912
  s_add_u32 s81, s72, 147840
  buffer_load_dwordx4 v12, s[24:27], s81 offen lds
  v_mfma_f32_16x16x32_bf16 v[64:67], a[84:87], v[96:99], v[64:67]
  ds_read_b128 v[88:91], v7 offset:37888
  v_mfma_f32_16x16x32_bf16 v[68:71], a[84:87], v[100:103], v[68:71]
  v_mfma_f32_16x16x32_bf16 v[72:75], a[84:87], v[104:107], v[72:75]
  ds_read_b128 v[92:95], v7 offset:52224
  v_mfma_f32_16x16x32_bf16 v[76:79], a[84:87], v[108:111], v[76:79]
  s_add_u32 m0, s73, 39936
  s_add_u32 s81, s72, 213376
  buffer_load_dwordx4 v13, s[24:27], s81 offen lds
  buffer_load_dwordx4 v[208:211], v204, s[48:51], s64 offen sc1
  buffer_load_dwordx4 v[212:215], v204, s[48:51], s64 offen offset:1024 sc1
  s_waitcnt lgkmcnt(4)
  v_mfma_f32_16x16x32_bf16 v[48:51], a[32:35], v[112:115], v[48:51]
  ds_read_b128 v[96:99], v7 offset:10240
  v_mfma_f32_16x16x32_bf16 v[52:55], a[32:35], v[116:119], v[52:55]
  v_mfma_f32_16x16x32_bf16 v[56:59], a[32:35], v[120:123], v[56:59]
  ds_read_b128 v[100:103], v7 offset:24576
  v_mfma_f32_16x16x32_bf16 v[60:63], a[32:35], v[124:127], v[60:63]
  v_mfma_f32_16x16x32_bf16 v[64:67], a[88:91], v[112:115], v[64:67]
  ds_read_b128 v[104:107], v7 offset:38912
  v_mfma_f32_16x16x32_bf16 v[68:71], a[88:91], v[116:119], v[68:71]
  v_mfma_f32_16x16x32_bf16 v[72:75], a[88:91], v[120:123], v[72:75]
  ds_read_b128 v[108:111], v7 offset:53248
  v_mfma_f32_16x16x32_bf16 v[76:79], a[88:91], v[124:127], v[76:79]
  s_waitcnt lgkmcnt(4)
  v_mfma_f32_16x16x32_bf16 v[48:51], a[36:39], v[80:83], v[48:51]
  ds_read_b128 v[112:115], v7 offset:11264
  v_mfma_f32_16x16x32_bf16 v[52:55], a[36:39], v[84:87], v[52:55]
  v_mfma_f32_16x16x32_bf16 v[56:59], a[36:39], v[88:91], v[56:59]
  ds_read_b128 v[116:119], v7 offset:25600
  v_mfma_f32_16x16x32_bf16 v[60:63], a[36:39], v[92:95], v[60:63]
  v_mfma_f32_16x16x32_bf16 v[64:67], a[92:95], v[80:83], v[64:67]
  ds_read_b128 v[120:123], v7 offset:39936
  v_mfma_f32_16x16x32_bf16 v[68:71], a[92:95], v[84:87], v[68:71]
  v_mfma_f32_16x16x32_bf16 v[72:75], a[92:95], v[88:91], v[72:75]
  ds_read_b128 v[124:127], v7 offset:54272
  v_mfma_f32_16x16x32_bf16 v[76:79], a[92:95], v[92:95], v[76:79]
  s_waitcnt lgkmcnt(4)
  v_mfma_f32_16x16x32_bf16 v[48:51], a[40:43], v[96:99], v[48:51]
  ds_read_b128 v[80:83], v7 offset:12288
  v_mfma_f32_16x16x32_bf16 v[52:55], a[40:43], v[100:103], v[52:55]
  v_mfma_f32_16x16x32_bf16 v[56:59], a[40:43], v[104:107], v[56:59]
  ds_read_b128 v[84:87], v7 offset:26624
  v_mfma_f32_16x16x32_bf16 v[60:63], a[40:43], v[108:111], v[60:63]
  v_mfma_f32_16x16x32_bf16 v[64:67], a[96:99], v[96:99], v[64:67]
  ds_read_b128 v[88:91], v7 offset:40960
  v_mfma_f32_16x16x32_bf16 v[68:71], a[96:99], v[100:103], v[68:71]
  v_mfma_f32_16x16x32_bf16 v[72:75], a[96:99], v[104:107], v[72:75]
  ds_read_b128 v[92:95], v7 offset:55296
  v_mfma_f32_16x16x32_bf16 v[76:79], a[96:99], v[108:111], v[76:79]
  s_waitcnt lgkmcnt(4)
  v_mfma_f32_16x16x32_bf16 v[48:51], a[44:47], v[112:115], v[48:51]
  ds_read_b128 v[96:99], v7 offset:13312
  v_mfma_f32_16x16x32_bf16 v[52:55], a[44:47], v[116:119], v[52:55]
  v_mfma_f32_16x16x32_bf16 v[56:59], a[44:47], v[120:123], v[56:59]
  ds_read_b128 v[100:103], v7 offset:27648
  v_mfma_f32_16x16x32_bf16 v[60:63], a[44:47], v[124:127], v[60:63]
  v_mfma_f32_16x16x32_bf16 v[64:67], a[100:103], v[112:115], v[64:67]
  ds_read_b128 v[104:107], v7 offset:41984
  v_mfma_f32_16x16x32_bf16 v[68:71], a[100:103], v[116:119], v[68:71]
  v_mfma_f32_16x16x32_bf16 v[72:75], a[100:103], v[120:123], v[72:75]
  ds_read_b128 v[108:111], v7 offset:56320
  v_mfma_f32_16x16x32_bf16 v[76:79], a[100:103], v[124:127], v[76:79]
  s_waitcnt lgkmcnt(4)
  v_mfma_f32_16x16x32_bf16 v[48:51], a[48:51], v[80:83], v[48:51]
  v_mfma_f32_16x16x32_bf16 v[52:55], a[48:51], v[84:87], v[52:55]
  v_mfma_f32_16x16x32_bf16 v[56:59], a[48:51], v[88:91], v[56:59]
  v_mfma_f32_16x16x32_bf16 v[60:63], a[48:51], v[92:95], v[60:63]
  v_mfma_f32_16x16x32_bf16 v[64:67], a[104:107], v[80:83], v[64:67]
  v_mfma_f32_16x16x32_bf16 v[68:71], a[104:107], v[84:87], v[68:71]
  v_mfma_f32_16x16x32_bf16 v[72:75], a[104:107], v[88:91], v[72:75]
  v_mfma_f32_16x16x32_bf16 v[76:79], a[104:107], v[92:95], v[76:79]
  s_waitcnt lgkmcnt(0)
  v_mfma_f32_16x16x32_bf16 v[48:51], a[52:55], v[96:99], v[48:51]
  v_mfma_f32_16x16x32_bf16 v[52:55], a[52:55], v[100:103], v[52:55]
  v_mfma_f32_16x16x32_bf16 v[56:59], a[52:55], v[104:107], v[56:59]
  v_mfma_f32_16x16x32_bf16 v[60:63], a[52:55], v[108:111], v[60:63]
  v_mfma_f32_16x16x32_bf16 v[64:67], a[108:111], v[96:99], v[64:67]
  v_mfma_f32_16x16x32_bf16 v[68:71], a[108:111], v[100:103], v[68:71]
  v_mfma_f32_16x16x32_bf16 v[72:75], a[108:111], v[104:107], v[72:75]
  v_mfma_f32_16x16x32_bf16 v[76:79], a[108:111], v[108:111], v[76:79]
  v_mov_b32_dpp v152, v136 quad_perm:[0,0,2,2] row_mask:0xf bank_mask:0xf
  v_mov_b32_dpp v168, v136 quad_perm:[1,1,3,3] row_mask:0xf bank_mask:0xf
  v_mov_b32_dpp v153, v137 quad_perm:[0,0,2,2] row_mask:0xf bank_mask:0xf
  v_mov_b32_dpp v169, v137 quad_perm:[1,1,3,3] row_mask:0xf bank_mask:0xf
  v_mov_b32_dpp v154, v138 quad_perm:[0,0,2,2] row_mask:0xf bank_mask:0xf
  v_mov_b32_dpp v170, v138 quad_perm:[1,1,3,3] row_mask:0xf bank_mask:0xf
  v_mov_b32_dpp v155, v139 quad_perm:[0,0,2,2] row_mask:0xf bank_mask:0xf
  v_mov_b32_dpp v171, v139 quad_perm:[1,1,3,3] row_mask:0xf bank_mask:0xf
  v_mov_b32_dpp v156, v140 quad_perm:[0,0,2,2] row_mask:0xf bank_mask:0xf
  v_mov_b32_dpp v172, v140 quad_perm:[1,1,3,3] row_mask:0xf bank_mask:0xf
  v_mov_b32_dpp v157, v141 quad_perm:[0,0,2,2] row_mask:0xf bank_mask:0xf
  v_mov_b32_dpp v173, v141 quad_perm:[1,1,3,3] row_mask:0xf bank_mask:0xf
  v_mov_b32_dpp v158, v142 quad_perm:[0,0,2,2] row_mask:0xf bank_mask:0xf
  v_mov_b32_dpp v174, v142 quad_perm:[1,1,3,3] row_mask:0xf bank_mask:0xf
  v_mov_b32_dpp v159, v143 quad_perm:[0,0,2,2] row_mask:0xf bank_mask:0xf
  v_mov_b32_dpp v175, v143 quad_perm:[1,1,3,3] row_mask:0xf bank_mask:0xf
  s_waitcnt vmcnt(10)
  ds_read_b128 a[192:195], v14 offset:0
  ds_read_b128 a[196:199], v14 offset:2048
  ds_read_b128 a[200:203], v14 offset:4096
  ds_read_b128 a[204:207], v14 offset:6144
  ds_read_b128 a[208:211], v15 offset:0
  ds_read_b128 a[212:215], v15 offset:2048
  ds_read_b128 a[216:219], v15 offset:4096
  ds_read_b128 a[220:223], v15 offset:6144
  s_waitcnt vmcnt(2)
  ds_read_b128 a[224:227], v14 offset:32768
  ds_read_b128 a[228:231], v14 offset:34816
  ds_read_b128 a[232:235], v14 offset:36864
  ds_read_b128 a[236:239], v14 offset:38912
  ds_read_b128 a[240:243], v15 offset:32768
  ds_read_b128 a[244:247], v15 offset:34816
  ds_read_b128 a[248:251], v15 offset:36864
  ds_read_b128 a[252:255], v15 offset:38912
  s_lshl_b32 s82, s52, 12
  s_add_u32 s82, s82, 135168
  v_lshrrev_b32 v8, 2, v3
  v_xor_b32 v8, v8, v4
  v_lshlrev_b32 v8, 3, v8
  v_lshlrev_b32 v9, 5, v3
  v_add_u32 v8, v8, v9
  v_add_u32 v8, s82, v8
  v_lshrrev_b32 v9, 2, v3
  v_lshlrev_b32 v10, 2, v4
  v_add_u32 v9, v9, v10
  v_lshlrev_b32 v9, 5, v9
  v_and_b32 v10, 3, v3
  v_xor_b32 v10, v10, v4
  v_lshlrev_b32 v10, 3, v10
  v_add_u32 v9, v9, v10
  v_add_u32 v9, s82, v9
  v_lshlrev_b32 v7, 3, v3
  v_add_u32 v7, 131584, v7
  s_lshl_b32 s82, s52, 7
  v_add_u32 v10, s82, v7
  s_lshl_b32 s82, s54, 6
  s_lshl_b32 s83, s53, 1
  s_add_u32 s82, s82, s83
  s_mul_i32 s82, s82, 7
  s_lshl_b32 s83, s52, 1
  s_add_u32 s83, s83, 0
  s_add_u32 s82, s82, s83
  s_lshl_b32 s82, s82, 10
  s_add_u32 s82, s82, 13631488
  s_cmp_lt_u32 s83, 7
  s_cselect_b32 s84, s82, 2130706432
  s_add_u32 s85, s84, 7168
  s_lshl_b32 s82, s54, 6
  s_lshl_b32 s83, s53, 1
  s_add_u32 s82, s82, s83
  s_mul_i32 s82, s82, 7
  s_lshl_b32 s83, s52, 1
  s_add_u32 s83, s83, 1
  s_add_u32 s82, s82, s83
  s_lshl_b32 s82, s82, 10
  s_add_u32 s82, s82, 13631488
  s_cmp_lt_u32 s83, 7
  s_cselect_b32 s86, s82, 2130706432
  s_add_u32 s87, s86, 7168
  s_lshl_b32 s82, s54, 7
  s_lshl_b32 s83, s53, 2
  s_add_u32 s66, s82, s83
  s_add_u32 s66, s66, 24576
  s_lshl_b32 s83, s52, 5
  s_add_u32 s62, s82, s83
  s_add_u32 s62, s62, 24576
  s_waitcnt vmcnt(0)
  v_xor_b32 v209, s55, v209
  v_xor_b32 v211, s55, v211
  v_xor_b32 v213, s55, v213
  v_xor_b32 v215, s55, v215
  v_or3_b32 v209, v209, v211, v213
  v_or_b32 v209, v209, v215
  v_cmp_ne_u32 vcc, 0, v209
  s_nop 3
  s_cmp_eq_u64 vcc, 0
  s_cbranch_scc1 L_st2ok_14
  s_mov_b32 s101, 0
L_st2_15:
  buffer_load_dwordx4 v[208:211], v204, s[48:51], s64 offen offset:0 sc1
  buffer_load_dwordx4 v[212:215], v204, s[48:51], s64 offen offset:1024 sc1
  s_waitcnt vmcnt(0)
  v_xor_b32 v209, s55, v209
  v_xor_b32 v211, s55, v211
  v_xor_b32 v213, s55, v213
  v_xor_b32 v215, s55, v215
  v_or3_b32 v209, v209, v211, v213
  v_or_b32 v209, v209, v215
  v_cmp_ne_u32 vcc, 0, v209
  s_nop 3
  s_cmp_eq_u64 vcc, 0
  s_cbranch_scc1 L_st2ok_16
  s_add_u32 s101, s101, 1
  s_cmp_lt_u32 s101, 131072
  s_cbranch_scc1 L_st2_15
  v_mov_b32 v5, 16
  v_mov_b32 v6, 0
  buffer_store_dword v5, v6, s[4:7], 0 offen
  s_nop 0
L_st2ok_16:
L_st2ok_14:
  v_add_f32 v208, v208, v212
  v_add_f32 v209, v210, v214
  v_mov_b32 v5, v208
  v_mov_b32 v6, v209
  s_nop 0
  v_permlane32_swap_b32 v208, v5
  v_permlane32_swap_b32 v209, v6
  v_add_f32 v208, v208, v5
  v_add_f32 v209, v209, v6
  v_mov_b32 v5, v208
  v_mov_b32 v6, v209
  s_nop 0
  v_permlane16_swap_b32 v208, v5
  v_permlane16_swap_b32 v209, v6
  v_add_f32 v208, v208, v5
  v_add_f32 v209, v209, v6
  v_mul_f32 v208, 0x3a924925, v208
  v_mul_f32 v209, 0x3a924925, v209
  v_fma_f32 v209, -v208, v208, v209
  v_max_f32 v209, 0, v209
  v_add_f32 v209, 0x3727c5ac, v209
  v_rsq_f32 v210, v209
  s_nop 0
  v_mul_f32_e64 v211, -v208, v210
  ds_write_b64 v10, v[210:211]
  s_waitcnt lgkmcnt(0)
  s_barrier
  ds_read_b64 v[196:197], v7 offset:0
  ds_read_b64 v[198:199], v7 offset:128
  ds_read_b64 v[200:201], v7 offset:256
  ds_read_b64 v[202:203], v7 offset:384
  s_waitcnt lgkmcnt(3)
  v_pk_fma_f32 v[16:17], v[16:17], v[196:197], v[196:197] op_sel:[0,0,1] op_sel_hi:[1,0,1]
  v_pk_fma_f32 v[18:19], v[18:19], v[196:197], v[196:197] op_sel:[0,0,1] op_sel_hi:[1,0,1]
  v_cvt_pk_bf16_f32 v208, v16, v17
  v_cvt_pk_bf16_f32 v209, v18, v19
  ds_write_b64 v8, v[208:209] offset:0
  v_pk_fma_f32 v[32:33], v[32:33], v[196:197], v[196:197] op_sel:[0,0,1] op_sel_hi:[1,0,1]
  v_pk_fma_f32 v[34:35], v[34:35], v[196:197], v[196:197] op_sel:[0,0,1] op_sel_hi:[1,0,1]
  v_cvt_pk_bf16_f32 v210, v32, v33
  v_cvt_pk_bf16_f32 v211, v34, v35
  ds_write_b64 v8, v[210:211] offset:2048
  s_waitcnt lgkmcnt(4)
  v_pk_fma_f32 v[20:21], v[20:21], v[198:199], v[198:199] op_sel:[0,0,1] op_sel_hi:[1,0,1]
  v_pk_fma_f32 v[22:23], v[22:23], v[198:199], v[198:199] op_sel:[0,0,1] op_sel_hi:[1,0,1]
  v_cvt_pk_bf16_f32 v212, v20, v21
  v_cvt_pk_bf16_f32 v213, v22, v23
  ds_write_b64 v8, v[212:213] offset:512
  v_pk_fma_f32 v[36:37], v[36:37], v[198:199], v[198:199] op_sel:[0,0,1] op_sel_hi:[1,0,1]
  v_pk_fma_f32 v[38:39], v[38:39], v[198:199], v[198:199] op_sel:[0,0,1] op_sel_hi:[1,0,1]
  v_cvt_pk_bf16_f32 v214, v36, v37
  v_cvt_pk_bf16_f32 v215, v38, v39
  ds_write_b64 v8, v[214:215] offset:2560
  s_waitcnt lgkmcnt(5)
  v_pk_fma_f32 v[24:25], v[24:25], v[200:201], v[200:201] op_sel:[0,0,1] op_sel_hi:[1,0,1]
  v_pk_fma_f32 v[26:27], v[26:27], v[200:201], v[200:201] op_sel:[0,0,1] op_sel_hi:[1,0,1]
  v_cvt_pk_bf16_f32 v208, v24, v25
  v_cvt_pk_bf16_f32 v209, v26, v27
  ds_write_b64 v8, v[208:209] offset:1024
  v_pk_fma_f32 v[40:41], v[40:41], v[200:201], v[200:201] op_sel:[0,0,1] op_sel_hi:[1,0,1]
  v_pk_fma_f32 v[42:43], v[42:43], v[200:201], v[200:201] op_sel:[0,0,1] op_sel_hi:[1,0,1]
  v_cvt_pk_bf16_f32 v210, v40, v41
  v_cvt_pk_bf16_f32 v211, v42, v43
  ds_write_b64 v8, v[210:211] offset:3072
  s_waitcnt lgkmcnt(6)
  v_pk_fma_f32 v[28:29], v[28:29], v[202:203], v[202:203] op_sel:[0,0,1] op_sel_hi:[1,0,1]
  v_pk_fma_f32 v[30:31], v[30:31], v[202:203], v[202:203] op_sel:[0,0,1] op_sel_hi:[1,0,1]
  v_cvt_pk_bf16_f32 v212, v28, v29
  v_cvt_pk_bf16_f32 v213, v30, v31
  ds_write_b64 v8, v[212:213] offset:1536
  v_pk_fma_f32 v[44:45], v[44:45], v[202:203], v[202:203] op_sel:[0,0,1] op_sel_hi:[1,0,1]
  v_pk_fma_f32 v[46:47], v[46:47], v[202:203], v[202:203] op_sel:[0,0,1] op_sel_hi:[1,0,1]
  v_cvt_pk_bf16_f32 v214, v44, v45
  v_cvt_pk_bf16_f32 v215, v46, v47
  ds_write_b64 v8, v[214:215] offset:3584
  s_waitcnt lgkmcnt(0)
  ds_read_b64_tr_b16 v[216:217], v9 offset:0
  ds_read_b64_tr_b16 v[218:219], v9 offset:512
  ds_read_b64_tr_b16 v[220:221], v9 offset:1024
  ds_read_b64_tr_b16 v[222:223], v9 offset:1536
  ds_read_b64_tr_b16 v[224:225], v9 offset:2048
  ds_read_b64_tr_b16 v[226:227], v9 offset:2560
  ds_read_b64_tr_b16 v[228:229], v9 offset:3072
  ds_read_b64_tr_b16 v[230:231], v9 offset:3584
  s_waitcnt lgkmcnt(6)
  buffer_store_dwordx4 v[216:219], v2, s[48:51], s84 offen sc1
  s_waitcnt lgkmcnt(4)
  buffer_store_dwordx4 v[220:223], v2, s[48:51], s85 offen sc1
  s_waitcnt lgkmcnt(2)
  buffer_store_dwordx4 v[224:227], v2, s[48:51], s86 offen sc1
  s_waitcnt lgkmcnt(0)
  buffer_store_dwordx4 v[228:231], v2, s[48:51], s87 offen sc1
  s_add_u32 m0, s73, 65536
  s_add_u32 s81, s72, 512
  buffer_load_dwordx4 v12, s[24:27], s81 offen lds
  s_add_u32 m0, s73, 66560
  s_add_u32 s81, s72, 66048
  buffer_load_dwordx4 v13, s[24:27], s81 offen lds
  s_add_u32 m0, s73, 67584
  s_add_u32 s81, s72, 16896
  buffer_load_dwordx4 v12, s[24:27], s81 offen lds
  s_add_u32 m0, s73, 68608
  s_add_u32 s81, s72, 82432
  buffer_load_dwordx4 v13, s[24:27], s81 offen lds
  s_add_u32 m0, s73, 69632
  s_add_u32 s81, s72, 131584
  buffer_load_dwordx4 v12, s[24:27], s81 offen lds
  s_add_u32 m0, s73, 70656
  s_add_u32 s81, s72, 197120
  buffer_load_dwordx4 v13, s[24:27], s81 offen lds
  s_add_u32 m0, s73, 71680
  s_add_u32 s81, s72, 147968
  buffer_load_dwordx4 v12, s[24:27], s81 offen lds
  s_add_u32 m0, s73, 72704
  s_add_u32 s81, s72, 213504
  buffer_load_dwordx4 v13, s[24:27], s81 offen lds
  s_waitcnt vmcnt(8)
  s_barrier
  s_cmp_eq_u32 s52, 0
  s_cbranch_scc0 L_pub_17
  v_mov_b32 v5, s55
  s_mov_b64 exec, 1
  buffer_store_dword v5, off, s[48:51], s66 sc1
  s_mov_b64 exec, -1
L_pub_17:
  v_pk_fma_f32 v[48:49], v[152:153], v[188:189], v[48:49] op_sel:[0,1,0] op_sel_hi:[1,1,1] neg_lo:[0,1,0] neg_hi:[0,1,0]
  v_pk_fma_f32 v[50:51], v[154:155], v[188:189], v[50:51] op_sel:[0,1,0] op_sel_hi:[1,1,1] neg_lo:[0,1,0] neg_hi:[0,1,0]
  v_pk_fma_f32 v[48:49], v[48:49], v[188:189], v[168:169] op_sel:[0,0,0] op_sel_hi:[1,0,1]
  v_pk_fma_f32 v[50:51], v[50:51], v[188:189], v[170:171] op_sel:[0,0,0] op_sel_hi:[1,0,1]
  v_pk_mul_f32 v[208:209], v[48:49], v[48:49]
  v_pk_mul_f32 v[210:211], v[50:51], v[50:51]
  v_pk_fma_f32 v[208:209], v[208:209], s[68:69], s[68:69] op_sel:[0,0,1] op_sel_hi:[1,0,1]
  v_pk_fma_f32 v[210:211], v[210:211], s[68:69], s[68:69] op_sel:[0,0,1] op_sel_hi:[1,0,1]
  v_pk_mul_f32 v[208:209], v[208:209], v[48:49]
  v_pk_mul_f32 v[210:211], v[210:211], v[50:51]
  v_exp_f32 v208, v208
  v_exp_f32 v209, v209
  v_exp_f32 v210, v210
  v_exp_f32 v211, v211
  s_add_u32 m0, s73, 98304
  s_add_u32 s81, s72, 640
  buffer_load_dwordx4 v12, s[24:27], s81 offen lds
  s_add_u32 m0, s73, 99328
  s_add_u32 s81, s72, 66176
  buffer_load_dwordx4 v13, s[24:27], s81 offen lds
  v_pk_add_f32 v[208:209], v[208:209], s[70:71]
  v_pk_add_f32 v[210:211], v[210:211], s[70:71]
  v_rcp_f32 v208, v208
  v_rcp_f32 v209, v209
  v_rcp_f32 v210, v210
  v_rcp_f32 v211, v211
  s_add_u32 m0, s73, 100352
  s_add_u32 s81, s72, 17024
  buffer_load_dwordx4 v12, s[24:27], s81 offen lds
  v_pk_mul_f32 v[48:49], v[48:49], v[208:209]
  v_pk_mul_f32 v[50:51], v[50:51], v[210:211]
  v_pk_fma_f32 v[52:53], v[152:153], v[190:191], v[52:53] op_sel:[0,1,0] op_sel_hi:[1,1,1] neg_lo:[0,1,0] neg_hi:[0,1,0]
  v_pk_fma_f32 v[54:55], v[154:155], v[190:191], v[54:55] op_sel:[0,1,0] op_sel_hi:[1,1,1] neg_lo:[0,1,0] neg_hi:[0,1,0]
  v_pk_fma_f32 v[52:53], v[52:53], v[190:191], v[168:169] op_sel:[0,0,0] op_sel_hi:[1,0,1]
  v_pk_fma_f32 v[54:55], v[54:55], v[190:191], v[170:171] op_sel:[0,0,0] op_sel_hi:[1,0,1]
  v_pk_mul_f32 v[212:213], v[52:53], v[52:53]
  v_pk_mul_f32 v[214:215], v[54:55], v[54:55]
  v_pk_fma_f32 v[212:213], v[212:213], s[68:69], s[68:69] op_sel:[0,0,1] op_sel_hi:[1,0,1]
  v_pk_fma_f32 v[214:215], v[214:215], s[68:69], s[68:69] op_sel:[0,0,1] op_sel_hi:[1,0,1]
  v_pk_mul_f32 v[212:213], v[212:213], v[52:53]
  v_pk_mul_f32 v[214:215], v[214:215], v[54:55]
  v_exp_f32 v212, v212
  v_exp_f32 v213, v213
  v_exp_f32 v214, v214
  v_exp_f32 v215, v215
  s_add_u32 m0, s73, 101376
  s_add_u32 s81, s72, 82560
  buffer_load_dwordx4 v13, s[24:27], s81 offen lds
  s_add_u32 m0, s73, 102400
  s_add_u32 s81, s72, 131712
  buffer_load_dwordx4 v12, s[24:27], s81 offen lds
  v_pk_add_f32 v[212:213], v[212:213], s[70:71]
  v_pk_add_f32 v[214:215], v[214:215], s[70:71]
  v_rcp_f32 v212, v212
  v_rcp_f32 v213, v213
  v_rcp_f32 v214, v214
  v_rcp_f32 v215, v215
  s_add_u32 m0, s73, 103424
  s_add_u32 s81, s72, 197248
  buffer_load_dwordx4 v13, s[24:27], s81 offen lds
  v_pk_mul_f32 v[52:53], v[52:53], v[212:213]
  v_pk_mul_f32 v[54:55], v[54:55], v[214:215]
  v_pk_fma_f32 v[56:57], v[152:153], v[192:193], v[56:57] op_sel:[0,1,0] op_sel_hi:[1,1,1] neg_lo:[0,1,0] neg_hi:[0,1,0]
  v_pk_fma_f32 v[58:59], v[154:155], v[192:193], v[58:59] op_sel:[0,1,0] op_sel_hi:[1,1,1] neg_lo:[0,1,0] neg_hi:[0,1,0]
  v_pk_fma_f32 v[56:57], v[56:57], v[192:193], v[168:169] op_sel:[0,0,0] op_sel_hi:[1,0,1]
  v_pk_fma_f32 v[58:59], v[58:59], v[192:193], v[170:171] op_sel:[0,0,0] op_sel_hi:[1,0,1]
  v_pk_mul_f32 v[208:209], v[56:57], v[56:57]
  v_pk_mul_f32 v[210:211], v[58:59], v[58:59]
  v_pk_fma_f32 v[208:209], v[208:209], s[68:69], s[68:69] op_sel:[0,0,1] op_sel_hi:[1,0,1]
  v_pk_fma_f32 v[210:211], v[210:211], s[68:69], s[68:69] op_sel:[0,0,1] op_sel_hi:[1,0,1]
  v_pk_mul_f32 v[208:209], v[208:209], v[56:57]
  v_pk_mul_f32 v[210:211], v[210:211], v[58:59]
  v_exp_f32 v208, v208
  v_exp_f32 v209, v209
  v_exp_f32 v210, v210
  v_exp_f32 v211, v211
  s_add_u32 m0, s73, 104448
  s_add_u32 s81, s72, 148096
  buffer_load_dwordx4 v12, s[24:27], s81 offen lds
  s_add_u32 m0, s73, 105472
  s_add_u32 s81, s72, 213632
  buffer_load_dwordx4 v13, s[24:27], s81 offen lds
  v_pk_add_f32 v[208:209], v[208:209], s[70:71]
  v_pk_add_f32 v[210:211], v[210:211], s[70:71]
  v_rcp_f32 v208, v208
  v_rcp_f32 v209, v209
  v_rcp_f32 v210, v210
  v_rcp_f32 v211, v211
  s_add_u32 m0, s73, 0
  s_add_u32 s81, s72, 768
  buffer_load_dwordx4 v12, s[24:27], s81 offen lds
  v_pk_mul_f32 v[56:57], v[56:57], v[208:209]
  v_pk_mul_f32 v[58:59], v[58:59], v[210:211]
  v_pk_fma_f32 v[60:61], v[152:153], v[194:195], v[60:61] op_sel:[0,1,0] op_sel_hi:[1,1,1] neg_lo:[0,1,0] neg_hi:[0,1,0]
  v_pk_fma_f32 v[62:63], v[154:155], v[194:195], v[62:63] op_sel:[0,1,0] op_sel_hi:[1,1,1] neg_lo:[0,1,0] neg_hi:[0,1,0]
  v_pk_fma_f32 v[60:61], v[60:61], v[194:195], v[168:169] op_sel:[0,0,0] op_sel_hi:[1,0,1]
  v_pk_fma_f32 v[62:63], v[62:63], v[194:195], v[170:171] op_sel:[0,0,0] op_sel_hi:[1,0,1]
  v_pk_mul_f32 v[212:213], v[60:61], v[60:61]
  v_pk_mul_f32 v[214:215], v[62:63], v[62:63]
  v_pk_fma_f32 v[212:213], v[212:213], s[68:69], s[68:69] op_sel:[0,0,1] op_sel_hi:[1,0,1]
  v_pk_fma_f32 v[214:215], v[214:215], s[68:69], s[68:69] op_sel:[0,0,1] op_sel_hi:[1,0,1]
  v_pk_mul_f32 v[212:213], v[212:213], v[60:61]
  v_pk_mul_f32 v[214:215], v[214:215], v[62:63]
  v_exp_f32 v212, v212
  v_exp_f32 v213, v213
  v_exp_f32 v214, v214
  v_exp_f32 v215, v215
  s_add_u32 m0, s73, 1024
  s_add_u32 s81, s72, 66304
  buffer_load_dwordx4 v13, s[24:27], s81 offen lds
  s_add_u32 m0, s73, 2048
  s_add_u32 s81, s72, 17152
  buffer_load_dwordx4 v12, s[24:27], s81 offen lds
  v_pk_add_f32 v[212:213], v[212:213], s[70:71]
  v_pk_add_f32 v[214:215], v[214:215], s[70:71]
  v_rcp_f32 v212, v212
  v_rcp_f32 v213, v213
  v_rcp_f32 v214, v214
  v_rcp_f32 v215, v215
  s_add_u32 m0, s73, 3072
  s_add_u32 s81, s72, 82688
  buffer_load_dwordx4 v13, s[24:27], s81 offen lds
  v_pk_mul_f32 v[60:61], v[60:61], v[212:213]
  v_pk_mul_f32 v[62:63], v[62:63], v[214:215]
  v_pk_fma_f32 v[64:65], v[156:157], v[188:189], v[64:65] op_sel:[0,1,0] op_sel_hi:[1,1,1] neg_lo:[0,1,0] neg_hi:[0,1,0]
  v_pk_fma_f32 v[66:67], v[158:159], v[188:189], v[66:67] op_sel:[0,1,0] op_sel_hi:[1,1,1] neg_lo:[0,1,0] neg_hi:[0,1,0]
  v_pk_fma_f32 v[64:65], v[64:65], v[188:189], v[172:173] op_sel:[0,0,0] op_sel_hi:[1,0,1]
  v_pk_fma_f32 v[66:67], v[66:67], v[188:189], v[174:175] op_sel:[0,0,0] op_sel_hi:[1,0,1]
  v_pk_mul_f32 v[208:209], v[64:65], v[64:65]
  v_pk_mul_f32 v[210:211], v[66:67], v[66:67]
  v_pk_fma_f32 v[208:209], v[208:209], s[68:69], s[68:69] op_sel:[0,0,1] op_sel_hi:[1,0,1]
  v_pk_fma_f32 v[210:211], v[210:211], s[68:69], s[68:69] op_sel:[0,0,1] op_sel_hi:[1,0,1]
  v_pk_mul_f32 v[208:209], v[208:209], v[64:65]
  v_pk_mul_f32 v[210:211], v[210:211], v[66:67]
  v_exp_f32 v208, v208
  v_exp_f32 v209, v209
  v_exp_f32 v210, v210
  v_exp_f32 v211, v211
  s_add_u32 m0, s73, 4096
  s_add_u32 s81, s72, 131840
  buffer_load_dwordx4 v12, s[24:27], s81 offen lds
  s_add_u32 m0, s73, 5120
  s_add_u32 s81, s72, 197376
  buffer_load_dwordx4 v13, s[24:27], s81 offen lds
  v_pk_add_f32 v[208:209], v[208:209], s[70:71]
  v_pk_add_f32 v[210:211], v[210:211], s[70:71]
  v_rcp_f32 v208, v208
  v_rcp_f32 v209, v209
  v_rcp_f32 v210, v210
  v_rcp_f32 v211, v211
  s_add_u32 m0, s73, 6144
  s_add_u32 s81, s72, 148224
  buffer_load_dwordx4 v12, s[24:27], s81 offen lds
  v_pk_mul_f32 v[64:65], v[64:65], v[208:209]
  v_pk_mul_f32 v[66:67], v[66:67], v[210:211]
  v_pk_fma_f32 v[68:69], v[156:157], v[190:191], v[68:69] op_sel:[0,1,0] op_sel_hi:[1,1,1] neg_lo:[0,1,0] neg_hi:[0,1,0]
  v_pk_fma_f32 v[70:71], v[158:159], v[190:191], v[70:71] op_sel:[0,1,0] op_sel_hi:[1,1,1] neg_lo:[0,1,0] neg_hi:[0,1,0]
  v_pk_fma_f32 v[68:69], v[68:69], v[190:191], v[172:173] op_sel:[0,0,0] op_sel_hi:[1,0,1]
  v_pk_fma_f32 v[70:71], v[70:71], v[190:191], v[174:175] op_sel:[0,0,0] op_sel_hi:[1,0,1]
  v_pk_mul_f32 v[212:213], v[68:69], v[68:69]
  v_pk_mul_f32 v[214:215], v[70:71], v[70:71]
  v_pk_fma_f32 v[212:213], v[212:213], s[68:69], s[68:69] op_sel:[0,0,1] op_sel_hi:[1,0,1]
  v_pk_fma_f32 v[214:215], v[214:215], s[68:69], s[68:69] op_sel:[0,0,1] op_sel_hi:[1,0,1]
  v_pk_mul_f32 v[212:213], v[212:213], v[68:69]
  v_pk_mul_f32 v[214:215], v[214:215], v[70:71]
  v_exp_f32 v212, v212
  v_exp_f32 v213, v213
  v_exp_f32 v214, v214
  v_exp_f32 v215, v215
  s_add_u32 m0, s73, 7168
  s_add_u32 s81, s72, 213760
  buffer_load_dwordx4 v13, s[24:27], s81 offen lds
  s_add_u32 m0, s73, 32768
  s_add_u32 s81, s72, 896
  buffer_load_dwordx4 v12, s[24:27], s81 offen lds
  v_pk_add_f32 v[212:213], v[212:213], s[70:71]
  v_pk_add_f32 v[214:215], v[214:215], s[70:71]
  v_rcp_f32 v212, v212
  v_rcp_f32 v213, v213
  v_rcp_f32 v214, v214
  v_rcp_f32 v215, v215
  s_add_u32 m0, s73, 33792
  s_add_u32 s81, s72, 66432
  buffer_load_dwordx4 v13, s[24:27], s81 offen lds
  v_pk_mul_f32 v[68:69], v[68:69], v[212:213]
  v_pk_mul_f32 v[70:71], v[70:71], v[214:215]
  v_pk_fma_f32 v[72:73], v[156:157], v[192:193], v[72:73] op_sel:[0,1,0] op_sel_hi:[1,1,1] neg_lo:[0,1,0] neg_hi:[0,1,0]
  v_pk_fma_f32 v[74:75], v[158:159], v[192:193], v[74:75] op_sel:[0,1,0] op_sel_hi:[1,1,1] neg_lo:[0,1,0] neg_hi:[0,1,0]
  v_pk_fma_f32 v[72:73], v[72:73], v[192:193], v[172:173] op_sel:[0,0,0] op_sel_hi:[1,0,1]
  v_pk_fma_f32 v[74:75], v[74:75], v[192:193], v[174:175] op_sel:[0,0,0] op_sel_hi:[1,0,1]
  v_pk_mul_f32 v[208:209], v[72:73], v[72:73]
  v_pk_mul_f32 v[210:211], v[74:75], v[74:75]
  v_pk_fma_f32 v[208:209], v[208:209], s[68:69], s[68:69] op_sel:[0,0,1] op_sel_hi:[1,0,1]
  v_pk_fma_f32 v[210:211], v[210:211], s[68:69], s[68:69] op_sel:[0,0,1] op_sel_hi:[1,0,1]
  v_pk_mul_f32 v[208:209], v[208:209], v[72:73]
  v_pk_mul_f32 v[210:211], v[210:211], v[74:75]
  v_exp_f32 v208, v208
  v_exp_f32 v209, v209
  v_exp_f32 v210, v210
  v_exp_f32 v211, v211
  s_add_u32 m0, s73, 34816
  s_add_u32 s81, s72, 17280
  buffer_load_dwordx4 v12, s[24:27], s81 offen lds
  s_add_u32 m0, s73, 35840
  s_add_u32 s81, s72, 82816
  buffer_load_dwordx4 v13, s[24:27], s81 offen lds
  v_pk_add_f32 v[208:209], v[208:209], s[70:71]
  v_pk_add_f32 v[210:211], v[210:211], s[70:71]
  v_rcp_f32 v208, v208
  v_rcp_f32 v209, v209
  v_rcp_f32 v210, v210
  v_rcp_f32 v211, v211
  s_add_u32 m0, s73, 36864
  s_add_u32 s81, s72, 131968
  buffer_load_dwordx4 v12, s[24:27], s81 offen lds
  v_pk_mul_f32 v[72:73], v[72:73], v[208:209]
  v_pk_mul_f32 v[74:75], v[74:75], v[210:211]
  v_pk_fma_f32 v[76:77], v[156:157], v[194:195], v[76:77] op_sel:[0,1,0] op_sel_hi:[1,1,1] neg_lo:[0,1,0] neg_hi:[0,1,0]
  v_pk_fma_f32 v[78:79], v[158:159], v[194:195], v[78:79] op_sel:[0,1,0] op_sel_hi:[1,1,1] neg_lo:[0,1,0] neg_hi:[0,1,0]
  v_pk_fma_f32 v[76:77], v[76:77], v[194:195], v[172:173] op_sel:[0,0,0] op_sel_hi:[1,0,1]
  v_pk_fma_f32 v[78:79], v[78:79], v[194:195], v[174:175] op_sel:[0,0,0] op_sel_hi:[1,0,1]
  v_pk_mul_f32 v[212:213], v[76:77], v[76:77]
  v_pk_mul_f32 v[214:215], v[78:79], v[78:79]
  v_pk_fma_f32 v[212:213], v[212:213], s[68:69], s[68:69] op_sel:[0,0,1] op_sel_hi:[1,0,1]
  v_pk_fma_f32 v[214:215], v[214:215], s[68:69], s[68:69] op_sel:[0,0,1] op_sel_hi:[1,0,1]
  v_pk_mul_f32 v[212:213], v[212:213], v[76:77]
  v_pk_mul_f32 v[214:215], v[214:215], v[78:79]
  v_exp_f32 v212, v212
  v_exp_f32 v213, v213
  v_exp_f32 v214, v214
  v_exp_f32 v215, v215
  s_add_u32 m0, s73, 37888
  s_add_u32 s81, s72, 197504
  buffer_load_dwordx4 v13, s[24:27], s81 offen lds
  s_add_u32 m0, s73, 38912
  s_add_u32 s81, s72, 148352
  buffer_load_dwordx4 v12, s[24:27], s81 offen lds
  v_pk_add_f32 v[212:213], v[212:213], s[70:71]
  v_pk_add_f32 v[214:215], v[214:215], s[70:71]
  v_rcp_f32 v212, v212
  v_rcp_f32 v213, v213
  v_rcp_f32 v214, v214
  v_rcp_f32 v215, v215
  s_add_u32 m0, s73, 39936
  s_add_u32 s81, s72, 213888
  buffer_load_dwordx4 v13, s[24:27], s81 offen lds
  v_pk_mul_f32 v[76:77], v[76:77], v[212:213]
  v_pk_mul_f32 v[78:79], v[78:79], v[214:215]
  v_cvt_pk_bf16_f32 v232, v48, v49
  v_cvt_pk_bf16_f32 v233, v50, v51
  v_cvt_pk_bf16_f32 v234, v52, v53
  v_cvt_pk_bf16_f32 v235, v54, v55
  v_cvt_pk_bf16_f32 v236, v56, v57
  v_cvt_pk_bf16_f32 v237, v58, v59
  v_cvt_pk_bf16_f32 v238, v60, v61
  v_cvt_pk_bf16_f32 v239, v62, v63
  v_cvt_pk_bf16_f32 v240, v64, v65
  v_cvt_pk_bf16_f32 v241, v66, v67
  v_cvt_pk_bf16_f32 v242, v68, v69
  v_cvt_pk_bf16_f32 v243, v70, v71
  v_cvt_pk_bf16_f32 v244, v72, v73
  v_cvt_pk_bf16_f32 v245, v74, v75
  v_cvt_pk_bf16_f32 v246, v76, v77
  v_cvt_pk_bf16_f32 v247, v78, v79
  s_lshl_b32 s82, s52, 12
  s_add_u32 s82, s82, 135168
  v_add_u32 v7, s82, v2
  ds_write_b128 v7, v[232:235] offset:0
  ds_write_b128 v7, v[236:239] offset:1024
  ds_write_b128 v7, v[240:243] offset:2048
  ds_write_b128 v7, v[244:247] offset:3072
  s_waitcnt lgkmcnt(0)
  v_lshrrev_b32 v6, 2, v3
  v_lshlrev_b32 v6, 3, v6
  v_and_b32 v7, 3, v3
  v_add_u32 v6, v6, v7
  v_lshlrev_b32 v6, 1, v6
  s_lshl_b32 s82, s53, 7
  buffer_load_ushort v240, v6, s[28:31], s82 offen offset:0
  buffer_load_ushort v241, v6, s[28:31], s82 offen offset:8
  buffer_load_ushort v242, v6, s[28:31], s82 offen offset:64
  buffer_load_ushort v243, v6, s[28:31], s82 offen offset:72
  s_lshl_b32 s82, s54, 6
  s_lshl_b32 s83, s52, 4
  s_add_u32 s82, s82, s83
  s_mul_i32 s74, s82, 7168
  s_add_u32 s74, s74, 13631488
  v_and_b32 v5, 7, v1
  v_lshlrev_b32 v11, 2, v5
  s_mov_b32 s101, 0
  s_nop 0
L_f5_18:
  buffer_load_dword v10, v11, s[48:51], s62 offen sc1
  s_waitcnt vmcnt(0)
  v_cmp_eq_u32 vcc, s55, v10
  s_nop 3
  s_mov_b32 s82, vcc_lo
  s_and_b32 s82, s82, 0xff
  s_cmp_eq_u32 s82, 0xff
  s_cbranch_scc1 L_f5ok_19
  s_add_u32 s101, s101, 1
  s_cmp_lt_u32 s101, 131072
  s_cbranch_scc1 L_f5_18
  v_mov_b32 v5, 19
  v_mov_b32 v6, 0
  buffer_store_dword v5, v6, s[4:7], 0 offen
  s_nop 0
L_f5ok_19:
  v_add_u32 v10, 65536, v14
  v_add_u32 v11, 65536, v15
  s_add_u32 s82, s74, 0
  buffer_load_dwordx4 v[128:131], v2, s[48:51], s82 offen offset:0 sc1
  buffer_load_dwordx4 v[132:135], v2, s[48:51], s82 offen offset:1024 sc1
  buffer_load_dwordx4 v[136:139], v2, s[48:51], s82 offen offset:2048 sc1
  buffer_load_dwordx4 v[140:143], v2, s[48:51], s82 offen offset:3072 sc1
  s_add_u32 s82, s74, 4096
  buffer_load_dwordx4 v[144:147], v2, s[48:51], s82 offen offset:0 sc1
  buffer_load_dwordx4 v[148:151], v2, s[48:51], s82 offen offset:1024 sc1
  buffer_load_dwordx4 v[152:155], v2, s[48:51], s82 offen offset:2048 sc1
  s_add_u32 s82, s74, 7168
  buffer_load_dwordx4 v[156:159], v2, s[48:51], s82 offen offset:0 sc1
  buffer_load_dwordx4 v[160:163], v2, s[48:51], s82 offen offset:1024 sc1
  buffer_load_dwordx4 v[164:167], v2, s[48:51], s82 offen offset:2048 sc1
  buffer_load_dwordx4 v[168:171], v2, s[48:51], s82 offen offset:3072 sc1
  s_add_u32 s82, s74, 11264
  buffer_load_dwordx4 v[172:175], v2, s[48:51], s82 offen offset:0 sc1
  buffer_load_dwordx4 v[176:179], v2, s[48:51], s82 offen offset:1024 sc1
  buffer_load_dwordx4 v[180:183], v2, s[48:51], s82 offen offset:2048 sc1
  s_add_u32 s82, s74, 14336
  buffer_load_dwordx4 v[184:187], v2, s[48:51], s82 offen offset:0 sc1
  buffer_load_dwordx4 v[188:191], v2, s[48:51], s82 offen offset:1024 sc1
  buffer_load_dwordx4 v[192:195], v2, s[48:51], s82 offen offset:2048 sc1
  buffer_load_dwordx4 v[196:199], v2, s[48:51], s82 offen offset:3072 sc1
  s_add_u32 s82, s74, 18432
  buffer_load_dwordx4 v[200:203], v2, s[48:51], s82 offen offset:0 sc1
  buffer_load_dwordx4 v[204:207], v2, s[48:51], s82 offen offset:1024 sc1
  buffer_load_dwordx4 v[208:211], v2, s[48:51], s82 offen offset:2048 sc1
  s_waitcnt vmcnt(14)
  v_mfma_f32_16x16x32_bf16 v[16:19], v[128:131], a[128:131], 0
  s_add_u32 s82, s74, 21504
  buffer_load_dwordx4 v[212:215], v2, s[48:51], s82 offen offset:0 sc1
  v_mfma_f32_16x16x32_bf16 v[20:23], v[128:131], a[132:135], 0
  v_mfma_f32_16x16x32_bf16 v[24:27], v[128:131], a[136:139], 0
  v_mfma_f32_16x16x32_bf16 v[28:31], v[128:131], a[140:143], 0
  v_mfma_f32_16x16x32_bf16 v[32:35], v[132:135], a[128:131], 0
  buffer_load_dwordx4 v[216:219], v2, s[48:51], s82 offen offset:1024 sc1
  v_mfma_f32_16x16x32_bf16 v[36:39], v[132:135], a[132:135], 0
  v_mfma_f32_16x16x32_bf16 v[40:43], v[132:135], a[136:139], 0
  v_mfma_f32_16x16x32_bf16 v[44:47], v[132:135], a[140:143], 0
  v_mfma_f32_16x16x32_bf16 v[48:51], v[136:139], a[128:131], 0
  buffer_load_dwordx4 v[220:223], v2, s[48:51], s82 offen offset:2048 sc1
  v_mfma_f32_16x16x32_bf16 v[52:55], v[136:139], a[132:135], 0
  v_mfma_f32_16x16x32_bf16 v[56:59], v[136:139], a[136:139], 0
  v_mfma_f32_16x16x32_bf16 v[60:63], v[136:139], a[140:143], 0
  v_mfma_f32_16x16x32_bf16 v[64:67], v[140:143], a[128:131], 0
  buffer_load_dwordx4 v[224:227], v2, s[48:51], s82 offen offset:3072 sc1
  v_mfma_f32_16x16x32_bf16 v[68:71], v[140:143], a[132:135], 0
  v_mfma_f32_16x16x32_bf16 v[72:75], v[140:143], a[136:139], 0
  v_mfma_f32_16x16x32_bf16 v[76:79], v[140:143], a[140:143], 0
  v_mfma_f32_16x16x32_bf16 v[80:83], v[144:147], a[128:131], 0
  s_add_u32 s82, s74, 25600
  buffer_load_dwordx4 v[228:231], v2, s[48:51], s82 offen offset:0 sc1
  v_mfma_f32_16x16x32_bf16 v[84:87], v[144:147], a[132:135], 0
  v_mfma_f32_16x16x32_bf16 v[88:91], v[144:147], a[136:139], 0
  v_mfma_f32_16x16x32_bf16 v[92:95], v[144:147], a[140:143], 0
  v_mfma_f32_16x16x32_bf16 v[96:99], v[148:151], a[128:131], 0
  buffer_load_dwordx4 v[232:235], v2, s[48:51], s82 offen offset:1024 sc1
  v_mfma_f32_16x16x32_bf16 v[100:103], v[148:151], a[132:135], 0
  v_mfma_f32_16x16x32_bf16 v[104:107], v[148:151], a[136:139], 0
  v_mfma_f32_16x16x32_bf16 v[108:111], v[148:151], a[140:143], 0
  v_mfma_f32_16x16x32_bf16 v[112:115], v[152:155], a[128:131], 0
  buffer_load_dwordx4 v[236:239], v2, s[48:51], s82 offen offset:2048 sc1
  v_mfma_f32_16x16x32_bf16 v[116:119], v[152:155], a[132:135], 0
  v_mfma_f32_16x16x32_bf16 v[120:123], v[152:155], a[136:139], 0
  v_mfma_f32_16x16x32_bf16 v[124:127], v[152:155], a[140:143], 0
  s_waitcnt vmcnt(14)
  v_mfma_f32_16x16x32_bf16 v[16:19], v[156:159], a[144:147], v[16:19]
  s_add_u32 s82, s74, 28672
  buffer_load_dwordx4 v[128:131], v2, s[48:51], s82 offen offset:0 sc1
  v_mfma_f32_16x16x32_bf16 v[20:23], v[156:159], a[148:151], v[20:23]
  v_mfma_f32_16x16x32_bf16 v[24:27], v[156:159], a[152:155], v[24:27]
  v_mfma_f32_16x16x32_bf16 v[28:31], v[156:159], a[156:159], v[28:31]
  v_mfma_f32_16x16x32_bf16 v[32:35], v[160:163], a[144:147], v[32:35]
  buffer_load_dwordx4 v[132:135], v2, s[48:51], s82 offen offset:1024 sc1
  v_mfma_f32_16x16x32_bf16 v[36:39], v[160:163], a[148:151], v[36:39]
  v_mfma_f32_16x16x32_bf16 v[40:43], v[160:163], a[152:155], v[40:43]
  v_mfma_f32_16x16x32_bf16 v[44:47], v[160:163], a[156:159], v[44:47]
  v_mfma_f32_16x16x32_bf16 v[48:51], v[164:167], a[144:147], v[48:51]
  buffer_load_dwordx4 v[136:139], v2, s[48:51], s82 offen offset:2048 sc1
  v_mfma_f32_16x16x32_bf16 v[52:55], v[164:167], a[148:151], v[52:55]
  v_mfma_f32_16x16x32_bf16 v[56:59], v[164:167], a[152:155], v[56:59]
  v_mfma_f32_16x16x32_bf16 v[60:63], v[164:167], a[156:159], v[60:63]
  v_mfma_f32_16x16x32_bf16 v[64:67], v[168:171], a[144:147], v[64:67]
  buffer_load_dwordx4 v[140:143], v2, s[48:51], s82 offen offset:3072 sc1
  v_mfma_f32_16x16x32_bf16 v[68:71], v[168:171], a[148:151], v[68:71]
  v_mfma_f32_16x16x32_bf16 v[72:75], v[168:171], a[152:155], v[72:75]
  v_mfma_f32_16x16x32_bf16 v[76:79], v[168:171], a[156:159], v[76:79]
  v_mfma_f32_16x16x32_bf16 v[80:83], v[172:175], a[144:147], v[80:83]
  s_add_u32 s82, s74, 32768
  buffer_load_dwordx4 v[144:147], v2, s[48:51], s82 offen offset:0 sc1
  v_mfma_f32_16x16x32_bf16 v[84:87], v[172:175], a[148:151], v[84:87]
  v_mfma_f32_16x16x32_bf16 v[88:91], v[172:175], a[152:155], v[88:91]
  v_mfma_f32_16x16x32_bf16 v[92:95], v[172:175], a[156:159], v[92:95]
  v_mfma_f32_16x16x32_bf16 v[96:99], v[176:179], a[144:147], v[96:99]
  buffer_load_dwordx4 v[148:151], v2, s[48:51], s82 offen offset:1024 sc1
  v_mfma_f32_16x16x32_bf16 v[100:103], v[176:179], a[148:151], v[100:103]
  v_mfma_f32_16x16x32_bf16 v[104:107], v[176:179], a[152:155], v[104:107]
  v_mfma_f32_16x16x32_bf16 v[108:111], v[176:179], a[156:159], v[108:111]
  v_mfma_f32_16x16x32_bf16 v[112:115], v[180:183], a[144:147], v[112:115]
  buffer_load_dwordx4 v[152:155], v2, s[48:51], s82 offen offset:2048 sc1
  v_mfma_f32_16x16x32_bf16 v[116:119], v[180:183], a[148:151], v[116:119]
  v_mfma_f32_16x16x32_bf16 v[120:123], v[180:183], a[152:155], v[120:123]
  v_mfma_f32_16x16x32_bf16 v[124:127], v[180:183], a[156:159], v[124:127]
  s_waitcnt vmcnt(14)
  v_mfma_f32_16x16x32_bf16 v[16:19], v[184:187], a[160:163], v[16:19]
  s_add_u32 s82, s74, 35840
  buffer_load_dwordx4 v[156:159], v2, s[48:51], s82 offen offset:0 sc1
  v_mfma_f32_16x16x32_bf16 v[20:23], v[184:187], a[164:167], v[20:23]
  ds_read_b128 a[0:3], v10 offset:0
  v_mfma_f32_16x16x32_bf16 v[24:27], v[184:187], a[168:171], v[24:27]
  v_mfma_f32_16x16x32_bf16 v[28:31], v[184:187], a[172:175], v[28:31]
  ds_read_b128 a[4:7], v10 offset:2048
  v_mfma_f32_16x16x32_bf16 v[32:35], v[188:191], a[160:163], v[32:35]
  buffer_load_dwordx4 v[160:163], v2, s[48:51], s82 offen offset:1024 sc1
  v_mfma_f32_16x16x32_bf16 v[36:39], v[188:191], a[164:167], v[36:39]
  ds_read_b128 a[8:11], v10 offset:4096
  v_mfma_f32_16x16x32_bf16 v[40:43], v[188:191], a[168:171], v[40:43]
  v_mfma_f32_16x16x32_bf16 v[44:47], v[188:191], a[172:175], v[44:47]
  ds_read_b128 a[12:15], v10 offset:6144
  v_mfma_f32_16x16x32_bf16 v[48:51], v[192:195], a[160:163], v[48:51]
  buffer_load_dwordx4 v[164:167], v2, s[48:51], s82 offen offset:2048 sc1
  v_mfma_f32_16x16x32_bf16 v[52:55], v[192:195], a[164:167], v[52:55]
  ds_read_b128 a[16:19], v11 offset:0
  v_mfma_f32_16x16x32_bf16 v[56:59], v[192:195], a[168:171], v[56:59]
  v_mfma_f32_16x16x32_bf16 v[60:63], v[192:195], a[172:175], v[60:63]
  ds_read_b128 a[20:23], v11 offset:2048
  v_mfma_f32_16x16x32_bf16 v[64:67], v[196:199], a[160:163], v[64:67]
  buffer_load_dwordx4 v[168:171], v2, s[48:51], s82 offen offset:3072 sc1
  v_mfma_f32_16x16x32_bf16 v[68:71], v[196:199], a[164:167], v[68:71]
  ds_read_b128 a[24:27], v11 offset:4096
  v_mfma_f32_16x16x32_bf16 v[72:75], v[196:199], a[168:171], v[72:75]
  v_mfma_f32_16x16x32_bf16 v[76:79], v[196:199], a[172:175], v[76:79]
  ds_read_b128 a[28:31], v11 offset:6144
  v_mfma_f32_16x16x32_bf16 v[80:83], v[200:203], a[160:163], v[80:83]
  s_add_u32 s82, s74, 39936
  buffer_load_dwordx4 v[172:175], v2, s[48:51], s82 offen offset:0 sc1
  v_mfma_f32_16x16x32_bf16 v[84:87], v[200:203], a[164:167], v[84:87]
  ds_read_b128 a[32:35], v10 offset:32768
  v_mfma_f32_16x16x32_bf16 v[88:91], v[200:203], a[168:171], v[88:91]
  v_mfma_f32_16x16x32_bf16 v[92:95], v[200:203], a[172:175], v[92:95]
  ds_read_b128 a[36:39], v10 offset:34816
  v_mfma_f32_16x16x32_bf16 v[96:99], v[204:207], a[160:163], v[96:99]
  buffer_load_dwordx4 v[176:179], v2, s[48:51], s82 offen offset:1024 sc1
  v_mfma_f32_16x16x32_bf16 v[100:103], v[204:207], a[164:167], v[100:103]
  ds_read_b128 a[40:43], v10 offset:36864
  v_mfma_f32_16x16x32_bf16 v[104:107], v[204:207], a[168:171], v[104:107]
  v_mfma_f32_16x16x32_bf16 v[108:111], v[204:207], a[172:175], v[108:111]
  ds_read_b128 a[44:47], v10 offset:38912
  v_mfma_f32_16x16x32_bf16 v[112:115], v[208:211], a[160:163], v[112:115]
  buffer_load_dwordx4 v[180:183], v2, s[48:51], s82 offen offset:2048 sc1
  v_mfma_f32_16x16x32_bf16 v[116:119], v[208:211], a[164:167], v[116:119]
  ds_read_b128 a[48:51], v11 offset:32768
  v_mfma_f32_16x16x32_bf16 v[120:123], v[208:211], a[168:171], v[120:123]
  v_mfma_f32_16x16x32_bf16 v[124:127], v[208:211], a[172:175], v[124:127]
  ds_read_b128 a[52:55], v11 offset:34816
  s_waitcnt vmcnt(14)
  v_mfma_f32_16x16x32_bf16 v[16:19], v[212:215], a[176:179], v[16:19]
  s_add_u32 s82, s74, 43008
  buffer_load_dwordx4 v[184:187], v2, s[48:51], s82 offen offset:0 sc1
  v_mfma_f32_16x16x32_bf16 v[20:23], v[212:215], a[180:183], v[20:23]
  ds_read_b128 a[56:59], v11 offset:36864
  v_mfma_f32_16x16x32_bf16 v[24:27], v[212:215], a[184:187], v[24:27]
  v_mfma_f32_16x16x32_bf16 v[28:31], v[212:215], a[188:191], v[28:31]
  ds_read_b128 a[60:63], v11 offset:38912
  v_mfma_f32_16x16x32_bf16 v[32:35], v[216:219], a[176:179], v[32:35]
  buffer_load_dwordx4 v[188:191], v2, s[48:51], s82 offen offset:1024 sc1
  v_mfma_f32_16x16x32_bf16 v[36:39], v[216:219], a[180:183], v[36:39]
  v_mfma_f32_16x16x32_bf16 v[40:43], v[216:219], a[184:187], v[40:43]
  v_mfma_f32_16x16x32_bf16 v[44:47], v[216:219], a[188:191], v[44:47]
  v_mfma_f32_16x16x32_bf16 v[48:51], v[220:223], a[176:179], v[48:51]
  buffer_load_dwordx4 v[192:195], v2, s[48:51], s82 offen offset:2048 sc1
  v_mfma_f32_16x16x32_bf16 v[52:55], v[220:223], a[180:183], v[52:55]
  v_mfma_f32_16x16x32_bf16 v[56:59], v[220:223], a[184:187], v[56:59]
  v_mfma_f32_16x16x32_bf16 v[60:63], v[220:223], a[188:191], v[60:63]
  v_mfma_f32_16x16x32_bf16 v[64:67], v[224:227], a[176:179], v[64:67]
  buffer_load_dwordx4 v[196:199], v2, s[48:51], s82 offen offset:3072 sc1
  v_mfma_f32_16x16x32_bf16 v[68:71], v[224:227], a[180:183], v[68:71]
  v_mfma_f32_16x16x32_bf16 v[72:75], v[224:227], a[184:187], v[72:75]
  v_mfma_f32_16x16x32_bf16 v[76:79], v[224:227], a[188:191], v[76:79]
  v_mfma_f32_16x16x32_bf16 v[80:83], v[228:231], a[176:179], v[80:83]
  s_add_u32 s82, s74, 47104
  buffer_load_dwordx4 v[200:203], v2, s[48:51], s82 offen offset:0 sc1
  v_mfma_f32_16x16x32_bf16 v[84:87], v[228:231], a[180:183], v[84:87]
  v_mfma_f32_16x16x32_bf16 v[88:91], v[228:231], a[184:187], v[88:91]
  v_mfma_f32_16x16x32_bf16 v[92:95], v[228:231], a[188:191], v[92:95]
  v_mfma_f32_16x16x32_bf16 v[96:99], v[232:235], a[176:179], v[96:99]
  buffer_load_dwordx4 v[204:207], v2, s[48:51], s82 offen offset:1024 sc1
  v_mfma_f32_16x16x32_bf16 v[100:103], v[232:235], a[180:183], v[100:103]
  v_mfma_f32_16x16x32_bf16 v[104:107], v[232:235], a[184:187], v[104:107]
  v_mfma_f32_16x16x32_bf16 v[108:111], v[232:235], a[188:191], v[108:111]
  v_mfma_f32_16x16x32_bf16 v[112:115], v[236:239], a[176:179], v[112:115]
  buffer_load_dwordx4 v[208:211], v2, s[48:51], s82 offen offset:2048 sc1
  v_mfma_f32_16x16x32_bf16 v[116:119], v[236:239], a[180:183], v[116:119]
  v_mfma_f32_16x16x32_bf16 v[120:123], v[236:239], a[184:187], v[120:123]
  v_mfma_f32_16x16x32_bf16 v[124:127], v[236:239], a[188:191], v[124:127]
  s_waitcnt vmcnt(14)
  v_mfma_f32_16x16x32_bf16 v[16:19], v[128:131], a[192:195], v[16:19]
  s_add_u32 s82, s74, 50176
  buffer_load_dwordx4 v[212:215], v2, s[48:51], s82 offen offset:0 sc1
  v_mfma_f32_16x16x32_bf16 v[20:23], v[128:131], a[196:199], v[20:23]
  v_mfma_f32_16x16x32_bf16 v[24:27], v[128:131], a[200:203], v[24:27]
  v_mfma_f32_16x16x32_bf16 v[28:31], v[128:131], a[204:207], v[28:31]
  v_mfma_f32_16x16x32_bf16 v[32:35], v[132:135], a[192:195], v[32:35]
  buffer_load_dwordx4 v[216:219], v2, s[48:51], s82 offen offset:1024 sc1
  v_mfma_f32_16x16x32_bf16 v[36:39], v[132:135], a[196:199], v[36:39]
  v_mfma_f32_16x16x32_bf16 v[40:43], v[132:135], a[200:203], v[40:43]
  v_mfma_f32_16x16x32_bf16 v[44:47], v[132:135], a[204:207], v[44:47]
  v_mfma_f32_16x16x32_bf16 v[48:51], v[136:139], a[192:195], v[48:51]
  buffer_load_dwordx4 v[220:223], v2, s[48:51], s82 offen offset:2048 sc1
  v_mfma_f32_16x16x32_bf16 v[52:55], v[136:139], a[196:199], v[52:55]
  v_mfma_f32_16x16x32_bf16 v[56:59], v[136:139], a[200:203], v[56:59]
  v_mfma_f32_16x16x32_bf16 v[60:63], v[136:139], a[204:207], v[60:63]
  v_mfma_f32_16x16x32_bf16 v[64:67], v[140:143], a[192:195], v[64:67]
  buffer_load_dwordx4 v[224:227], v2, s[48:51], s82 offen offset:3072 sc1
  v_mfma_f32_16x16x32_bf16 v[68:71], v[140:143], a[196:199], v[68:71]
  v_mfma_f32_16x16x32_bf16 v[72:75], v[140:143], a[200:203], v[72:75]
  v_mfma_f32_16x16x32_bf16 v[76:79], v[140:143], a[204:207], v[76:79]
  v_mfma_f32_16x16x32_bf16 v[80:83], v[144:147], a[192:195], v[80:83]
  s_add_u32 s82, s74, 54272
  buffer_load_dwordx4 v[228:231], v2, s[48:51], s82 offen offset:0 sc1
  v_mfma_f32_16x16x32_bf16 v[84:87], v[144:147], a[196:199], v[84:87]
  v_mfma_f32_16x16x32_bf16 v[88:91], v[144:147], a[200:203], v[88:91]
  v_mfma_f32_16x16x32_bf16 v[92:95], v[144:147], a[204:207], v[92:95]
  v_mfma_f32_16x16x32_bf16 v[96:99], v[148:151], a[192:195], v[96:99]
  buffer_load_dwordx4 v[232:235], v2, s[48:51], s82 offen offset:1024 sc1
  v_mfma_f32_16x16x32_bf16 v[100:103], v[148:151], a[196:199], v[100:103]
  v_mfma_f32_16x16x32_bf16 v[104:107], v[148:151], a[200:203], v[104:107]
  v_mfma_f32_16x16x32_bf16 v[108:111], v[148:151], a[204:207], v[108:111]
  v_mfma_f32_16x16x32_bf16 v[112:115], v[152:155], a[192:195], v[112:115]
  buffer_load_dwordx4 v[236:239], v2, s[48:51], s82 offen offset:2048 sc1
  v_mfma_f32_16x16x32_bf16 v[116:119], v[152:155], a[196:199], v[116:119]
  v_mfma_f32_16x16x32_bf16 v[120:123], v[152:155], a[200:203], v[120:123]
  v_mfma_f32_16x16x32_bf16 v[124:127], v[152:155], a[204:207], v[124:127]
  s_waitcnt vmcnt(14)
  v_mfma_f32_16x16x32_bf16 v[16:19], v[156:159], a[208:211], v[16:19]
  s_add_u32 s82, s74, 57344
  buffer_load_dwordx4 v[128:131], v2, s[48:51], s82 offen offset:0 sc1
  v_mfma_f32_16x16x32_bf16 v[20:23], v[156:159], a[212:215], v[20:23]
  ds_read_b128 a[64:67], v14 offset:0
  v_mfma_f32_16x16x32_bf16 v[24:27], v[156:159], a[216:219], v[24:27]
  v_mfma_f32_16x16x32_bf16 v[28:31], v[156:159], a[220:223], v[28:31]
  ds_read_b128 a[68:71], v14 offset:2048
  v_mfma_f32_16x16x32_bf16 v[32:35], v[160:163], a[208:211], v[32:35]
  buffer_load_dwordx4 v[132:135], v2, s[48:51], s82 offen offset:1024 sc1
  v_mfma_f32_16x16x32_bf16 v[36:39], v[160:163], a[212:215], v[36:39]
  ds_read_b128 a[72:75], v14 offset:4096
  v_mfma_f32_16x16x32_bf16 v[40:43], v[160:163], a[216:219], v[40:43]
  v_mfma_f32_16x16x32_bf16 v[44:47], v[160:163], a[220:223], v[44:47]
  ds_read_b128 a[76:79], v14 offset:6144
  v_mfma_f32_16x16x32_bf16 v[48:51], v[164:167], a[208:211], v[48:51]
  buffer_load_dwordx4 v[136:139], v2, s[48:51], s82 offen offset:2048 sc1
  v_mfma_f32_16x16x32_bf16 v[52:55], v[164:167], a[212:215], v[52:55]
  ds_read_b128 a[80:83], v15 offset:0
  v_mfma_f32_16x16x32_bf16 v[56:59], v[164:167], a[216:219], v[56:59]
  v_mfma_f32_16x16x32_bf16 v[60:63], v[164:167], a[220:223], v[60:63]
  ds_read_b128 a[84:87], v15 offset:2048
  v_mfma_f32_16x16x32_bf16 v[64:67], v[168:171], a[208:211], v[64:67]
  buffer_load_dwordx4 v[140:143], v2, s[48:51], s82 offen offset:3072 sc1
  v_mfma_f32_16x16x32_bf16 v[68:71], v[168:171], a[212:215], v[68:71]
  ds_read_b128 a[88:91], v15 offset:4096
  v_mfma_f32_16x16x32_bf16 v[72:75], v[168:171], a[216:219], v[72:75]
  v_mfma_f32_16x16x32_bf16 v[76:79], v[168:171], a[220:223], v[76:79]
  ds_read_b128 a[92:95], v15 offset:6144
  v_mfma_f32_16x16x32_bf16 v[80:83], v[172:175], a[208:211], v[80:83]
  s_add_u32 s82, s74, 61440
  buffer_load_dwordx4 v[144:147], v2, s[48:51], s82 offen offset:0 sc1
  v_mfma_f32_16x16x32_bf16 v[84:87], v[172:175], a[212:215], v[84:87]
  ds_read_b128 a[96:99], v14 offset:32768
  v_mfma_f32_16x16x32_bf16 v[88:91], v[172:175], a[216:219], v[88:91]
  v_mfma_f32_16x16x32_bf16 v[92:95], v[172:175], a[220:223], v[92:95]
  ds_read_b128 a[100:103], v14 offset:34816
  v_mfma_f32_16x16x32_bf16 v[96:99], v[176:179], a[208:211], v[96:99]
  buffer_load_dwordx4 v[148:151], v2, s[48:51], s82 offen offset:1024 sc1
  v_mfma_f32_16x16x32_bf16 v[100:103], v[176:179], a[212:215], v[100:103]
  ds_read_b128 a[104:107], v14 offset:36864
  v_mfma_f32_16x16x32_bf16 v[104:107], v[176:179], a[216:219], v[104:107]
  v_mfma_f32_16x16x32_bf16 v[108:111], v[176:179], a[220:223], v[108:111]
  ds_read_b128 a[108:111], v14 offset:38912
  v_mfma_f32_16x16x32_bf16 v[112:115], v[180:183], a[208:211], v[112:115]
  buffer_load_dwordx4 v[152:155], v2, s[48:51], s82 offen offset:2048 sc1
  v_mfma_f32_16x16x32_bf16 v[116:119], v[180:183], a[212:215], v[116:119]
  ds_read_b128 a[112:115], v15 offset:32768
  v_mfma_f32_16x16x32_bf16 v[120:123], v[180:183], a[216:219], v[120:123]
  v_mfma_f32_16x16x32_bf16 v[124:127], v[180:183], a[220:223], v[124:127]
  ds_read_b128 a[116:119], v15 offset:34816
  s_waitcnt vmcnt(14)
  v_mfma_f32_16x16x32_bf16 v[16:19], v[184:187], a[224:227], v[16:19]
  s_add_u32 s82, s74, 64512
  buffer_load_dwordx4 v[156:159], v2, s[48:51], s82 offen offset:0 sc1
  v_mfma_f32_16x16x32_bf16 v[20:23], v[184:187], a[228:231], v[20:23]
  ds_read_b128 a[120:123], v15 offset:36864
  v_mfma_f32_16x16x32_bf16 v[24:27], v[184:187], a[232:235], v[24:27]
  v_mfma_f32_16x16x32_bf16 v[28:31], v[184:187], a[236:239], v[28:31]
  ds_read_b128 a[124:127], v15 offset:38912
  v_mfma_f32_16x16x32_bf16 v[32:35], v[188:191], a[224:227], v[32:35]
  buffer_load_dwordx4 v[160:163], v2, s[48:51], s82 offen offset:1024 sc1
  v_mfma_f32_16x16x32_bf16 v[36:39], v[188:191], a[228:231], v[36:39]
  v_mfma_f32_16x16x32_bf16 v[40:43], v[188:191], a[232:235], v[40:43]
  v_mfma_f32_16x16x32_bf16 v[44:47], v[188:191], a[236:239], v[44:47]
  v_mfma_f32_16x16x32_bf16 v[48:51], v[192:195], a[224:227], v[48:51]
  buffer_load_dwordx4 v[164:167], v2, s[48:51], s82 offen offset:2048 sc1
  v_mfma_f32_16x16x32_bf16 v[52:55], v[192:195], a[228:231], v[52:55]
  v_mfma_f32_16x16x32_bf16 v[56:59], v[192:195], a[232:235], v[56:59]
  v_mfma_f32_16x16x32_bf16 v[60:63], v[192:195], a[236:239], v[60:63]
  v_mfma_f32_16x16x32_bf16 v[64:67], v[196:199], a[224:227], v[64:67]
  buffer_load_dwordx4 v[168:171], v2, s[48:51], s82 offen offset:3072 sc1
  v_mfma_f32_16x16x32_bf16 v[68:71], v[196:199], a[228:231], v[68:71]
  v_mfma_f32_16x16x32_bf16 v[72:75], v[196:199], a[232:235], v[72:75]
  v_mfma_f32_16x16x32_bf16 v[76:79], v[196:199], a[236:239], v[76:79]
  v_mfma_f32_16x16x32_bf16 v[80:83], v[200:203], a[224:227], v[80:83]
  s_add_u32 s82, s74, 68608
  buffer_load_dwordx4 v[172:175], v2, s[48:51], s82 offen offset:0 sc1
  v_mfma_f32_16x16x32_bf16 v[84:87], v[200:203], a[228:231], v[84:87]
  v_mfma_f32_16x16x32_bf16 v[88:91], v[200:203], a[232:235], v[88:91]
  v_mfma_f32_16x16x32_bf16 v[92:95], v[200:203], a[236:239], v[92:95]
  v_mfma_f32_16x16x32_bf16 v[96:99], v[204:207], a[224:227], v[96:99]
  buffer_load_dwordx4 v[176:179], v2, s[48:51], s82 offen offset:1024 sc1
  v_mfma_f32_16x16x32_bf16 v[100:103], v[204:207], a[228:231], v[100:103]
  v_mfma_f32_16x16x32_bf16 v[104:107], v[204:207], a[232:235], v[104:107]
  v_mfma_f32_16x16x32_bf16 v[108:111], v[204:207], a[236:239], v[108:111]
  v_mfma_f32_16x16x32_bf16 v[112:115], v[208:211], a[224:227], v[112:115]
  buffer_load_dwordx4 v[180:183], v2, s[48:51], s82 offen offset:2048 sc1
  v_mfma_f32_16x16x32_bf16 v[116:119], v[208:211], a[228:231], v[116:119]
  v_mfma_f32_16x16x32_bf16 v[120:123], v[208:211], a[232:235], v[120:123]
  v_mfma_f32_16x16x32_bf16 v[124:127], v[208:211], a[236:239], v[124:127]
  s_waitcnt vmcnt(14)
  v_mfma_f32_16x16x32_bf16 v[16:19], v[212:215], a[240:243], v[16:19]
  s_add_u32 s82, s74, 71680
  buffer_load_dwordx4 v[184:187], v2, s[48:51], s82 offen offset:0 sc1
  v_mfma_f32_16x16x32_bf16 v[20:23], v[212:215], a[244:247], v[20:23]
  v_mfma_f32_16x16x32_bf16 v[24:27], v[212:215], a[248:251], v[24:27]
  v_mfma_f32_16x16x32_bf16 v[28:31], v[212:215], a[252:255], v[28:31]
  v_mfma_f32_16x16x32_bf16 v[32:35], v[216:219], a[240:243], v[32:35]
  buffer_load_dwordx4 v[188:191], v2, s[48:51], s82 offen offset:1024 sc1
  v_mfma_f32_16x16x32_bf16 v[36:39], v[216:219], a[244:247], v[36:39]
  v_mfma_f32_16x16x32_bf16 v[40:43], v[216:219], a[248:251], v[40:43]
  v_mfma_f32_16x16x32_bf16 v[44:47], v[216:219], a[252:255], v[44:47]
  v_mfma_f32_16x16x32_bf16 v[48:51], v[220:223], a[240:243], v[48:51]
  buffer_load_dwordx4 v[192:195], v2, s[48:51], s82 offen offset:2048 sc1
  v_mfma_f32_16x16x32_bf16 v[52:55], v[220:223], a[244:247], v[52:55]
  v_mfma_f32_16x16x32_bf16 v[56:59], v[220:223], a[248:251], v[56:59]
  v_mfma_f32_16x16x32_bf16 v[60:63], v[220:223], a[252:255], v[60:63]
  v_mfma_f32_16x16x32_bf16 v[64:67], v[224:227], a[240:243], v[64:67]
  buffer_load_dwordx4 v[196:199], v2, s[48:51], s82 offen offset:3072 sc1
  v_mfma_f32_16x16x32_bf16 v[68:71], v[224:227], a[244:247], v[68:71]
  v_mfma_f32_16x16x32_bf16 v[72:75], v[224:227], a[248:251], v[72:75]
  v_mfma_f32_16x16x32_bf16 v[76:79], v[224:227], a[252:255], v[76:79]
  v_mfma_f32_16x16x32_bf16 v[80:83], v[228:231], a[240:243], v[80:83]
  s_add_u32 s82, s74, 75776
  buffer_load_dwordx4 v[200:203], v2, s[48:51], s82 offen offset:0 sc1
  v_mfma_f32_16x16x32_bf16 v[84:87], v[228:231], a[244:247], v[84:87]
  v_mfma_f32_16x16x32_bf16 v[88:91], v[228:231], a[248:251], v[88:91]
  v_mfma_f32_16x16x32_bf16 v[92:95], v[228:231], a[252:255], v[92:95]
  v_mfma_f32_16x16x32_bf16 v[96:99], v[232:235], a[240:243], v[96:99]
  buffer_load_dwordx4 v[204:207], v2, s[48:51], s82 offen offset:1024 sc1
  v_mfma_f32_16x16x32_bf16 v[100:103], v[232:235], a[244:247], v[100:103]
  v_mfma_f32_16x16x32_bf16 v[104:107], v[232:235], a[248:251], v[104:107]
  v_mfma_f32_16x16x32_bf16 v[108:111], v[232:235], a[252:255], v[108:111]
  v_mfma_f32_16x16x32_bf16 v[112:115], v[236:239], a[240:243], v[112:115]
  buffer_load_dwordx4 v[208:211], v2, s[48:51], s82 offen offset:2048 sc1
  v_mfma_f32_16x16x32_bf16 v[116:119], v[236:239], a[244:247], v[116:119]
  v_mfma_f32_16x16x32_bf16 v[120:123], v[236:239], a[248:251], v[120:123]
  v_mfma_f32_16x16x32_bf16 v[124:127], v[236:239], a[252:255], v[124:127]
  s_waitcnt vmcnt(14)
  s_waitcnt lgkmcnt(0)
  v_mfma_f32_16x16x32_bf16 v[16:19], v[128:131], a[0:3], v[16:19]
  s_add_u32 s82, s74, 78848
  buffer_load_dwordx4 v[212:215], v2, s[48:51], s82 offen offset:0 sc1
  v_mfma_f32_16x16x32_bf16 v[20:23], v[128:131], a[4:7], v[20:23]
  v_mfma_f32_16x16x32_bf16 v[24:27], v[128:131], a[8:11], v[24:27]
  v_mfma_f32_16x16x32_bf16 v[28:31], v[128:131], a[12:15], v[28:31]
  v_mfma_f32_16x16x32_bf16 v[32:35], v[132:135], a[0:3], v[32:35]
  buffer_load_dwordx4 v[216:219], v2, s[48:51], s82 offen offset:1024 sc1
  v_mfma_f32_16x16x32_bf16 v[36:39], v[132:135], a[4:7], v[36:39]
  v_mfma_f32_16x16x32_bf16 v[40:43], v[132:135], a[8:11], v[40:43]
  v_mfma_f32_16x16x32_bf16 v[44:47], v[132:135], a[12:15], v[44:47]
  v_mfma_f32_16x16x32_bf16 v[48:51], v[136:139], a[0:3], v[48:51]
  buffer_load_dwordx4 v[220:223], v2, s[48:51], s82 offen offset:2048 sc1
  v_mfma_f32_16x16x32_bf16 v[52:55], v[136:139], a[4:7], v[52:55]
  v_mfma_f32_16x16x32_bf16 v[56:59], v[136:139], a[8:11], v[56:59]
  v_mfma_f32_16x16x32_bf16 v[60:63], v[136:139], a[12:15], v[60:63]
  v_mfma_f32_16x16x32_bf16 v[64:67], v[140:143], a[0:3], v[64:67]
  buffer_load_dwordx4 v[224:227], v2, s[48:51], s82 offen offset:3072 sc1
  v_mfma_f32_16x16x32_bf16 v[68:71], v[140:143], a[4:7], v[68:71]
  v_mfma_f32_16x16x32_bf16 v[72:75], v[140:143], a[8:11], v[72:75]
  v_mfma_f32_16x16x32_bf16 v[76:79], v[140:143], a[12:15], v[76:79]
  v_mfma_f32_16x16x32_bf16 v[80:83], v[144:147], a[0:3], v[80:83]
  s_add_u32 s82, s74, 82944
  buffer_load_dwordx4 v[228:231], v2, s[48:51], s82 offen offset:0 sc1
  v_mfma_f32_16x16x32_bf16 v[84:87], v[144:147], a[4:7], v[84:87]
  v_mfma_f32_16x16x32_bf16 v[88:91], v[144:147], a[8:11], v[88:91]
  v_mfma_f32_16x16x32_bf16 v[92:95], v[144:147], a[12:15], v[92:95]
  v_mfma_f32_16x16x32_bf16 v[96:99], v[148:151], a[0:3], v[96:99]
  buffer_load_dwordx4 v[232:235], v2, s[48:51], s82 offen offset:1024 sc1
  v_mfma_f32_16x16x32_bf16 v[100:103], v[148:151], a[4:7], v[100:103]
  v_mfma_f32_16x16x32_bf16 v[104:107], v[148:151], a[8:11], v[104:107]
  v_mfma_f32_16x16x32_bf16 v[108:111], v[148:151], a[12:15], v[108:111]
  v_mfma_f32_16x16x32_bf16 v[112:115], v[152:155], a[0:3], v[112:115]
  buffer_load_dwordx4 v[236:239], v2, s[48:51], s82 offen offset:2048 sc1
  v_mfma_f32_16x16x32_bf16 v[116:119], v[152:155], a[4:7], v[116:119]
  v_mfma_f32_16x16x32_bf16 v[120:123], v[152:155], a[8:11], v[120:123]
  v_mfma_f32_16x16x32_bf16 v[124:127], v[152:155], a[12:15], v[124:127]
  s_waitcnt vmcnt(14)
  v_mfma_f32_16x16x32_bf16 v[16:19], v[156:159], a[16:19], v[16:19]
  s_add_u32 s82, s74, 86016
  buffer_load_dwordx4 v[128:131], v2, s[48:51], s82 offen offset:0 sc1
  v_mfma_f32_16x16x32_bf16 v[20:23], v[156:159], a[20:23], v[20:23]
  v_mfma_f32_16x16x32_bf16 v[24:27], v[156:159], a[24:27], v[24:27]
  v_mfma_f32_16x16x32_bf16 v[28:31], v[156:159], a[28:31], v[28:31]
  v_mfma_f32_16x16x32_bf16 v[32:35], v[160:163], a[16:19], v[32:35]
  buffer_load_dwordx4 v[132:135], v2, s[48:51], s82 offen offset:1024 sc1
  v_mfma_f32_16x16x32_bf16 v[36:39], v[160:163], a[20:23], v[36:39]
  v_mfma_f32_16x16x32_bf16 v[40:43], v[160:163], a[24:27], v[40:43]
  v_mfma_f32_16x16x32_bf16 v[44:47], v[160:163], a[28:31], v[44:47]
  v_mfma_f32_16x16x32_bf16 v[48:51], v[164:167], a[16:19], v[48:51]
  buffer_load_dwordx4 v[136:139], v2, s[48:51], s82 offen offset:2048 sc1
  v_mfma_f32_16x16x32_bf16 v[52:55], v[164:167], a[20:23], v[52:55]
  v_mfma_f32_16x16x32_bf16 v[56:59], v[164:167], a[24:27], v[56:59]
  v_mfma_f32_16x16x32_bf16 v[60:63], v[164:167], a[28:31], v[60:63]
  v_mfma_f32_16x16x32_bf16 v[64:67], v[168:171], a[16:19], v[64:67]
  buffer_load_dwordx4 v[140:143], v2, s[48:51], s82 offen offset:3072 sc1
  v_mfma_f32_16x16x32_bf16 v[68:71], v[168:171], a[20:23], v[68:71]
  v_mfma_f32_16x16x32_bf16 v[72:75], v[168:171], a[24:27], v[72:75]
  v_mfma_f32_16x16x32_bf16 v[76:79], v[168:171], a[28:31], v[76:79]
  v_mfma_f32_16x16x32_bf16 v[80:83], v[172:175], a[16:19], v[80:83]
  s_add_u32 s82, s74, 90112
  buffer_load_dwordx4 v[144:147], v2, s[48:51], s82 offen offset:0 sc1
  v_mfma_f32_16x16x32_bf16 v[84:87], v[172:175], a[20:23], v[84:87]
  v_mfma_f32_16x16x32_bf16 v[88:91], v[172:175], a[24:27], v[88:91]
  v_mfma_f32_16x16x32_bf16 v[92:95], v[172:175], a[28:31], v[92:95]
  v_mfma_f32_16x16x32_bf16 v[96:99], v[176:179], a[16:19], v[96:99]
  buffer_load_dwordx4 v[148:151], v2, s[48:51], s82 offen offset:1024 sc1
  v_mfma_f32_16x16x32_bf16 v[100:103], v[176:179], a[20:23], v[100:103]
  v_mfma_f32_16x16x32_bf16 v[104:107], v[176:179], a[24:27], v[104:107]
  v_mfma_f32_16x16x32_bf16 v[108:111], v[176:179], a[28:31], v[108:111]
  v_mfma_f32_16x16x32_bf16 v[112:115], v[180:183], a[16:19], v[112:115]
  buffer_load_dwordx4 v[152:155], v2, s[48:51], s82 offen offset:2048 sc1
  v_mfma_f32_16x16x32_bf16 v[116:119], v[180:183], a[20:23], v[116:119]
  v_mfma_f32_16x16x32_bf16 v[120:123], v[180:183], a[24:27], v[120:123]
  v_mfma_f32_16x16x32_bf16 v[124:127], v[180:183], a[28:31], v[124:127]
  s_waitcnt vmcnt(14)
  v_mfma_f32_16x16x32_bf16 v[16:19], v[184:187], a[32:35], v[16:19]
  s_add_u32 s82, s74, 93184
  buffer_load_dwordx4 v[156:159], v2, s[48:51], s82 offen offset:0 sc1
  v_mfma_f32_16x16x32_bf16 v[20:23], v[184:187], a[36:39], v[20:23]
  v_mfma_f32_16x16x32_bf16 v[24:27], v[184:187], a[40:43], v[24:27]
  v_mfma_f32_16x16x32_bf16 v[28:31], v[184:187], a[44:47], v[28:31]
  v_mfma_f32_16x16x32_bf16 v[32:35], v[188:191], a[32:35], v[32:35]
  buffer_load_dwordx4 v[160:163], v2, s[48:51], s82 offen offset:1024 sc1
  v_mfma_f32_16x16x32_bf16 v[36:39], v[188:191], a[36:39], v[36:39]
  v_mfma_f32_16x16x32_bf16 v[40:43], v[188:191], a[40:43], v[40:43]
  v_mfma_f32_16x16x32_bf16 v[44:47], v[188:191], a[44:47], v[44:47]
  v_mfma_f32_16x16x32_bf16 v[48:51], v[192:195], a[32:35], v[48:51]
  buffer_load_dwordx4 v[164:167], v2, s[48:51], s82 offen offset:2048 sc1
  v_mfma_f32_16x16x32_bf16 v[52:55], v[192:195], a[36:39], v[52:55]
  v_mfma_f32_16x16x32_bf16 v[56:59], v[192:195], a[40:43], v[56:59]
  v_mfma_f32_16x16x32_bf16 v[60:63], v[192:195], a[44:47], v[60:63]
  v_mfma_f32_16x16x32_bf16 v[64:67], v[196:199], a[32:35], v[64:67]
  buffer_load_dwordx4 v[168:171], v2, s[48:51], s82 offen offset:3072 sc1
  v_mfma_f32_16x16x32_bf16 v[68:71], v[196:199], a[36:39], v[68:71]
  v_mfma_f32_16x16x32_bf16 v[72:75], v[196:199], a[40:43], v[72:75]
  v_mfma_f32_16x16x32_bf16 v[76:79], v[196:199], a[44:47], v[76:79]
  v_mfma_f32_16x16x32_bf16 v[80:83], v[200:203], a[32:35], v[80:83]
  s_add_u32 s82, s74, 97280
  buffer_load_dwordx4 v[172:175], v2, s[48:51], s82 offen offset:0 sc1
  v_mfma_f32_16x16x32_bf16 v[84:87], v[200:203], a[36:39], v[84:87]
  v_mfma_f32_16x16x32_bf16 v[88:91], v[200:203], a[40:43], v[88:91]
  v_mfma_f32_16x16x32_bf16 v[92:95], v[200:203], a[44:47], v[92:95]
  v_mfma_f32_16x16x32_bf16 v[96:99], v[204:207], a[32:35], v[96:99]
  buffer_load_dwordx4 v[176:179], v2, s[48:51], s82 offen offset:1024 sc1
  v_mfma_f32_16x16x32_bf16 v[100:103], v[204:207], a[36:39], v[100:103]
  v_mfma_f32_16x16x32_bf16 v[104:107], v[204:207], a[40:43], v[104:107]
  v_mfma_f32_16x16x32_bf16 v[108:111], v[204:207], a[44:47], v[108:111]
  v_mfma_f32_16x16x32_bf16 v[112:115], v[208:211], a[32:35], v[112:115]
  buffer_load_dwordx4 v[180:183], v2, s[48:51], s82 offen offset:2048 sc1
  v_mfma_f32_16x16x32_bf16 v[116:119], v[208:211], a[36:39], v[116:119]
  v_mfma_f32_16x16x32_bf16 v[120:123], v[208:211], a[40:43], v[120:123]
  v_mfma_f32_16x16x32_bf16 v[124:127], v[208:211], a[44:47], v[124:127]
  s_waitcnt vmcnt(14)
  v_mfma_f32_16x16x32_bf16 v[16:19], v[212:215], a[48:51], v[16:19]
  s_add_u32 s82, s74, 100352
  buffer_load_dwordx4 v[184:187], v2, s[48:51], s82 offen offset:0 sc1
  v_mfma_f32_16x16x32_bf16 v[20:23], v[212:215], a[52:55], v[20:23]
  v_mfma_f32_16x16x32_bf16 v[24:27], v[212:215], a[56:59], v[24:27]
  v_mfma_f32_16x16x32_bf16 v[28:31], v[212:215], a[60:63], v[28:31]
  v_mfma_f32_16x16x32_bf16 v[32:35], v[216:219], a[48:51], v[32:35]
  buffer_load_dwordx4 v[188:191], v2, s[48:51], s82 offen offset:1024 sc1
  v_mfma_f32_16x16x32_bf16 v[36:39], v[216:219], a[52:55], v[36:39]
  v_mfma_f32_16x16x32_bf16 v[40:43], v[216:219], a[56:59], v[40:43]
  v_mfma_f32_16x16x32_bf16 v[44:47], v[216:219], a[60:63], v[44:47]
  v_mfma_f32_16x16x32_bf16 v[48:51], v[220:223], a[48:51], v[48:51]
  buffer_load_dwordx4 v[192:195], v2, s[48:51], s82 offen offset:2048 sc1
  v_mfma_f32_16x16x32_bf16 v[52:55], v[220:223], a[52:55], v[52:55]
  v_mfma_f32_16x16x32_bf16 v[56:59], v[220:223], a[56:59], v[56:59]
  v_mfma_f32_16x16x32_bf16 v[60:63], v[220:223], a[60:63], v[60:63]
  v_mfma_f32_16x16x32_bf16 v[64:67], v[224:227], a[48:51], v[64:67]
  buffer_load_dwordx4 v[196:199], v2, s[48:51], s82 offen offset:3072 sc1
  v_mfma_f32_16x16x32_bf16 v[68:71], v[224:227], a[52:55], v[68:71]
  v_mfma_f32_16x16x32_bf16 v[72:75], v[224:227], a[56:59], v[72:75]
  v_mfma_f32_16x16x32_bf16 v[76:79], v[224:227], a[60:63], v[76:79]
  v_mfma_f32_16x16x32_bf16 v[80:83], v[228:231], a[48:51], v[80:83]
  s_add_u32 s82, s74, 104448
  buffer_load_dwordx4 v[200:203], v2, s[48:51], s82 offen offset:0 sc1
  v_mfma_f32_16x16x32_bf16 v[84:87], v[228:231], a[52:55], v[84:87]
  v_mfma_f32_16x16x32_bf16 v[88:91], v[228:231], a[56:59], v[88:91]
  v_mfma_f32_16x16x32_bf16 v[92:95], v[228:231], a[60:63], v[92:95]
  v_mfma_f32_16x16x32_bf16 v[96:99], v[232:235], a[48:51], v[96:99]
  buffer_load_dwordx4 v[204:207], v2, s[48:51], s82 offen offset:1024 sc1
  v_mfma_f32_16x16x32_bf16 v[100:103], v[232:235], a[52:55], v[100:103]
  v_mfma_f32_16x16x32_bf16 v[104:107], v[232:235], a[56:59], v[104:107]
  v_mfma_f32_16x16x32_bf16 v[108:111], v[232:235], a[60:63], v[108:111]
  v_mfma_f32_16x16x32_bf16 v[112:115], v[236:239], a[48:51], v[112:115]
  buffer_load_dwordx4 v[208:211], v2, s[48:51], s82 offen offset:2048 sc1
  v_mfma_f32_16x16x32_bf16 v[116:119], v[236:239], a[52:55], v[116:119]
  v_mfma_f32_16x16x32_bf16 v[120:123], v[236:239], a[56:59], v[120:123]
  v_mfma_f32_16x16x32_bf16 v[124:127], v[236:239], a[60:63], v[124:127]
  s_waitcnt vmcnt(14)
  v_mfma_f32_16x16x32_bf16 v[16:19], v[128:131], a[64:67], v[16:19]
  s_add_u32 s82, s74, 107520
  buffer_load_dwordx4 v[212:215], v2, s[48:51], s82 offen offset:0 sc1
  v_mfma_f32_16x16x32_bf16 v[20:23], v[128:131], a[68:71], v[20:23]
  v_mfma_f32_16x16x32_bf16 v[24:27], v[128:131], a[72:75], v[24:27]
  v_mfma_f32_16x16x32_bf16 v[28:31], v[128:131], a[76:79], v[28:31]
  v_mfma_f32_16x16x32_bf16 v[32:35], v[132:135], a[64:67], v[32:35]
  buffer_load_dwordx4 v[216:219], v2, s[48:51], s82 offen offset:1024 sc1
  v_mfma_f32_16x16x32_bf16 v[36:39], v[132:135], a[68:71], v[36:39]
  v_mfma_f32_16x16x32_bf16 v[40:43], v[132:135], a[72:75], v[40:43]
  v_mfma_f32_16x16x32_bf16 v[44:47], v[132:135], a[76:79], v[44:47]
  v_mfma_f32_16x16x32_bf16 v[48:51], v[136:139], a[64:67], v[48:51]
  buffer_load_dwordx4 v[220:223], v2, s[48:51], s82 offen offset:2048 sc1
  v_mfma_f32_16x16x32_bf16 v[52:55], v[136:139], a[68:71], v[52:55]
  v_mfma_f32_16x16x32_bf16 v[56:59], v[136:139], a[72:75], v[56:59]
  v_mfma_f32_16x16x32_bf16 v[60:63], v[136:139], a[76:79], v[60:63]
  v_mfma_f32_16x16x32_bf16 v[64:67], v[140:143], a[64:67], v[64:67]
  buffer_load_dwordx4 v[224:227], v2, s[48:51], s82 offen offset:3072 sc1
  v_mfma_f32_16x16x32_bf16 v[68:71], v[140:143], a[68:71], v[68:71]
  v_mfma_f32_16x16x32_bf16 v[72:75], v[140:143], a[72:75], v[72:75]
  v_mfma_f32_16x16x32_bf16 v[76:79], v[140:143], a[76:79], v[76:79]
  v_mfma_f32_16x16x32_bf16 v[80:83], v[144:147], a[64:67], v[80:83]
  s_add_u32 s82, s74, 111616
  buffer_load_dwordx4 v[228:231], v2, s[48:51], s82 offen offset:0 sc1
  v_mfma_f32_16x16x32_bf16 v[84:87], v[144:147], a[68:71], v[84:87]
  v_mfma_f32_16x16x32_bf16 v[88:91], v[144:147], a[72:75], v[88:91]
  v_mfma_f32_16x16x32_bf16 v[92:95], v[144:147], a[76:79], v[92:95]
  v_mfma_f32_16x16x32_bf16 v[96:99], v[148:151], a[64:67], v[96:99]
  buffer_load_dwordx4 v[232:235], v2, s[48:51], s82 offen offset:1024 sc1
  v_mfma_f32_16x16x32_bf16 v[100:103], v[148:151], a[68:71], v[100:103]
  v_mfma_f32_16x16x32_bf16 v[104:107], v[148:151], a[72:75], v[104:107]
  v_mfma_f32_16x16x32_bf16 v[108:111], v[148:151], a[76:79], v[108:111]
  v_mfma_f32_16x16x32_bf16 v[112:115], v[152:155], a[64:67], v[112:115]
  buffer_load_dwordx4 v[236:239], v2, s[48:51], s82 offen offset:2048 sc1
  v_mfma_f32_16x16x32_bf16 v[116:119], v[152:155], a[68:71], v[116:119]
  v_mfma_f32_16x16x32_bf16 v[120:123], v[152:155], a[72:75], v[120:123]
  v_mfma_f32_16x16x32_bf16 v[124:127], v[152:155], a[76:79], v[124:127]
  s_waitcnt vmcnt(14)
  v_mfma_f32_16x16x32_bf16 v[16:19], v[156:159], a[80:83], v[16:19]
  v_mfma_f32_16x16x32_bf16 v[20:23], v[156:159], a[84:87], v[20:23]
  v_mfma_f32_16x16x32_bf16 v[24:27], v[156:159], a[88:91], v[24:27]
  v_mfma_f32_16x16x32_bf16 v[28:31], v[156:159], a[92:95], v[28:31]
  v_mfma_f32_16x16x32_bf16 v[32:35], v[160:163], a[80:83], v[32:35]
  v_mfma_f32_16x16x32_bf16 v[36:39], v[160:163], a[84:87], v[36:39]
  v_mfma_f32_16x16x32_bf16 v[40:43], v[160:163], a[88:91], v[40:43]
  v_mfma_f32_16x16x32_bf16 v[44:47], v[160:163], a[92:95], v[44:47]
  v_mfma_f32_16x16x32_bf16 v[48:51], v[164:167], a[80:83], v[48:51]
  v_mfma_f32_16x16x32_bf16 v[52:55], v[164:167], a[84:87], v[52:55]
  v_mfma_f32_16x16x32_bf16 v[56:59], v[164:167], a[88:91], v[56:59]
  v_mfma_f32_16x16x32_bf16 v[60:63], v[164:167], a[92:95], v[60:63]
  v_mfma_f32_16x16x32_bf16 v[64:67], v[168:171], a[80:83], v[64:67]
  v_mfma_f32_16x16x32_bf16 v[68:71], v[168:171], a[84:87], v[68:71]
  v_mfma_f32_16x16x32_bf16 v[72:75], v[168:171], a[88:91], v[72:75]
  v_mfma_f32_16x16x32_bf16 v[76:79], v[168:171], a[92:95], v[76:79]
  v_mfma_f32_16x16x32_bf16 v[80:83], v[172:175], a[80:83], v[80:83]
  v_mfma_f32_16x16x32_bf16 v[84:87], v[172:175], a[84:87], v[84:87]
  v_mfma_f32_16x16x32_bf16 v[88:91], v[172:175], a[88:91], v[88:91]
  v_mfma_f32_16x16x32_bf16 v[92:95], v[172:175], a[92:95], v[92:95]
  v_mfma_f32_16x16x32_bf16 v[96:99], v[176:179], a[80:83], v[96:99]
  v_mfma_f32_16x16x32_bf16 v[100:103], v[176:179], a[84:87], v[100:103]
  v_mfma_f32_16x16x32_bf16 v[104:107], v[176:179], a[88:91], v[104:107]
  v_mfma_f32_16x16x32_bf16 v[108:111], v[176:179], a[92:95], v[108:111]
  v_mfma_f32_16x16x32_bf16 v[112:115], v[180:183], a[80:83], v[112:115]
  v_mfma_f32_16x16x32_bf16 v[116:119], v[180:183], a[84:87], v[116:119]
  v_mfma_f32_16x16x32_bf16 v[120:123], v[180:183], a[88:91], v[120:123]
  v_mfma_f32_16x16x32_bf16 v[124:127], v[180:183], a[92:95], v[124:127]
  s_waitcnt vmcnt(0)
  s_lshl_b32 s82, s52, 13
  v_add_u32 v7, s82, v2
  v_add_u32 v6, 65536, v7
  s_mul_i32 s75, s54, 114688
  s_mul_i32 s83, s52, 28672
  s_add_u32 s75, s75, s83
  s_add_u32 s75, s75, 4194304
  v_mfma_f32_16x16x32_bf16 v[16:19], v[184:187], a[96:99], v[16:19]
  s_add_u32 s81, s75, 0
  buffer_load_dwordx4 a[0:3], v2, s[48:51], s81 offen offset:0 sc1
  v_mfma_f32_16x16x32_bf16 v[20:23], v[184:187], a[100:103], v[20:23]
  s_add_u32 s81, s75, 0
  buffer_load_dwordx4 a[4:7], v2, s[48:51], s81 offen offset:1024 sc1
  v_mfma_f32_16x16x32_bf16 v[24:27], v[184:187], a[104:107], v[24:27]
  s_add_u32 s81, s75, 0
  buffer_load_dwordx4 a[8:11], v2, s[48:51], s81 offen offset:2048 sc1
  v_mfma_f32_16x16x32_bf16 v[28:31], v[184:187], a[108:111], v[28:31]
  v_mfma_f32_16x16x32_bf16 v[16:19], v[212:215], a[112:115], v[16:19]
  v_mfma_f32_16x16x32_bf16 v[20:23], v[212:215], a[116:119], v[20:23]
  v_mfma_f32_16x16x32_bf16 v[24:27], v[212:215], a[120:123], v[24:27]
  v_mfma_f32_16x16x32_bf16 v[28:31], v[212:215], a[124:127], v[28:31]
  v_mfma_f32_16x16x32_bf16 v[32:35], v[188:191], a[96:99], v[32:35]
  s_add_u32 s81, s75, 0
  buffer_load_dwordx4 a[12:15], v2, s[48:51], s81 offen offset:3072 sc1
  v_mfma_f32_16x16x32_bf16 v[36:39], v[188:191], a[100:103], v[36:39]
  s_add_u32 s81, s75, 4096
  buffer_load_dwordx4 a[16:19], v2, s[48:51], s81 offen offset:0 sc1
  v_mfma_f32_16x16x32_bf16 v[40:43], v[188:191], a[104:107], v[40:43]
  s_add_u32 s81, s75, 4096
  buffer_load_dwordx4 a[20:23], v2, s[48:51], s81 offen offset:1024 sc1
  v_mfma_f32_16x16x32_bf16 v[44:47], v[188:191], a[108:111], v[44:47]
  v_mfma_f32_16x16x32_bf16 v[32:35], v[216:219], a[112:115], v[32:35]
  ds_write_b128 v7, v[16:19] offset:0
  v_mfma_f32_16x16x32_bf16 v[36:39], v[216:219], a[116:119], v[36:39]
  ds_write_b128 v7, v[20:23] offset:1024
  v_mfma_f32_16x16x32_bf16 v[40:43], v[216:219], a[120:123], v[40:43]
  ds_write_b128 v7, v[24:27] offset:2048
  v_mfma_f32_16x16x32_bf16 v[44:47], v[216:219], a[124:127], v[44:47]
  ds_write_b128 v7, v[28:31] offset:3072
  v_mfma_f32_16x16x32_bf16 v[48:51], v[192:195], a[96:99], v[48:51]
  s_add_u32 s81, s75, 4096
  buffer_load_dwordx4 a[24:27], v2, s[48:51], s81 offen offset:2048 sc1
  v_mfma_f32_16x16x32_bf16 v[52:55], v[192:195], a[100:103], v[52:55]
  s_add_u32 s81, s75, 4096
  buffer_load_dwordx4 a[28:31], v2, s[48:51], s81 offen offset:3072 sc1
  v_mfma_f32_16x16x32_bf16 v[56:59], v[192:195], a[104:107], v[56:59]
  s_add_u32 s81, s75, 8192
  buffer_load_dwordx4 a[32:35], v2, s[48:51], s81 offen offset:0 sc1
  v_mfma_f32_16x16x32_bf16 v[60:63], v[192:195], a[108:111], v[60:63]
  v_mfma_f32_16x16x32_bf16 v[48:51], v[220:223], a[112:115], v[48:51]
  ds_write_b128 v7, v[32:35] offset:4096
  v_mfma_f32_16x16x32_bf16 v[52:55], v[220:223], a[116:119], v[52:55]
  ds_write_b128 v7, v[36:39] offset:5120
  v_mfma_f32_16x16x32_bf16 v[56:59], v[220:223], a[120:123], v[56:59]
  ds_write_b128 v7, v[40:43] offset:6144
  v_mfma_f32_16x16x32_bf16 v[60:63], v[220:223], a[124:127], v[60:63]
  ds_write_b128 v7, v[44:47] offset:7168
  v_mfma_f32_16x16x32_bf16 v[64:67], v[196:199], a[96:99], v[64:67]
  s_add_u32 s81, s75, 8192
  buffer_load_dwordx4 a[36:39], v2, s[48:51], s81 offen offset:1024 sc1
  v_mfma_f32_16x16x32_bf16 v[68:71], v[196:199], a[100:103], v[68:71]
  s_add_u32 s81, s75, 8192
  buffer_load_dwordx4 a[40:43], v2, s[48:51], s81 offen offset:2048 sc1
  v_mfma_f32_16x16x32_bf16 v[72:75], v[196:199], a[104:107], v[72:75]
  s_add_u32 s81, s75, 8192
  buffer_load_dwordx4 a[44:47], v2, s[48:51], s81 offen offset:3072 sc1
  v_mfma_f32_16x16x32_bf16 v[76:79], v[196:199], a[108:111], v[76:79]
  v_mfma_f32_16x16x32_bf16 v[64:67], v[224:227], a[112:115], v[64:67]
  ds_write_b128 v7, v[48:51] offset:32768
  v_mfma_f32_16x16x32_bf16 v[68:71], v[224:227], a[116:119], v[68:71]
  ds_write_b128 v7, v[52:55] offset:33792
  v_mfma_f32_16x16x32_bf16 v[72:75], v[224:227], a[120:123], v[72:75]
  ds_write_b128 v7, v[56:59] offset:34816
  v_mfma_f32_16x16x32_bf16 v[76:79], v[224:227], a[124:127], v[76:79]
  ds_write_b128 v7, v[60:63] offset:35840
  v_mfma_f32_16x16x32_bf16 v[80:83], v[200:203], a[96:99], v[80:83]
  s_add_u32 s81, s75, 12288
  buffer_load_dwordx4 a[48:51], v2, s[48:51], s81 offen offset:0 sc1
  v_mfma_f32_16x16x32_bf16 v[84:87], v[200:203], a[100:103], v[84:87]
  s_add_u32 s81, s75, 12288
  buffer_load_dwordx4 a[52:55], v2, s[48:51], s81 offen offset:1024 sc1
  v_mfma_f32_16x16x32_bf16 v[88:91], v[200:203], a[104:107], v[88:91]
  s_add_u32 s81, s75, 12288
  buffer_load_dwordx4 a[56:59], v2, s[48:51], s81 offen offset:2048 sc1
  v_mfma_f32_16x16x32_bf16 v[92:95], v[200:203], a[108:111], v[92:95]
  v_mfma_f32_16x16x32_bf16 v[80:83], v[228:231], a[112:115], v[80:83]
  ds_write_b128 v7, v[64:67] offset:36864
  v_mfma_f32_16x16x32_bf16 v[84:87], v[228:231], a[116:119], v[84:87]
  ds_write_b128 v7, v[68:71] offset:37888
  v_mfma_f32_16x16x32_bf16 v[88:91], v[228:231], a[120:123], v[88:91]
  ds_write_b128 v7, v[72:75] offset:38912
  v_mfma_f32_16x16x32_bf16 v[92:95], v[228:231], a[124:127], v[92:95]
  ds_write_b128 v7, v[76:79] offset:39936
  v_mfma_f32_16x16x32_bf16 v[96:99], v[204:207], a[96:99], v[96:99]
  s_add_u32 s81, s75, 12288
  buffer_load_dwordx4 a[60:63], v2, s[48:51], s81 offen offset:3072 sc1
  v_mfma_f32_16x16x32_bf16 v[100:103], v[204:207], a[100:103], v[100:103]
  s_add_u32 s81, s75, 16384
  buffer_load_dwordx4 a[64:67], v2, s[48:51], s81 offen offset:0 sc1
  v_mfma_f32_16x16x32_bf16 v[104:107], v[204:207], a[104:107], v[104:107]
  s_add_u32 s81, s75, 16384
  buffer_load_dwordx4 a[68:71], v2, s[48:51], s81 offen offset:1024 sc1
  v_mfma_f32_16x16x32_bf16 v[108:111], v[204:207], a[108:111], v[108:111]
  v_mfma_f32_16x16x32_bf16 v[96:99], v[232:235], a[112:115], v[96:99]
  ds_write_b128 v6, v[80:83] offset:0
  v_mfma_f32_16x16x32_bf16 v[100:103], v[232:235], a[116:119], v[100:103]
  ds_write_b128 v6, v[84:87] offset:1024
  v_mfma_f32_16x16x32_bf16 v[104:107], v[232:235], a[120:123], v[104:107]
  ds_write_b128 v6, v[88:91] offset:2048
  v_mfma_f32_16x16x32_bf16 v[108:111], v[232:235], a[124:127], v[108:111]
  ds_write_b128 v6, v[92:95] offset:3072
  v_mfma_f32_16x16x32_bf16 v[112:115], v[208:211], a[96:99], v[112:115]
  s_add_u32 s81, s75, 16384
  buffer_load_dwordx4 a[72:75], v2, s[48:51], s81 offen offset:2048 sc1
  v_mfma_f32_16x16x32_bf16 v[116:119], v[208:211], a[100:103], v[116:119]
  s_add_u32 s81, s75, 16384
  buffer_load_dwordx4 a[76:79], v2, s[48:51], s81 offen offset:3072 sc1
  v_mfma_f32_16x16x32_bf16 v[120:123], v[208:211], a[104:107], v[120:123]
  s_add_u32 s81, s75, 20480
  buffer_load_dwordx4 a[80:83], v2, s[48:51], s81 offen offset:0 sc1
  v_mfma_f32_16x16x32_bf16 v[124:127], v[208:211], a[108:111], v[124:127]
  v_mfma_f32_16x16x32_bf16 v[112:115], v[236:239], a[112:115], v[112:115]
  ds_write_b128 v6, v[96:99] offset:4096
  v_mfma_f32_16x16x32_bf16 v[116:119], v[236:239], a[116:119], v[116:119]
  ds_write_b128 v6, v[100:103] offset:5120
  v_mfma_f32_16x16x32_bf16 v[120:123], v[236:239], a[120:123], v[120:123]
  ds_write_b128 v6, v[104:107] offset:6144
  v_mfma_f32_16x16x32_bf16 v[124:127], v[236:239], a[124:127], v[124:127]
  ds_write_b128 v6, v[108:111] offset:7168
  s_nop 0
  ds_write_b128 v6, v[112:115] offset:32768
  s_nop 0
  ds_write_b128 v6, v[116:119] offset:33792
  s_nop 0
  ds_write_b128 v6, v[120:123] offset:34816
  s_nop 0
  ds_write_b128 v6, v[124:127] offset:35840
  s_lshl_b32 s82, s52, 12
  s_add_u32 s82, s82, 135168
  v_add_u32 v8, s82, v2
  ds_read_b128 v[144:147], v8 offset:0
  ds_read_b128 v[148:151], v8 offset:1024
  ds_read_b128 v[152:155], v8 offset:2048
  ds_read_b128 v[156:159], v8 offset:3072
  s_lshl_b32 s82, s52, 15
  v_add_u32 v7, s82, v2
  v_lshlrev_b32 v240, 16, v240
  v_lshlrev_b32 v241, 16, v241
  v_lshlrev_b32 v242, 16, v242
  v_lshlrev_b32 v243, 16, v243
  v_and_b32 v9, 1, v4
  v_mul_u32_u24 v9, 28672, v9
  v_lshrrev_b32 v10, 1, v4
  v_lshlrev_b32 v10, 8, v10
  v_add_u32 v9, v9, v10
  v_lshlrev_b32 v10, 4, v3
  v_add_u32 v9, v9, v10
  s_waitcnt lgkmcnt(0)
  s_barrier
  ds_read_b128 v[16:19], v7 offset:0
  ds_read_b128 v[20:23], v7 offset:8192
  ds_read_b128 v[24:27], v7 offset:16384
  ds_read_b128 v[28:31], v7 offset:24576
  ds_read_b128 v[32:35], v7 offset:1024
  ds_read_b128 v[36:39], v7 offset:9216
  ds_read_b128 v[40:43], v7 offset:17408
  ds_read_b128 v[44:47], v7 offset:25600
  ds_read_b128 v[48:51], v7 offset:2048
  ds_read_b128 v[52:55], v7 offset:10240
  ds_read_b128 v[56:59], v7 offset:18432
  ds_read_b128 v[60:63], v7 offset:26624
  ds_read_b128 v[64:67], v7 offset:3072
  ds_read_b128 v[68:71], v7 offset:11264
  ds_read_b128 v[72:75], v7 offset:19456
  ds_read_b128 v[76:79], v7 offset:27648
  s_waitcnt lgkmcnt(12)
  v_pk_add_f32 v[16:17], v[16:17], v[20:21]
  v_pk_add_f32 v[24:25], v[24:25], v[28:29]
  v_pk_add_f32 v[18:19], v[18:19], v[22:23]
  v_pk_add_f32 v[26:27], v[26:27], v[30:31]
  v_pk_add_f32 v[16:17], v[16:17], v[24:25]
  v_pk_add_f32 v[18:19], v[18:19], v[26:27]
  v_lshlrev_b32 v20, 16, v144
  v_and_b32 v21, s100, v144
  v_lshlrev_b32 v22, 16, v145
  v_and_b32 v23, s100, v145
  v_add_f32 v16, v16, v240
  v_add_f32 v17, v17, v240
  v_add_f32 v18, v18, v240
  v_add_f32 v19, v19, v240
  v_pk_mul_f32 v[16:17], v[16:17], v[20:21]
  v_pk_mul_f32 v[18:19], v[18:19], v[22:23]
  v_cvt_pk_bf16_f32 v216, v16, v17
  v_cvt_pk_bf16_f32 v217, v18, v19
  ds_read_b128 v[80:83], v7 offset:4096
  ds_read_b128 v[84:87], v7 offset:12288
  ds_read_b128 v[88:91], v7 offset:20480
  ds_read_b128 v[92:95], v7 offset:28672
  s_waitcnt lgkmcnt(12)
  v_pk_add_f32 v[32:33], v[32:33], v[36:37]
  v_pk_add_f32 v[40:41], v[40:41], v[44:45]
  v_pk_add_f32 v[34:35], v[34:35], v[38:39]
  v_pk_add_f32 v[42:43], v[42:43], v[46:47]
  v_pk_add_f32 v[32:33], v[32:33], v[40:41]
  v_pk_add_f32 v[34:35], v[34:35], v[42:43]
  v_lshlrev_b32 v36, 16, v146
  v_and_b32 v37, s100, v146
  v_lshlrev_b32 v38, 16, v147
  v_and_b32 v39, s100, v147
  v_add_f32 v32, v32, v241
  v_add_f32 v33, v33, v241
  v_add_f32 v34, v34, v241
  v_add_f32 v35, v35, v241
  v_pk_mul_f32 v[32:33], v[32:33], v[36:37]
  v_pk_mul_f32 v[34:35], v[34:35], v[38:39]
  v_cvt_pk_bf16_f32 v218, v32, v33
  v_cvt_pk_bf16_f32 v219, v34, v35
  s_lshl_b32 s83, s52, 1
  s_add_u32 s83, s83, 0
  s_mul_i32 s84, s54, 14
  s_lshl_b32 s85, s83, 1
  s_add_u32 s84, s84, s85
  s_lshl_b32 s84, s84, 8
  s_lshl_b32 s85, s53, 2
  s_mul_i32 s85, s85, 28672
  s_add_u32 s84, s84, s85
  s_add_u32 s84, s84, 17825792
  s_cmp_lt_u32 s83, 7
  s_cselect_b32 s84, s84, 2130706432
  s_add_u32 s85, s84, 57344
  v_permlane16_swap_b32 v216, v218
  v_permlane16_swap_b32 v217, v219
  buffer_store_dwordx4 v[216:219], v9, s[48:51], s84 offen sc1
  ds_read_b128 v[96:99], v7 offset:5120
  ds_read_b128 v[100:103], v7 offset:13312
  ds_read_b128 v[104:107], v7 offset:21504
  ds_read_b128 v[108:111], v7 offset:29696
  s_waitcnt lgkmcnt(12)
  v_pk_add_f32 v[48:49], v[48:49], v[52:53]
  v_pk_add_f32 v[56:57], v[56:57], v[60:61]
  v_pk_add_f32 v[50:51], v[50:51], v[54:55]
  v_pk_add_f32 v[58:59], v[58:59], v[62:63]
  v_pk_add_f32 v[48:49], v[48:49], v[56:57]
  v_pk_add_f32 v[50:51], v[50:51], v[58:59]
  v_lshlrev_b32 v52, 16, v148
  v_and_b32 v53, s100, v148
  v_lshlrev_b32 v54, 16, v149
  v_and_b32 v55, s100, v149
  v_add_f32 v48, v48, v242
  v_add_f32 v49, v49, v242
  v_add_f32 v50, v50, v242
  v_add_f32 v51, v51, v242
  v_pk_mul_f32 v[48:49], v[48:49], v[52:53]
  v_pk_mul_f32 v[50:51], v[50:51], v[54:55]
  v_cvt_pk_bf16_f32 v220, v48, v49
  v_cvt_pk_bf16_f32 v221, v50, v51
  ds_read_b128 v[112:115], v7 offset:6144
  ds_read_b128 v[116:119], v7 offset:14336
  ds_read_b128 v[120:123], v7 offset:22528
  ds_read_b128 v[124:127], v7 offset:30720
  s_waitcnt lgkmcnt(12)
  v_pk_add_f32 v[64:65], v[64:65], v[68:69]
  v_pk_add_f32 v[72:73], v[72:73], v[76:77]
  v_pk_add_f32 v[66:67], v[66:67], v[70:71]
  v_pk_add_f32 v[74:75], v[74:75], v[78:79]
  v_pk_add_f32 v[64:65], v[64:65], v[72:73]
  v_pk_add_f32 v[66:67], v[66:67], v[74:75]
  v_lshlrev_b32 v68, 16, v150
  v_and_b32 v69, s100, v150
  v_lshlrev_b32 v70, 16, v151
  v_and_b32 v71, s100, v151
  v_add_f32 v64, v64, v243
  v_add_f32 v65, v65, v243
  v_add_f32 v66, v66, v243
  v_add_f32 v67, v67, v243
  v_pk_mul_f32 v[64:65], v[64:65], v[68:69]
  v_pk_mul_f32 v[66:67], v[66:67], v[70:71]
  v_cvt_pk_bf16_f32 v222, v64, v65
  v_cvt_pk_bf16_f32 v223, v66, v67
  s_nop 0
  v_permlane16_swap_b32 v220, v222
  v_permlane16_swap_b32 v221, v223
  buffer_store_dwordx4 v[220:223], v9, s[48:51], s85 offen sc1
  ds_read_b128 v[128:131], v7 offset:7168
  ds_read_b128 v[132:135], v7 offset:15360
  ds_read_b128 v[136:139], v7 offset:23552
  ds_read_b128 v[140:143], v7 offset:31744
  s_waitcnt lgkmcnt(12)
  v_pk_add_f32 v[80:81], v[80:81], v[84:85]
  v_pk_add_f32 v[88:89], v[88:89], v[92:93]
  v_pk_add_f32 v[82:83], v[82:83], v[86:87]
  v_pk_add_f32 v[90:91], v[90:91], v[94:95]
  v_pk_add_f32 v[80:81], v[80:81], v[88:89]
  v_pk_add_f32 v[82:83], v[82:83], v[90:91]
  v_lshlrev_b32 v84, 16, v152
  v_and_b32 v85, s100, v152
  v_lshlrev_b32 v86, 16, v153
  v_and_b32 v87, s100, v153
  v_add_f32 v80, v80, v240
  v_add_f32 v81, v81, v240
  v_add_f32 v82, v82, v240
  v_add_f32 v83, v83, v240
  v_pk_mul_f32 v[80:81], v[80:81], v[84:85]
  v_pk_mul_f32 v[82:83], v[82:83], v[86:87]
  v_cvt_pk_bf16_f32 v224, v80, v81
  v_cvt_pk_bf16_f32 v225, v82, v83
  s_waitcnt lgkmcnt(8)
  v_pk_add_f32 v[96:97], v[96:97], v[100:101]
  v_pk_add_f32 v[104:105], v[104:105], v[108:109]
  v_pk_add_f32 v[98:99], v[98:99], v[102:103]
  v_pk_add_f32 v[106:107], v[106:107], v[110:111]
  v_pk_add_f32 v[96:97], v[96:97], v[104:105]
  v_pk_add_f32 v[98:99], v[98:99], v[106:107]
  v_lshlrev_b32 v100, 16, v154
  v_and_b32 v101, s100, v154
  v_lshlrev_b32 v102, 16, v155
  v_and_b32 v103, s100, v155
  v_add_f32 v96, v96, v241
  v_add_f32 v97, v97, v241
  v_add_f32 v98, v98, v241
  v_add_f32 v99, v99, v241
  v_pk_mul_f32 v[96:97], v[96:97], v[100:101]
  v_pk_mul_f32 v[98:99], v[98:99], v[102:103]
  v_cvt_pk_bf16_f32 v226, v96, v97
  v_cvt_pk_bf16_f32 v227, v98, v99
  s_lshl_b32 s83, s52, 1
  s_add_u32 s83, s83, 1
  s_mul_i32 s84, s54, 14
  s_lshl_b32 s85, s83, 1
  s_add_u32 s84, s84, s85
  s_lshl_b32 s84, s84, 8
  s_lshl_b32 s85, s53, 2
  s_mul_i32 s85, s85, 28672
  s_add_u32 s84, s84, s85
  s_add_u32 s84, s84, 17825792
  s_cmp_lt_u32 s83, 7
  s_cselect_b32 s84, s84, 2130706432
  s_add_u32 s85, s84, 57344
  v_permlane16_swap_b32 v224, v226
  v_permlane16_swap_b32 v225, v227
  buffer_store_dwordx4 v[224:227], v9, s[48:51], s84 offen sc1
  s_waitcnt lgkmcnt(4)
  v_pk_add_f32 v[112:113], v[112:113], v[116:117]
  v_pk_add_f32 v[120:121], v[120:121], v[124:125]
  v_pk_add_f32 v[114:115], v[114:115], v[118:119]
  v_pk_add_f32 v[122:123], v[122:123], v[126:127]
  v_pk_add_f32 v[112:113], v[112:113], v[120:121]
  v_pk_add_f32 v[114:115], v[114:115], v[122:123]
  v_lshlrev_b32 v116, 16, v156
  v_and_b32 v117, s100, v156
  v_lshlrev_b32 v118, 16, v157
  v_and_b32 v119, s100, v157
  v_add_f32 v112, v112, v242
  v_add_f32 v113, v113, v242
  v_add_f32 v114, v114, v242
  v_add_f32 v115, v115, v242
  v_pk_mul_f32 v[112:113], v[112:113], v[116:117]
  v_pk_mul_f32 v[114:115], v[114:115], v[118:119]
  v_cvt_pk_bf16_f32 v228, v112, v113
  v_cvt_pk_bf16_f32 v229, v114, v115
  s_waitcnt lgkmcnt(0)
  v_pk_add_f32 v[128:129], v[128:129], v[132:133]
  v_pk_add_f32 v[136:137], v[136:137], v[140:141]
  v_pk_add_f32 v[130:131], v[130:131], v[134:135]
  v_pk_add_f32 v[138:139], v[138:139], v[142:143]
  v_pk_add_f32 v[128:129], v[128:129], v[136:137]
  v_pk_add_f32 v[130:131], v[130:131], v[138:139]
  v_lshlrev_b32 v132, 16, v158
  v_and_b32 v133, s100, v158
  v_lshlrev_b32 v134, 16, v159
  v_and_b32 v135, s100, v159
  v_add_f32 v128, v128, v243
  v_add_f32 v129, v129, v243
  v_add_f32 v130, v130, v243
  v_add_f32 v131, v131, v243
  v_pk_mul_f32 v[128:129], v[128:129], v[132:133]
  v_pk_mul_f32 v[130:131], v[130:131], v[134:135]
  v_cvt_pk_bf16_f32 v230, v128, v129
  v_cvt_pk_bf16_f32 v231, v130, v131
  s_nop 0
  v_permlane16_swap_b32 v228, v230
  v_permlane16_swap_b32 v229, v231
  buffer_store_dwordx4 v[228:231], v9, s[48:51], s85 offen sc1
  s_lshl_b32 s82, s53, 7
  s_add_u32 s62, s82, 28672
  s_lshl_b32 s83, s54, 2
  s_add_u32 s66, s62, s83
  s_add_u32 s81, s75, 20480
  buffer_load_dwordx4 a[84:87], v2, s[48:51], s81 offen offset:1024 sc1
  s_add_u32 s81, s75, 20480
  buffer_load_dwordx4 a[88:91], v2, s[48:51], s81 offen offset:2048 sc1
  s_waitcnt vmcnt(2)
  s_barrier
  s_cmp_eq_u32 s52, 0
  s_cbranch_scc0 L_pub_20
  v_mov_b32 v5, s55
  s_mov_b64 exec, 1
  buffer_store_dword v5, off, s[48:51], s66 sc1
  s_mov_b64 exec, -1
L_pub_20:
  s_add_u32 s81, s75, 20480
  buffer_load_dwordx4 a[92:95], v2, s[48:51], s81 offen offset:3072 sc1
  s_add_u32 s81, s75, 24576
  buffer_load_dwordx4 a[96:99], v2, s[48:51], s81 offen offset:0 sc1
  s_add_u32 s81, s75, 24576
  buffer_load_dwordx4 a[100:103], v2, s[48:51], s81 offen offset:1024 sc1
  s_add_u32 s81, s75, 24576
  buffer_load_dwordx4 a[104:107], v2, s[48:51], s81 offen offset:2048 sc1
  s_add_u32 s81, s75, 24576
  buffer_load_dwordx4 a[108:111], v2, s[48:51], s81 offen offset:3072 sc1
  s_lshl_b32 s82, s53, 2
  s_mul_i32 s82, s82, 28672
  s_mul_i32 s83, s52, 7168
  s_add_u32 s82, s82, s83
  s_add_u32 s82, s82, 17825792
  s_add_u32 s76, s82, 0
  s_add_u32 s77, s82, 28672
  s_add_u32 s78, s82, 57344
  s_add_u32 s79, s82, 86016
  v_lshlrev_b32 v8, 4, v4
  s_mul_i32 s82, s54, 112
  s_add_u32 s82, s82, 160384
  v_add_u32 v8, s82, v8
  ds_read_b128 v[192:195], v8
  ds_read_b128 v[196:199], v8 offset:64
  v_lshrrev_b32 v6, 2, v3
  v_lshlrev_b32 v6, 3, v6
  v_and_b32 v7, 3, v3
  v_add_u32 v6, v6, v7
  s_lshr_b32 s82, s52, 1
  s_lshl_b32 s82, s82, 5
  s_and_b32 s83, s52, 1
  s_lshl_b32 s83, s83, 2
  s_add_u32 s82, s82, s83
  s_lshl_b32 s83, s53, 6
  s_add_u32 s82, s82, s83
  v_add_u32 v6, s82, v6
  v_mul_u32_u24 v6, 896, v6
  v_lshlrev_b32 v7, 4, v4
  v_add_u32 v9, v6, v7
  s_mul_i32 s67, s54, 112
  v_and_b32 v5, 7, v1
  v_lshlrev_b32 v11, 2, v5
  s_mov_b32 s101, 0
  s_nop 0
L_f6_21:
  buffer_load_dword v10, v11, s[48:51], s62 offen sc1
  s_waitcnt vmcnt(0)
  v_cmp_eq_u32 vcc, s55, v10
  s_nop 3
  s_mov_b32 s82, vcc_lo
  s_and_b32 s82, s82, 0xff
  s_cmp_eq_u32 s82, 0xff
  s_cbranch_scc1 L_f6ok_22
  s_add_u32 s101, s101, 1
  s_cmp_lt_u32 s101, 131072
  s_cbranch_scc1 L_f6_21
  v_mov_b32 v5, 22
  v_mov_b32 v6, 0
  buffer_store_dword v5, v6, s[4:7], 0 offen
  s_nop 0
L_f6ok_22:
  buffer_load_dwordx4 v[16:19], v2, s[48:51], s76 offen offset:0 sc1
  buffer_load_dwordx4 v[20:23], v2, s[48:51], s77 offen offset:0 sc1
  buffer_load_dwordx4 v[24:27], v2, s[48:51], s78 offen offset:0 sc1
  buffer_load_dwordx4 v[28:31], v2, s[48:51], s79 offen offset:0 sc1
  buffer_load_dwordx4 v[32:35], v2, s[48:51], s76 offen offset:1024 sc1
  buffer_load_dwordx4 v[36:39], v2, s[48:51], s77 offen offset:1024 sc1
  buffer_load_dwordx4 v[40:43], v2, s[48:51], s78 offen offset:1024 sc1
  buffer_load_dwordx4 v[44:47], v2, s[48:51], s79 offen offset:1024 sc1
  buffer_load_dwordx4 v[48:51], v2, s[48:51], s76 offen offset:2048 sc1
  buffer_load_dwordx4 v[52:55], v2, s[48:51], s77 offen offset:2048 sc1
  buffer_load_dwordx4 v[56:59], v2, s[48:51], s78 offen offset:2048 sc1
  buffer_load_dwordx4 v[60:63], v2, s[48:51], s79 offen offset:2048 sc1
  buffer_load_dwordx4 v[64:67], v2, s[48:51], s76 offen offset:3072 sc1
  buffer_load_dwordx4 v[68:71], v2, s[48:51], s77 offen offset:3072 sc1
  buffer_load_dwordx4 v[72:75], v2, s[48:51], s78 offen offset:3072 sc1
  buffer_load_dwordx4 v[76:79], v2, s[48:51], s79 offen offset:3072 sc1
  s_add_u32 s76, s76, 4096
  buffer_load_dwordx4 v[80:83], v2, s[48:51], s76 offen offset:0 sc1
  s_add_u32 s77, s77, 4096
  buffer_load_dwordx4 v[84:87], v2, s[48:51], s77 offen offset:0 sc1
  s_add_u32 s78, s78, 4096
  buffer_load_dwordx4 v[88:91], v2, s[48:51], s78 offen offset:0 sc1
  s_add_u32 s79, s79, 4096
  buffer_load_dwordx4 v[92:95], v2, s[48:51], s79 offen offset:0 sc1
  buffer_load_dwordx4 v[96:99], v2, s[48:51], s76 offen offset:1024 sc1
  buffer_load_dwordx4 v[100:103], v2, s[48:51], s77 offen offset:1024 sc1
  buffer_load_dwordx4 v[104:107], v2, s[48:51], s78 offen offset:1024 sc1
  buffer_load_dwordx4 v[108:111], v2, s[48:51], s79 offen offset:1024 sc1
  buffer_load_dwordx4 v[112:115], v2, s[48:51], s76 offen offset:2048 sc1
  buffer_load_dwordx4 v[116:119], v2, s[48:51], s77 offen offset:2048 sc1
  buffer_load_dwordx4 v[120:123], v2, s[48:51], s78 offen offset:2048 sc1
  buffer_load_dwordx4 v[124:127], v2, s[48:51], s79 offen offset:2048 sc1
  v_lshlrev_b32 v200, 16, v248
  v_and_b32 v201, s100, v248
  v_lshlrev_b32 v216, 16, v192
  v_and_b32 v217, s100, v192
  v_lshlrev_b32 v202, 16, v249
  v_and_b32 v203, s100, v249
  v_lshlrev_b32 v218, 16, v193
  v_and_b32 v219, s100, v193
  v_lshlrev_b32 v204, 16, v250
  v_and_b32 v205, s100, v250
  v_lshlrev_b32 v220, 16, v194
  v_and_b32 v221, s100, v194
  v_lshlrev_b32 v206, 16, v251
  v_and_b32 v207, s100, v251
  v_lshlrev_b32 v222, 16, v195
  v_and_b32 v223, s100, v195
  v_lshlrev_b32 v208, 16, v252
  v_and_b32 v209, s100, v252
  v_lshlrev_b32 v224, 16, v196
  v_and_b32 v225, s100, v196
  v_lshlrev_b32 v210, 16, v253
  v_and_b32 v211, s100, v253
  v_lshlrev_b32 v226, 16, v197
  v_and_b32 v227, s100, v197
  v_lshlrev_b32 v212, 16, v254
  v_and_b32 v213, s100, v254
  v_lshlrev_b32 v228, 16, v198
  v_and_b32 v229, s100, v198
  v_lshlrev_b32 v214, 16, v255
  v_and_b32 v215, s100, v255
  v_lshlrev_b32 v230, 16, v199
  v_and_b32 v231, s100, v199
  s_waitcnt vmcnt(24)
  v_mfma_f32_16x16x32_bf16 v[128:131], a[0:3], v[16:19], 0
  v_mfma_f32_16x16x32_bf16 v[132:135], a[0:3], v[20:23], 0
  v_mfma_f32_16x16x32_bf16 v[136:139], a[0:3], v[24:27], 0
  v_mfma_f32_16x16x32_bf16 v[140:143], a[0:3], v[28:31], 0
  v_mfma_f32_16x16x32_bf16 v[144:147], a[4:7], v[16:19], 0
  v_mfma_f32_16x16x32_bf16 v[148:151], a[4:7], v[20:23], 0
  v_mfma_f32_16x16x32_bf16 v[152:155], a[4:7], v[24:27], 0
  v_mfma_f32_16x16x32_bf16 v[156:159], a[4:7], v[28:31], 0
  v_mfma_f32_16x16x32_bf16 v[160:163], a[8:11], v[16:19], 0
  v_mfma_f32_16x16x32_bf16 v[164:167], a[8:11], v[20:23], 0
  v_mfma_f32_16x16x32_bf16 v[168:171], a[8:11], v[24:27], 0
  v_mfma_f32_16x16x32_bf16 v[172:175], a[8:11], v[28:31], 0
  v_mfma_f32_16x16x32_bf16 v[176:179], a[12:15], v[16:19], 0
  v_mfma_f32_16x16x32_bf16 v[180:183], a[12:15], v[20:23], 0
  v_mfma_f32_16x16x32_bf16 v[184:187], a[12:15], v[24:27], 0
  v_mfma_f32_16x16x32_bf16 v[188:191], a[12:15], v[28:31], 0
  s_waitcnt vmcnt(20)
  v_mfma_f32_16x16x32_bf16 v[128:131], a[16:19], v[32:35], v[128:131]
  v_mfma_f32_16x16x32_bf16 v[132:135], a[16:19], v[36:39], v[132:135]
  v_mfma_f32_16x16x32_bf16 v[136:139], a[16:19], v[40:43], v[136:139]
  v_mfma_f32_16x16x32_bf16 v[140:143], a[16:19], v[44:47], v[140:143]
  v_mfma_f32_16x16x32_bf16 v[144:147], a[20:23], v[32:35], v[144:147]
  v_mfma_f32_16x16x32_bf16 v[148:151], a[20:23], v[36:39], v[148:151]
  v_mfma_f32_16x16x32_bf16 v[152:155], a[20:23], v[40:43], v[152:155]
  v_mfma_f32_16x16x32_bf16 v[156:159], a[20:23], v[44:47], v[156:159]
  v_mfma_f32_16x16x32_bf16 v[160:163], a[24:27], v[32:35], v[160:163]
  v_mfma_f32_16x16x32_bf16 v[164:167], a[24:27], v[36:39], v[164:167]
  v_mfma_f32_16x16x32_bf16 v[168:171], a[24:27], v[40:43], v[168:171]
  v_mfma_f32_16x16x32_bf16 v[172:175], a[24:27], v[44:47], v[172:175]
  v_mfma_f32_16x16x32_bf16 v[176:179], a[28:31], v[32:35], v[176:179]
  v_mfma_f32_16x16x32_bf16 v[180:183], a[28:31], v[36:39], v[180:183]
  v_mfma_f32_16x16x32_bf16 v[184:187], a[28:31], v[40:43], v[184:187]
  v_mfma_f32_16x16x32_bf16 v[188:191], a[28:31], v[44:47], v[188:191]
  s_waitcnt vmcnt(16)
  v_mfma_f32_16x16x32_bf16 v[128:131], a[32:35], v[48:51], v[128:131]
  v_mfma_f32_16x16x32_bf16 v[132:135], a[32:35], v[52:55], v[132:135]
  v_mfma_f32_16x16x32_bf16 v[136:139], a[32:35], v[56:59], v[136:139]
  v_mfma_f32_16x16x32_bf16 v[140:143], a[32:35], v[60:63], v[140:143]
  v_mfma_f32_16x16x32_bf16 v[144:147], a[36:39], v[48:51], v[144:147]
  v_mfma_f32_16x16x32_bf16 v[148:151], a[36:39], v[52:55], v[148:151]
  v_mfma_f32_16x16x32_bf16 v[152:155], a[36:39], v[56:59], v[152:155]
  v_mfma_f32_16x16x32_bf16 v[156:159], a[36:39], v[60:63], v[156:159]
  v_mfma_f32_16x16x32_bf16 v[160:163], a[40:43], v[48:51], v[160:163]
  v_mfma_f32_16x16x32_bf16 v[164:167], a[40:43], v[52:55], v[164:167]
  v_mfma_f32_16x16x32_bf16 v[168:171], a[40:43], v[56:59], v[168:171]
  v_mfma_f32_16x16x32_bf16 v[172:175], a[40:43], v[60:63], v[172:175]
  v_mfma_f32_16x16x32_bf16 v[176:179], a[44:47], v[48:51], v[176:179]
  v_mfma_f32_16x16x32_bf16 v[180:183], a[44:47], v[52:55], v[180:183]
  v_mfma_f32_16x16x32_bf16 v[184:187], a[44:47], v[56:59], v[184:187]
  v_mfma_f32_16x16x32_bf16 v[188:191], a[44:47], v[60:63], v[188:191]
  s_waitcnt vmcnt(12)
  v_mfma_f32_16x16x32_bf16 v[128:131], a[48:51], v[64:67], v[128:131]
  v_mfma_f32_16x16x32_bf16 v[132:135], a[48:51], v[68:71], v[132:135]
  v_mfma_f32_16x16x32_bf16 v[136:139], a[48:51], v[72:75], v[136:139]
  v_mfma_f32_16x16x32_bf16 v[140:143], a[48:51], v[76:79], v[140:143]
  v_mfma_f32_16x16x32_bf16 v[144:147], a[52:55], v[64:67], v[144:147]
  v_mfma_f32_16x16x32_bf16 v[148:151], a[52:55], v[68:71], v[148:151]
  v_mfma_f32_16x16x32_bf16 v[152:155], a[52:55], v[72:75], v[152:155]
  v_mfma_f32_16x16x32_bf16 v[156:159], a[52:55], v[76:79], v[156:159]
  v_mfma_f32_16x16x32_bf16 v[160:163], a[56:59], v[64:67], v[160:163]
  v_mfma_f32_16x16x32_bf16 v[164:167], a[56:59], v[68:71], v[164:167]
  v_mfma_f32_16x16x32_bf16 v[168:171], a[56:59], v[72:75], v[168:171]
  v_mfma_f32_16x16x32_bf16 v[172:175], a[56:59], v[76:79], v[172:175]
  v_mfma_f32_16x16x32_bf16 v[176:179], a[60:63], v[64:67], v[176:179]
  v_mfma_f32_16x16x32_bf16 v[180:183], a[60:63], v[68:71], v[180:183]
  v_mfma_f32_16x16x32_bf16 v[184:187], a[60:63], v[72:75], v[184:187]
  v_mfma_f32_16x16x32_bf16 v[188:191], a[60:63], v[76:79], v[188:191]
  s_waitcnt vmcnt(8)
  v_mfma_f32_16x16x32_bf16 v[128:131], a[64:67], v[80:83], v[128:131]
  v_mfma_f32_16x16x32_bf16 v[132:135], a[64:67], v[84:87], v[132:135]
  v_mfma_f32_16x16x32_bf16 v[136:139], a[64:67], v[88:91], v[136:139]
  v_mfma_f32_16x16x32_bf16 v[140:143], a[64:67], v[92:95], v[140:143]
  v_mfma_f32_16x16x32_bf16 v[144:147], a[68:71], v[80:83], v[144:147]
  v_mfma_f32_16x16x32_bf16 v[148:151], a[68:71], v[84:87], v[148:151]
  v_mfma_f32_16x16x32_bf16 v[152:155], a[68:71], v[88:91], v[152:155]
  v_mfma_f32_16x16x32_bf16 v[156:159], a[68:71], v[92:95], v[156:159]
  v_mfma_f32_16x16x32_bf16 v[160:163], a[72:75], v[80:83], v[160:163]
  v_mfma_f32_16x16x32_bf16 v[164:167], a[72:75], v[84:87], v[164:167]
  v_mfma_f32_16x16x32_bf16 v[168:171], a[72:75], v[88:91], v[168:171]
  v_mfma_f32_16x16x32_bf16 v[172:175], a[72:75], v[92:95], v[172:175]
  v_mfma_f32_16x16x32_bf16 v[176:179], a[76:79], v[80:83], v[176:179]
  v_mfma_f32_16x16x32_bf16 v[180:183], a[76:79], v[84:87], v[180:183]
  v_mfma_f32_16x16x32_bf16 v[184:187], a[76:79], v[88:91], v[184:187]
  v_mfma_f32_16x16x32_bf16 v[188:191], a[76:79], v[92:95], v[188:191]
  s_lshl_b32 s82, s52, 14
  s_add_u32 s82, s82, 0
  v_add_u32 v7, s82, v2
  s_waitcnt vmcnt(0)
  v_mfma_f32_16x16x32_bf16 v[128:131], a[80:83], v[96:99], v[128:131]
  v_mfma_f32_16x16x32_bf16 v[132:135], a[80:83], v[100:103], v[132:135]
  v_mfma_f32_16x16x32_bf16 v[136:139], a[80:83], v[104:107], v[136:139]
  v_mfma_f32_16x16x32_bf16 v[140:143], a[80:83], v[108:111], v[140:143]
  v_mfma_f32_16x16x32_bf16 v[128:131], a[96:99], v[112:115], v[128:131]
  v_mfma_f32_16x16x32_bf16 v[132:135], a[96:99], v[116:119], v[132:135]
  v_mfma_f32_16x16x32_bf16 v[136:139], a[96:99], v[120:123], v[136:139]
  v_mfma_f32_16x16x32_bf16 v[140:143], a[96:99], v[124:127], v[140:143]
  v_mfma_f32_16x16x32_bf16 v[144:147], a[84:87], v[96:99], v[144:147]
  v_mfma_f32_16x16x32_bf16 v[148:151], a[84:87], v[100:103], v[148:151]
  v_mfma_f32_16x16x32_bf16 v[152:155], a[84:87], v[104:107], v[152:155]
  v_mfma_f32_16x16x32_bf16 v[156:159], a[84:87], v[108:111], v[156:159]
  v_mfma_f32_16x16x32_bf16 v[144:147], a[100:103], v[112:115], v[144:147]
  ds_write_b128 v7, v[128:131] offset:0
  v_mfma_f32_16x16x32_bf16 v[148:151], a[100:103], v[116:119], v[148:151]
  ds_write_b128 v7, v[132:135] offset:1024
  v_mfma_f32_16x16x32_bf16 v[152:155], a[100:103], v[120:123], v[152:155]
  ds_write_b128 v7, v[136:139] offset:2048
  v_mfma_f32_16x16x32_bf16 v[156:159], a[100:103], v[124:127], v[156:159]
  ds_write_b128 v7, v[140:143] offset:3072
  v_mfma_f32_16x16x32_bf16 v[160:163], a[88:91], v[96:99], v[160:163]
  v_mfma_f32_16x16x32_bf16 v[164:167], a[88:91], v[100:103], v[164:167]
  v_mfma_f32_16x16x32_bf16 v[168:171], a[88:91], v[104:107], v[168:171]
  v_mfma_f32_16x16x32_bf16 v[172:175], a[88:91], v[108:111], v[172:175]
  v_mfma_f32_16x16x32_bf16 v[160:163], a[104:107], v[112:115], v[160:163]
  ds_write_b128 v7, v[144:147] offset:4096
  v_mfma_f32_16x16x32_bf16 v[164:167], a[104:107], v[116:119], v[164:167]
  ds_write_b128 v7, v[148:151] offset:5120
  v_mfma_f32_16x16x32_bf16 v[168:171], a[104:107], v[120:123], v[168:171]
  ds_write_b128 v7, v[152:155] offset:6144
  v_mfma_f32_16x16x32_bf16 v[172:175], a[104:107], v[124:127], v[172:175]
  ds_write_b128 v7, v[156:159] offset:7168
  v_mfma_f32_16x16x32_bf16 v[176:179], a[92:95], v[96:99], v[176:179]
  v_mfma_f32_16x16x32_bf16 v[180:183], a[92:95], v[100:103], v[180:183]
  v_mfma_f32_16x16x32_bf16 v[184:187], a[92:95], v[104:107], v[184:187]
  v_mfma_f32_16x16x32_bf16 v[188:191], a[92:95], v[108:111], v[188:191]
  v_mfma_f32_16x16x32_bf16 v[176:179], a[108:111], v[112:115], v[176:179]
  ds_write_b128 v7, v[160:163] offset:8192
  v_mfma_f32_16x16x32_bf16 v[180:183], a[108:111], v[116:119], v[180:183]
  ds_write_b128 v7, v[164:167] offset:9216
  v_mfma_f32_16x16x32_bf16 v[184:187], a[108:111], v[120:123], v[184:187]
  ds_write_b128 v7, v[168:171] offset:10240
  v_mfma_f32_16x16x32_bf16 v[188:191], a[108:111], v[124:127], v[188:191]
  ds_write_b128 v7, v[172:175] offset:11264
  s_nop 0
  ds_write_b128 v7, v[176:179] offset:12288
  s_nop 0
  ds_write_b128 v7, v[180:183] offset:13312
  s_nop 0
  ds_write_b128 v7, v[184:187] offset:14336
  s_nop 0
  ds_write_b128 v7, v[188:191] offset:15360
  s_lshl_b32 s82, s52, 10
  s_add_u32 s82, s82, 0
  v_add_u32 v7, s82, v2
  s_waitcnt lgkmcnt(0)
  s_barrier
  ds_read_b128 v[16:19], v7 offset:0
  ds_read_b128 v[20:23], v7 offset:16384
  ds_read_b128 v[24:27], v7 offset:32768
  ds_read_b128 v[28:31], v7 offset:49152
  ds_read_b128 v[32:35], v7 offset:4096
  ds_read_b128 v[36:39], v7 offset:20480
  ds_read_b128 v[40:43], v7 offset:36864
  ds_read_b128 v[44:47], v7 offset:53248
  ds_read_b128 v[48:51], v7 offset:8192
  ds_read_b128 v[52:55], v7 offset:24576
  ds_read_b128 v[56:59], v7 offset:40960
  ds_read_b128 v[60:63], v7 offset:57344
  ds_read_b128 v[64:67], v7 offset:12288
  ds_read_b128 v[68:71], v7 offset:28672
  ds_read_b128 v[72:75], v7 offset:45056
  ds_read_b128 v[76:79], v7 offset:61440
  s_waitcnt lgkmcnt(12)
  v_pk_add_f32 v[16:17], v[16:17], v[20:21]
  v_pk_add_f32 v[24:25], v[24:25], v[28:29]
  v_pk_add_f32 v[18:19], v[18:19], v[22:23]
  v_pk_add_f32 v[26:27], v[26:27], v[30:31]
  v_pk_add_f32 v[16:17], v[16:17], v[24:25]
  v_pk_add_f32 v[18:19], v[18:19], v[26:27]
  v_pk_fma_f32 v[16:17], v[216:217], v[16:17], v[200:201]
  v_pk_fma_f32 v[18:19], v[218:219], v[18:19], v[202:203]
  v_cvt_pk_bf16_f32 v112, v16, v17
  v_cvt_pk_bf16_f32 v113, v18, v19
  s_waitcnt lgkmcnt(8)
  v_pk_add_f32 v[32:33], v[32:33], v[36:37]
  v_pk_add_f32 v[40:41], v[40:41], v[44:45]
  v_pk_add_f32 v[34:35], v[34:35], v[38:39]
  v_pk_add_f32 v[42:43], v[42:43], v[46:47]
  v_pk_add_f32 v[32:33], v[32:33], v[40:41]
  v_pk_add_f32 v[34:35], v[34:35], v[42:43]
  v_pk_fma_f32 v[32:33], v[220:221], v[32:33], v[204:205]
  v_pk_fma_f32 v[34:35], v[222:223], v[34:35], v[206:207]
  v_cvt_pk_bf16_f32 v114, v32, v33
  v_cvt_pk_bf16_f32 v115, v34, v35
  buffer_store_dwordx4 v[112:115], v9, s[44:47], s67 offen
  s_waitcnt lgkmcnt(4)
  v_pk_add_f32 v[48:49], v[48:49], v[52:53]
  v_pk_add_f32 v[56:57], v[56:57], v[60:61]
  v_pk_add_f32 v[50:51], v[50:51], v[54:55]
  v_pk_add_f32 v[58:59], v[58:59], v[62:63]
  v_pk_add_f32 v[48:49], v[48:49], v[56:57]
  v_pk_add_f32 v[50:51], v[50:51], v[58:59]
  v_pk_fma_f32 v[48:49], v[224:225], v[48:49], v[208:209]
  v_pk_fma_f32 v[50:51], v[226:227], v[50:51], v[210:211]
  v_cvt_pk_bf16_f32 v116, v48, v49
  v_cvt_pk_bf16_f32 v117, v50, v51
  s_waitcnt lgkmcnt(0)
  v_pk_add_f32 v[64:65], v[64:65], v[68:69]
  v_pk_add_f32 v[72:73], v[72:73], v[76:77]
  v_pk_add_f32 v[66:67], v[66:67], v[70:71]
  v_pk_add_f32 v[74:75], v[74:75], v[78:79]
  v_pk_add_f32 v[64:65], v[64:65], v[72:73]
  v_pk_add_f32 v[66:67], v[66:67], v[74:75]
  v_pk_fma_f32 v[64:65], v[228:229], v[64:65], v[212:213]
  v_pk_fma_f32 v[66:67], v[230:231], v[66:67], v[214:215]
  v_cvt_pk_bf16_f32 v118, v64, v65
  v_cvt_pk_bf16_f32 v119, v66, v67
  s_mov_b32 exec_hi, 0x0000ffff
  buffer_store_dwordx4 v[116:119], v9, s[44:47], s67 offen offset:64
  s_mov_b32 exec_hi, -1
  s_add_u32 s82, s2, s52
  s_cmp_eq_u32 s82, 0
  s_cbranch_scc0 L_end
  v_mov_b32 v5, s55
  s_mov_b64 exec, 1
  buffer_store_dword v5, off, s[48:51], 0 sc1
L_end:
  s_endpgm
.section .rodata,"a"
.p2align 6
.amdhsa_kernel adaLN_cond__sliding_block__mixer_gmlp__prompt_kernel
  .amdhsa_next_free_vgpr 512
  .amdhsa_next_free_sgpr 102
  .amdhsa_accum_offset 256
  .amdhsa_group_segment_fixed_size 0
  .amdhsa_kernarg_size 104
  .amdhsa_user_sgpr_count 2
  .amdhsa_user_sgpr_kernarg_segment_ptr 1
  .amdhsa_system_sgpr_workgroup_id_x 1
.end_amdhsa_kernel
```
